```python
import torch

def _softmax(x, axis=-1):
    return torch.softmax(x, dim=axis)
def _gelu(x):
    return torch.nn.functional.gelu(x, approximate="tanh")
def _silu(x):
    return torch.nn.functional.silu(x)
def _sigmoid(x):
    return torch.sigmoid(x)
def _layernorm(x, axis=-1, eps=1e-5):
    m = x.mean(dim=axis, keepdim=True)
    v = x.var(dim=axis, keepdim=True, unbiased=False)
    return (x - m) / torch.sqrt(v + eps)
def _scatter_add(tgt, idx, src, axis=0):
    return tgt.clone().index_add_(axis, idx, src)
def _segment_sum(src, seg, n):
    out = torch.zeros((n,) + src.shape[1:], dtype=src.dtype)
    return out.index_add_(0, seg, src)
def _pad(x, pw):
    flat = tuple(v for pair in reversed(pw) for v in pair)
    return torch.nn.functional.pad(x, flat)

kernel_name = 'sequential_preLN__sliding_local_dilated__dense_activation_gelu__prompt'

def setup_inputs():

    _w = (lambda a: (lambda t: t.to(torch.bfloat16) if t.is_floating_point() else t)(torch.as_tensor(a)))
    def _A_setup():
        B, S, D = 1, 2048, 576
        return {
            "x": _w((lambda *s: torch.randn(*s, dtype=torch.bfloat16) * 0.05)(B, S, D)),
            "wqkv": _w((lambda *s: torch.randn(*s, dtype=torch.bfloat16) * 0.05)(D, 3 * D)),
            "wo": _w((lambda *s: torch.randn(*s, dtype=torch.bfloat16) * 0.05)(D, D)),
        }
    _A_in = _A_setup()

    def _B_setup():
        B, S, D, F = 1, 2048, 576, 4608
        return {
            "x": _w((lambda *s: torch.randn(*s, dtype=torch.bfloat16) * 0.05)(B, S, D)),
            "w1": _w((lambda *s: torch.randn(*s, dtype=torch.bfloat16) * 0.8)(D, F) * (D ** -0.5)),
            "b1": _w((lambda *s: torch.randn(*s, dtype=torch.bfloat16) * 0.8)(F) * 0.01),
            "w2": _w((lambda *s: torch.randn(*s, dtype=torch.bfloat16) * 0.8)(F, D) * (F ** -0.5)),
            "b2": _w((lambda *s: torch.randn(*s, dtype=torch.bfloat16) * 0.8)(D) * 0.01),
        }
    _B_in = _B_setup()

    return {
        "A_x": _A_in["x"],
        "A_wqkv": _A_in["wqkv"],
        "A_wo": _A_in["wo"],
        "B_x": _B_in["x"],
        "B_w1": _B_in["w1"],
        "B_b1": _B_in["b1"],
        "B_w2": _B_in["w2"],
        "B_b2": _B_in["b2"],
    }

def reference(A_x, A_wqkv, A_wo, B_x, B_w1, B_b1, B_w2, B_b2):
    def _A_ref(x, wqkv, wo):
        B, S, D = x.shape
        H = 32; Dh = D // H
        W, dil = 8, 2
        qkv = (lambda x, *d: x.permute(*d))((x @ wqkv).reshape(B, S, 3, H, Dh), 2, 0, 3, 1, 4)
        q, k, v = qkv[0], qkv[1], qkv[2]
        scale = Dh ** -0.5
        pos = torch.arange(S)
        off = torch.arange(W) * dil
        idx = pos[:, None] - off[None, :]
        mask = idx >= 0
        idx_c = torch.where(mask, idx, 0).reshape(-1)
        kg = k[:, :, idx_c, :].reshape(B, H, S, W, Dh)
        vg = v[:, :, idx_c, :].reshape(B, H, S, W, Dh)
        logits = torch.einsum("bhsd,bhswd->bhsw", q, kg) * scale
        logits = torch.where(mask[None, None, :, :], logits, -1e9)
        attn = _softmax(logits, axis=-1)
        o = torch.einsum("bhsw,bhswd->bhsd", attn, vg)
        return (lambda x, *d: x.permute(*d))(o, 0, 2, 1, 3).reshape(B, S, D) @ wo

    def _B_ref(x, w1, b1, w2, b2):
        h = torch.einsum("bsd,df->bsf", x, w1) + b1
        h = _gelu(h)
        return torch.einsum("bsf,fd->bsd", h, w2) + b2

    x = A_x
    h = x + _A_ref(_layernorm(x, axis=-1), A_wqkv, A_wo)
    h2 = h + _B_ref(_layernorm(h, axis=-1), B_w1, B_b1, B_w2, B_b2)
    return h2
```

```asm
; @launch grid=(256,1,1) block=(256,1,1) lds=163840
.amdgcn_target "amdgcn-amd-amdhsa--gfx950"
.text
.globl sequential_preLN__sliding_local_dilated__dense_activation_gelu__prompt_kernel
.p2align 8
.type sequential_preLN__sliding_local_dilated__dense_activation_gelu__prompt_kernel,@function
sequential_preLN__sliding_local_dilated__dense_activation_gelu__prompt_kernel:
    s_cmp_ge_u32 s2, 256
    s_cbranch_scc1 L_end
    s_load_dwordx16 s[52:67], s[0:1], 0
    s_load_dwordx4 s[68:71], s[0:1], 64
    s_load_dwordx2 s[28:29], s[0:1], 80
    s_lshr_b32 s7, s2, 3
    s_getpc_b64 s[50:51]
    s_lshl_b32 s6, s7, 9
    v_lshlrev_b32 v1, 1, v0
    v_and_b32 v1, 0x180, v1
    v_add_u32 v1, s6, v1
    global_load_dword v253, v1, s[50:51]
    v_lshrrev_b32 v1, 6, v0
    v_and_b32 v0, 63, v0
    v_readfirstlane_b32 s3, v1
    s_and_b32 s6, s2, 7
    s_and_b32 s5, s6, 1
    s_lshl_b32 s5, s5, 2
    s_and_b32 s48, s7, 3
    s_add_u32 s5, s5, s48
    s_lshr_b32 s4, s6, 1
    s_lshl_b32 s4, s4, 3
    s_lshr_b32 s48, s7, 2
    s_add_u32 s4, s4, s48
    s_mov_b32 s10, 2359296
    s_mov_b32 s11, 0x20000
    s_lshl_b32 s6, s4, 6
    s_mul_i32 s7, s3, 20
    s_add_u32 s6, s6, s7
    s_sub_u32 s6, s6, 16
    s_and_b32 s48, s5, 1
    s_lshl_b32 s48, s48, 3
    v_lshrrev_b32 v232, 3, v0
    v_add_u32 v232, s48, v232
    v_and_b32 v233, 7, v0
    v_lshlrev_b32 v233, 4, v233
    v_add_u32 v234, s6, v232
    v_mul_i32_i24 v234, 1152, v234
    v_add_u32 v8, v234, v233
    s_waitcnt lgkmcnt(0)
    s_mov_b64 s[8:9], s[52:53]
    buffer_load_dwordx4 v[16:19], v8, s[8:11], 0 offen offset:0
    buffer_load_dwordx4 v[20:23], v8, s[8:11], 0 offen offset:128
    buffer_load_dwordx4 v[24:27], v8, s[8:11], 0 offen offset:256
    buffer_load_dwordx4 v[28:31], v8, s[8:11], 0 offen offset:384
    buffer_load_dwordx4 v[32:35], v8, s[8:11], 0 offen offset:512
    buffer_load_dwordx4 v[36:39], v8, s[8:11], 0 offen offset:640
    buffer_load_dwordx4 v[40:43], v8, s[8:11], 0 offen offset:768
    buffer_load_dwordx4 v[44:47], v8, s[8:11], 0 offen offset:896
    buffer_load_dwordx4 v[48:51], v8, s[8:11], 0 offen offset:1024
    s_mov_b64 s[12:13], s[54:55]
    s_mov_b64 s[16:17], s[56:57]
    s_mov_b64 s[20:21], s[60:61]
    s_mov_b64 s[36:37], s[62:63]
    s_mov_b64 s[24:25], s[64:65]
    s_mov_b64 s[40:41], s[66:67]
    s_mov_b64 s[32:33], s[68:69]
    s_mov_b64 s[44:45], s[70:71]
    s_mov_b32 s14, 1990656
    s_mov_b32 s15, 0x20000
    s_mov_b32 s18, 663552
    s_mov_b32 s19, 0x20000
    s_mov_b32 s30, 786432
    s_mov_b32 s31, 0x20000
    s_lshl_b32 s52, s2, 2
    s_add_u32 s52, s52, s3
    s_mul_i32 s52, s52, 16
    v_min_u32 v237, 15, v0
    v_add_u32 v237, s52, v237
    v_lshlrev_b32 v237, 7, v237
    buffer_load_dword v253, v237, s[12:15], 0 offen
    s_mul_i32 s52, s5, 5
    v_min_u32 v237, 4, v0
    v_add_u32 v237, s52, v237
    v_min_u32 v237, 35, v237
    v_lshlrev_b32 v237, 7, v237
    s_add_u32 s52, s6, 16
    s_mul_i32 s52, s52, 1152
    buffer_load_dword v253, v237, s[8:11], s52 offen
    s_mul_i32 s51, s4, 786432
    s_add_u32 s28, s28, s51
    s_addc_u32 s29, s29, 0
    s_lshl_b32 s52, s3, 10
    s_cmp_lg_u32 s5, 0
    s_cbranch_scc1 L_clr_1
    v_lshlrev_b32 v235, 4, v0
    v_mov_b32 v236, 0
    v_mov_b32 v237, 0
    v_mov_b32 v238, 0
    v_mov_b32 v239, 0
    buffer_store_dwordx4 v[236:239], v235, s[28:31], s52 offen sc1
    L_clr_1:
    v_xor_b32 v234, 8, v232
    v_add_u32 v235, s6, v234
    v_mul_i32_i24 v235, 1152, v235
    v_add_u32 v9, v235, v233
    v_add_u32 v232, s7, v232
    v_mul_u32_u24 v232, 1184, v232
    v_add_u32 v233, 65536, v233
    v_add_u32 v224, v232, v233
    v_add_u32 v234, s7, v234
    v_mul_u32_u24 v234, 1184, v234
    v_add_u32 v225, v234, v233
    v_and_b32 v1, 15, v0
    v_lshrrev_b32 v2, 4, v0
    v_add_u32 v232, 16, v2
    v_add_u32 v235, s6, v232
    v_mul_i32_i24 v235, 1152, v235
    v_lshl_add_u32 v10, v1, 3, v235
    v_add_u32 v232, s7, v232
    v_mul_u32_u24 v232, 1184, v232
    v_lshl_add_u32 v232, v1, 3, v232
    v_add_u32 v226, 65536, v232
    s_mov_b32 s49, 0xffff0000
    s_mul_i32 s53, s5, 144
    s_movk_i32 s60, 1152
    s_lshl_b32 s6, s3, 8
    v_add_u32 v236, s6, v0
    v_add_u32 v232, 0, v236
    v_mul_u32_u24 v240, 6554, v232
    v_lshrrev_b32 v240, 16, v240
    v_mad_i32_i24 v244, v240, -10, v232
    v_min_u32 v244, 8, v244
    v_subrev_u32 v244, 0, v244
    v_lshlrev_b32 v244, 4, v244
    v_and_b32 v232, 3, v240
    v_bfe_u32 v233, v240, 4, 1
    v_lshl_add_u32 v232, v233, 2, v232
    v_bfe_u32 v233, v240, 2, 2
    v_lshl_add_u32 v232, v233, 3, v232
    v_lshrrev_b32 v233, 5, v240
    v_mad_u32_u24 v232, v232, 3, v233
    v_mad_u32_u24 v4, v232, s60, v244
    v_add_u32 v232, 64, v236
    v_mul_u32_u24 v241, 6554, v232
    v_lshrrev_b32 v241, 16, v241
    v_mad_i32_i24 v245, v241, -10, v232
    v_min_u32 v245, 8, v245
    v_subrev_u32 v245, 64, v245
    v_lshlrev_b32 v245, 4, v245
    v_and_b32 v232, 3, v241
    v_bfe_u32 v233, v241, 4, 1
    v_lshl_add_u32 v232, v233, 2, v232
    v_bfe_u32 v233, v241, 2, 2
    v_lshl_add_u32 v232, v233, 3, v232
    v_lshrrev_b32 v233, 5, v241
    v_mad_u32_u24 v232, v232, 3, v233
    v_mad_u32_u24 v5, v232, s60, v245
    v_add_u32 v232, 128, v236
    v_mul_u32_u24 v242, 6554, v232
    v_lshrrev_b32 v242, 16, v242
    v_mad_i32_i24 v246, v242, -10, v232
    v_min_u32 v246, 8, v246
    v_subrev_u32 v246, 128, v246
    v_lshlrev_b32 v246, 4, v246
    v_and_b32 v232, 3, v242
    v_bfe_u32 v233, v242, 4, 1
    v_lshl_add_u32 v232, v233, 2, v232
    v_bfe_u32 v233, v242, 2, 2
    v_lshl_add_u32 v232, v233, 3, v232
    v_lshrrev_b32 v233, 5, v242
    v_mad_u32_u24 v232, v232, 3, v233
    v_mad_u32_u24 v6, v232, s60, v246
    v_add_u32 v232, 192, v236
    v_mul_u32_u24 v243, 6554, v232
    v_lshrrev_b32 v243, 16, v243
    v_mad_i32_i24 v247, v243, -10, v232
    v_min_u32 v247, 8, v247
    v_subrev_u32 v247, 192, v247
    v_lshlrev_b32 v247, 4, v247
    v_and_b32 v232, 3, v243
    v_bfe_u32 v233, v243, 4, 1
    v_lshl_add_u32 v232, v233, 2, v232
    v_bfe_u32 v233, v243, 2, 2
    v_lshl_add_u32 v232, v233, 3, v232
    v_lshrrev_b32 v233, 5, v243
    v_mad_u32_u24 v232, v232, 3, v233
    v_mad_u32_u24 v7, v232, s60, v247
    s_cmp_eq_u32 s3, 3
    s_cselect_b32 s71, 0x7f000000, 0
    v_or_b32 v7, s71, v7
    s_and_b32 s6, s4, 3
    s_lshl_b32 s6, s6, 1
    s_lshl_b32 s55, s6, 7
    s_mul_i32 s54, s6, 221184
    s_add_u32 s54, s54, s53
    s_add_u32 s56, s53, 1990656
    s_lshl_b32 s57, s3, 12
    s_and_b32 s6, s3, 1
    s_lshl_b32 s6, s6, 2
    s_mul_i32 s7, s3, 36
    s_add_u32 s7, s7, s6
    v_lshrrev_b32 v232, 2, v0
    v_mul_u32_u24 v232, 160, v232
    v_and_b32 v233, 3, v0
    v_lshl_add_u32 v228, v233, 3, v232
    v_add_u32 v13, s7, v228
    s_lshr_b32 s6, s3, 1
    s_mul_i32 s6, s6, 72
    s_add_u32 s6, s6, 32
    v_mul_u32_u24 v14, 5120, v233
    v_add3_u32 v14, v14, v232, s6
    v_mov_b32 v234, 15360
    v_cmp_eq_u32 vcc, 3, v233
    v_mul_u32_u24 v235, 1184, v1
    v_add_u32 v223, 2560, v14
    v_cndmask_b32 v14, v14, v234, vcc
    v_cndmask_b32 v223, v223, v234, vcc
    v_lshl_add_u32 v222, v2, 4, v235
    v_add_u32 v222, 65536, v222
    v_add_u32 v15, s55, v222
    v_add_u32 v3, 75776, v15
    s_waitcnt vmcnt(10)
    buffer_load_dwordx4 v[52:55], v9, s[8:11], 0 offen offset:0
    v_lshlrev_b32 v108, 16, v16
    v_and_b32 v109, s49, v16
    v_pk_mul_f32 v[184:185], v[108:109], v[108:109]
    v_lshlrev_b32 v110, 16, v17
    v_and_b32 v111, s49, v17
    v_pk_mul_f32 v[186:187], v[110:111], v[110:111]
    v_lshlrev_b32 v112, 16, v18
    v_and_b32 v113, s49, v18
    v_pk_fma_f32 v[184:185], v[112:113], v[112:113], v[184:185]
    v_pk_add_f32 v[180:181], v[112:113], v[108:109]
    v_lshlrev_b32 v114, 16, v19
    v_and_b32 v115, s49, v19
    v_pk_fma_f32 v[186:187], v[114:115], v[114:115], v[186:187]
    v_pk_add_f32 v[182:183], v[114:115], v[110:111]
    s_waitcnt vmcnt(10)
    buffer_load_dwordx4 v[56:59], v9, s[8:11], 0 offen offset:128
    v_lshlrev_b32 v116, 16, v20
    v_and_b32 v117, s49, v20
    v_pk_fma_f32 v[184:185], v[116:117], v[116:117], v[184:185]
    v_pk_add_f32 v[180:181], v[116:117], v[180:181]
    v_lshlrev_b32 v118, 16, v21
    v_and_b32 v119, s49, v21
    v_pk_fma_f32 v[186:187], v[118:119], v[118:119], v[186:187]
    v_pk_add_f32 v[182:183], v[118:119], v[182:183]
    v_lshlrev_b32 v120, 16, v22
    v_and_b32 v121, s49, v22
    v_pk_fma_f32 v[184:185], v[120:121], v[120:121], v[184:185]
    v_pk_add_f32 v[180:181], v[120:121], v[180:181]
    v_lshlrev_b32 v122, 16, v23
    v_and_b32 v123, s49, v23
    v_pk_fma_f32 v[186:187], v[122:123], v[122:123], v[186:187]
    v_pk_add_f32 v[182:183], v[122:123], v[182:183]
    s_waitcnt vmcnt(10)
    buffer_load_dwordx4 v[60:63], v9, s[8:11], 0 offen offset:256
    v_lshlrev_b32 v124, 16, v24
    v_and_b32 v125, s49, v24
    v_pk_fma_f32 v[184:185], v[124:125], v[124:125], v[184:185]
    v_pk_add_f32 v[180:181], v[124:125], v[180:181]
    v_lshlrev_b32 v126, 16, v25
    v_and_b32 v127, s49, v25
    v_pk_fma_f32 v[186:187], v[126:127], v[126:127], v[186:187]
    v_pk_add_f32 v[182:183], v[126:127], v[182:183]
    v_lshlrev_b32 v128, 16, v26
    v_and_b32 v129, s49, v26
    v_pk_fma_f32 v[184:185], v[128:129], v[128:129], v[184:185]
    v_pk_add_f32 v[180:181], v[128:129], v[180:181]
    v_lshlrev_b32 v130, 16, v27
    v_and_b32 v131, s49, v27
    v_pk_fma_f32 v[186:187], v[130:131], v[130:131], v[186:187]
    v_pk_add_f32 v[182:183], v[130:131], v[182:183]
    s_waitcnt vmcnt(10)
    buffer_load_dwordx4 v[64:67], v9, s[8:11], 0 offen offset:384
    v_lshlrev_b32 v132, 16, v28
    v_and_b32 v133, s49, v28
    v_pk_fma_f32 v[184:185], v[132:133], v[132:133], v[184:185]
    v_pk_add_f32 v[180:181], v[132:133], v[180:181]
    v_lshlrev_b32 v134, 16, v29
    v_and_b32 v135, s49, v29
    v_pk_fma_f32 v[186:187], v[134:135], v[134:135], v[186:187]
    v_pk_add_f32 v[182:183], v[134:135], v[182:183]
    v_lshlrev_b32 v136, 16, v30
    v_and_b32 v137, s49, v30
    v_pk_fma_f32 v[184:185], v[136:137], v[136:137], v[184:185]
    v_pk_add_f32 v[180:181], v[136:137], v[180:181]
    v_lshlrev_b32 v138, 16, v31
    v_and_b32 v139, s49, v31
    v_pk_fma_f32 v[186:187], v[138:139], v[138:139], v[186:187]
    v_pk_add_f32 v[182:183], v[138:139], v[182:183]
    s_waitcnt vmcnt(10)
    buffer_load_dwordx4 v[68:71], v9, s[8:11], 0 offen offset:512
    v_lshlrev_b32 v140, 16, v32
    v_and_b32 v141, s49, v32
    v_pk_fma_f32 v[184:185], v[140:141], v[140:141], v[184:185]
    v_pk_add_f32 v[180:181], v[140:141], v[180:181]
    v_lshlrev_b32 v142, 16, v33
    v_and_b32 v143, s49, v33
    v_pk_fma_f32 v[186:187], v[142:143], v[142:143], v[186:187]
    v_pk_add_f32 v[182:183], v[142:143], v[182:183]
    v_lshlrev_b32 v144, 16, v34
    v_and_b32 v145, s49, v34
    v_pk_fma_f32 v[184:185], v[144:145], v[144:145], v[184:185]
    v_pk_add_f32 v[180:181], v[144:145], v[180:181]
    v_lshlrev_b32 v146, 16, v35
    v_and_b32 v147, s49, v35
    v_pk_fma_f32 v[186:187], v[146:147], v[146:147], v[186:187]
    v_pk_add_f32 v[182:183], v[146:147], v[182:183]
    s_waitcnt vmcnt(10)
    buffer_load_dwordx4 v[72:75], v9, s[8:11], 0 offen offset:640
    v_lshlrev_b32 v148, 16, v36
    v_and_b32 v149, s49, v36
    v_pk_fma_f32 v[184:185], v[148:149], v[148:149], v[184:185]
    v_pk_add_f32 v[180:181], v[148:149], v[180:181]
    v_lshlrev_b32 v150, 16, v37
    v_and_b32 v151, s49, v37
    v_pk_fma_f32 v[186:187], v[150:151], v[150:151], v[186:187]
    v_pk_add_f32 v[182:183], v[150:151], v[182:183]
    v_lshlrev_b32 v152, 16, v38
    v_and_b32 v153, s49, v38
    v_pk_fma_f32 v[184:185], v[152:153], v[152:153], v[184:185]
    v_pk_add_f32 v[180:181], v[152:153], v[180:181]
    v_lshlrev_b32 v154, 16, v39
    v_and_b32 v155, s49, v39
    v_pk_fma_f32 v[186:187], v[154:155], v[154:155], v[186:187]
    v_pk_add_f32 v[182:183], v[154:155], v[182:183]
    s_waitcnt vmcnt(10)
    buffer_load_dwordx4 v[76:79], v9, s[8:11], 0 offen offset:768
    v_lshlrev_b32 v156, 16, v40
    v_and_b32 v157, s49, v40
    v_pk_fma_f32 v[184:185], v[156:157], v[156:157], v[184:185]
    v_pk_add_f32 v[180:181], v[156:157], v[180:181]
    v_lshlrev_b32 v158, 16, v41
    v_and_b32 v159, s49, v41
    v_pk_fma_f32 v[186:187], v[158:159], v[158:159], v[186:187]
    v_pk_add_f32 v[182:183], v[158:159], v[182:183]
    v_lshlrev_b32 v160, 16, v42
    v_and_b32 v161, s49, v42
    v_pk_fma_f32 v[184:185], v[160:161], v[160:161], v[184:185]
    v_pk_add_f32 v[180:181], v[160:161], v[180:181]
    v_lshlrev_b32 v162, 16, v43
    v_and_b32 v163, s49, v43
    v_pk_fma_f32 v[186:187], v[162:163], v[162:163], v[186:187]
    v_pk_add_f32 v[182:183], v[162:163], v[182:183]
    s_waitcnt vmcnt(10)
    buffer_load_dwordx4 v[80:83], v9, s[8:11], 0 offen offset:896
    v_lshlrev_b32 v164, 16, v44
    v_and_b32 v165, s49, v44
    v_pk_fma_f32 v[184:185], v[164:165], v[164:165], v[184:185]
    v_pk_add_f32 v[180:181], v[164:165], v[180:181]
    v_lshlrev_b32 v166, 16, v45
    v_and_b32 v167, s49, v45
    v_pk_fma_f32 v[186:187], v[166:167], v[166:167], v[186:187]
    v_pk_add_f32 v[182:183], v[166:167], v[182:183]
    v_lshlrev_b32 v168, 16, v46
    v_and_b32 v169, s49, v46
    v_pk_fma_f32 v[184:185], v[168:169], v[168:169], v[184:185]
    v_pk_add_f32 v[180:181], v[168:169], v[180:181]
    v_lshlrev_b32 v170, 16, v47
    v_and_b32 v171, s49, v47
    v_pk_fma_f32 v[186:187], v[170:171], v[170:171], v[186:187]
    v_pk_add_f32 v[182:183], v[170:171], v[182:183]
    s_waitcnt vmcnt(10)
    buffer_load_dwordx4 v[84:87], v9, s[8:11], 0 offen offset:1024
    v_lshlrev_b32 v172, 16, v48
    v_and_b32 v173, s49, v48
    v_pk_fma_f32 v[184:185], v[172:173], v[172:173], v[184:185]
    v_pk_add_f32 v[180:181], v[172:173], v[180:181]
    v_lshlrev_b32 v174, 16, v49
    v_and_b32 v175, s49, v49
    v_pk_fma_f32 v[186:187], v[174:175], v[174:175], v[186:187]
    v_pk_add_f32 v[182:183], v[174:175], v[182:183]
    v_lshlrev_b32 v176, 16, v50
    v_and_b32 v177, s49, v50
    v_pk_fma_f32 v[184:185], v[176:177], v[176:177], v[184:185]
    v_pk_add_f32 v[180:181], v[176:177], v[180:181]
    v_lshlrev_b32 v178, 16, v51
    v_and_b32 v179, s49, v51
    v_pk_fma_f32 v[186:187], v[178:179], v[178:179], v[186:187]
    v_pk_add_f32 v[182:183], v[178:179], v[182:183]
    v_pk_add_f32 v[180:181], v[180:181], v[182:183]
    v_pk_add_f32 v[184:185], v[184:185], v[186:187]
    v_add_f32 v180, v180, v181
    v_add_f32 v181, v184, v185
    s_nop 0
    v_add_f32_dpp v180, v180, v180 quad_perm:[1,0,3,2] row_mask:0xf bank_mask:0xf
    v_add_f32_dpp v181, v181, v181 quad_perm:[1,0,3,2] row_mask:0xf bank_mask:0xf
    s_nop 0
    v_add_f32_dpp v180, v180, v180 quad_perm:[2,3,0,1] row_mask:0xf bank_mask:0xf
    v_add_f32_dpp v181, v181, v181 quad_perm:[2,3,0,1] row_mask:0xf bank_mask:0xf
    s_nop 0
    v_add_f32_dpp v180, v180, v180 row_half_mirror row_mask:0xf bank_mask:0xf
    v_add_f32_dpp v181, v181, v181 row_half_mirror row_mask:0xf bank_mask:0xf
    v_mul_f32 v180, 0x3ae38e39, v180
    v_mul_f32 v181, 0x3ae38e39, v181
    v_fma_f32 v181, -v180, v180, v181
    v_max_f32 v181, 0, v181
    v_add_f32 v181, 0x3727c5ac, v181
    v_rsq_f32 v182, v181
    s_nop 0
    v_mul_f32 v183, -v180, v182
    v_pk_fma_f32 v[108:109], v[108:109], v[182:183], v[182:183] op_sel:[0,0,1] op_sel_hi:[1,0,1]
    v_cvt_pk_bf16_f32 v16, v108, v109
    v_pk_fma_f32 v[110:111], v[110:111], v[182:183], v[182:183] op_sel:[0,0,1] op_sel_hi:[1,0,1]
    v_cvt_pk_bf16_f32 v17, v110, v111
    v_pk_fma_f32 v[112:113], v[112:113], v[182:183], v[182:183] op_sel:[0,0,1] op_sel_hi:[1,0,1]
    v_cvt_pk_bf16_f32 v18, v112, v113
    v_pk_fma_f32 v[114:115], v[114:115], v[182:183], v[182:183] op_sel:[0,0,1] op_sel_hi:[1,0,1]
    v_cvt_pk_bf16_f32 v19, v114, v115
    ds_write_b128 v224, v[16:19] offset:0
    v_pk_fma_f32 v[116:117], v[116:117], v[182:183], v[182:183] op_sel:[0,0,1] op_sel_hi:[1,0,1]
    v_cvt_pk_bf16_f32 v20, v116, v117
    v_pk_fma_f32 v[118:119], v[118:119], v[182:183], v[182:183] op_sel:[0,0,1] op_sel_hi:[1,0,1]
    v_cvt_pk_bf16_f32 v21, v118, v119
    v_pk_fma_f32 v[120:121], v[120:121], v[182:183], v[182:183] op_sel:[0,0,1] op_sel_hi:[1,0,1]
    v_cvt_pk_bf16_f32 v22, v120, v121
    v_pk_fma_f32 v[122:123], v[122:123], v[182:183], v[182:183] op_sel:[0,0,1] op_sel_hi:[1,0,1]
    v_cvt_pk_bf16_f32 v23, v122, v123
    ds_write_b128 v224, v[20:23] offset:128
    buffer_load_dwordx2 v[88:89], v10, s[8:11], 0 offen offset:0
    v_pk_fma_f32 v[124:125], v[124:125], v[182:183], v[182:183] op_sel:[0,0,1] op_sel_hi:[1,0,1]
    v_cvt_pk_bf16_f32 v24, v124, v125
    v_pk_fma_f32 v[126:127], v[126:127], v[182:183], v[182:183] op_sel:[0,0,1] op_sel_hi:[1,0,1]
    v_cvt_pk_bf16_f32 v25, v126, v127
    v_pk_fma_f32 v[128:129], v[128:129], v[182:183], v[182:183] op_sel:[0,0,1] op_sel_hi:[1,0,1]
    v_cvt_pk_bf16_f32 v26, v128, v129
    v_pk_fma_f32 v[130:131], v[130:131], v[182:183], v[182:183] op_sel:[0,0,1] op_sel_hi:[1,0,1]
    v_cvt_pk_bf16_f32 v27, v130, v131
    ds_write_b128 v224, v[24:27] offset:256
    v_pk_fma_f32 v[132:133], v[132:133], v[182:183], v[182:183] op_sel:[0,0,1] op_sel_hi:[1,0,1]
    v_cvt_pk_bf16_f32 v28, v132, v133
    v_pk_fma_f32 v[134:135], v[134:135], v[182:183], v[182:183] op_sel:[0,0,1] op_sel_hi:[1,0,1]
    v_cvt_pk_bf16_f32 v29, v134, v135
    v_pk_fma_f32 v[136:137], v[136:137], v[182:183], v[182:183] op_sel:[0,0,1] op_sel_hi:[1,0,1]
    v_cvt_pk_bf16_f32 v30, v136, v137
    v_pk_fma_f32 v[138:139], v[138:139], v[182:183], v[182:183] op_sel:[0,0,1] op_sel_hi:[1,0,1]
    v_cvt_pk_bf16_f32 v31, v138, v139
    ds_write_b128 v224, v[28:31] offset:384
    buffer_load_dwordx2 v[90:91], v10, s[8:11], 0 offen offset:128
    v_pk_fma_f32 v[140:141], v[140:141], v[182:183], v[182:183] op_sel:[0,0,1] op_sel_hi:[1,0,1]
    v_cvt_pk_bf16_f32 v32, v140, v141
    v_pk_fma_f32 v[142:143], v[142:143], v[182:183], v[182:183] op_sel:[0,0,1] op_sel_hi:[1,0,1]
    v_cvt_pk_bf16_f32 v33, v142, v143
    v_pk_fma_f32 v[144:145], v[144:145], v[182:183], v[182:183] op_sel:[0,0,1] op_sel_hi:[1,0,1]
    v_cvt_pk_bf16_f32 v34, v144, v145
    v_pk_fma_f32 v[146:147], v[146:147], v[182:183], v[182:183] op_sel:[0,0,1] op_sel_hi:[1,0,1]
    v_cvt_pk_bf16_f32 v35, v146, v147
    ds_write_b128 v224, v[32:35] offset:512
    v_pk_fma_f32 v[148:149], v[148:149], v[182:183], v[182:183] op_sel:[0,0,1] op_sel_hi:[1,0,1]
    v_cvt_pk_bf16_f32 v36, v148, v149
    v_pk_fma_f32 v[150:151], v[150:151], v[182:183], v[182:183] op_sel:[0,0,1] op_sel_hi:[1,0,1]
    v_cvt_pk_bf16_f32 v37, v150, v151
    v_pk_fma_f32 v[152:153], v[152:153], v[182:183], v[182:183] op_sel:[0,0,1] op_sel_hi:[1,0,1]
    v_cvt_pk_bf16_f32 v38, v152, v153
    v_pk_fma_f32 v[154:155], v[154:155], v[182:183], v[182:183] op_sel:[0,0,1] op_sel_hi:[1,0,1]
    v_cvt_pk_bf16_f32 v39, v154, v155
    ds_write_b128 v224, v[36:39] offset:640
    buffer_load_dwordx2 v[92:93], v10, s[8:11], 0 offen offset:256
    v_pk_fma_f32 v[156:157], v[156:157], v[182:183], v[182:183] op_sel:[0,0,1] op_sel_hi:[1,0,1]
    v_cvt_pk_bf16_f32 v40, v156, v157
    v_pk_fma_f32 v[158:159], v[158:159], v[182:183], v[182:183] op_sel:[0,0,1] op_sel_hi:[1,0,1]
    v_cvt_pk_bf16_f32 v41, v158, v159
    v_pk_fma_f32 v[160:161], v[160:161], v[182:183], v[182:183] op_sel:[0,0,1] op_sel_hi:[1,0,1]
    v_cvt_pk_bf16_f32 v42, v160, v161
    v_pk_fma_f32 v[162:163], v[162:163], v[182:183], v[182:183] op_sel:[0,0,1] op_sel_hi:[1,0,1]
    v_cvt_pk_bf16_f32 v43, v162, v163
    ds_write_b128 v224, v[40:43] offset:768
    v_pk_fma_f32 v[164:165], v[164:165], v[182:183], v[182:183] op_sel:[0,0,1] op_sel_hi:[1,0,1]
    v_cvt_pk_bf16_f32 v44, v164, v165
    v_pk_fma_f32 v[166:167], v[166:167], v[182:183], v[182:183] op_sel:[0,0,1] op_sel_hi:[1,0,1]
    v_cvt_pk_bf16_f32 v45, v166, v167
    v_pk_fma_f32 v[168:169], v[168:169], v[182:183], v[182:183] op_sel:[0,0,1] op_sel_hi:[1,0,1]
    v_cvt_pk_bf16_f32 v46, v168, v169
    v_pk_fma_f32 v[170:171], v[170:171], v[182:183], v[182:183] op_sel:[0,0,1] op_sel_hi:[1,0,1]
    v_cvt_pk_bf16_f32 v47, v170, v171
    ds_write_b128 v224, v[44:47] offset:896
    buffer_load_dwordx2 v[94:95], v10, s[8:11], 0 offen offset:384
    v_pk_fma_f32 v[172:173], v[172:173], v[182:183], v[182:183] op_sel:[0,0,1] op_sel_hi:[1,0,1]
    v_cvt_pk_bf16_f32 v48, v172, v173
    v_pk_fma_f32 v[174:175], v[174:175], v[182:183], v[182:183] op_sel:[0,0,1] op_sel_hi:[1,0,1]
    v_cvt_pk_bf16_f32 v49, v174, v175
    v_pk_fma_f32 v[176:177], v[176:177], v[182:183], v[182:183] op_sel:[0,0,1] op_sel_hi:[1,0,1]
    v_cvt_pk_bf16_f32 v50, v176, v177
    v_pk_fma_f32 v[178:179], v[178:179], v[182:183], v[182:183] op_sel:[0,0,1] op_sel_hi:[1,0,1]
    v_cvt_pk_bf16_f32 v51, v178, v179
    ds_write_b128 v224, v[48:51] offset:1024
    buffer_load_dwordx2 v[96:97], v10, s[8:11], 0 offen offset:512
    s_waitcnt vmcnt(13)
    buffer_load_dwordx2 v[98:99], v10, s[8:11], 0 offen offset:640
    v_lshlrev_b32 v108, 16, v52
    v_and_b32 v109, s49, v52
    v_pk_mul_f32 v[184:185], v[108:109], v[108:109]
    v_lshlrev_b32 v110, 16, v53
    v_and_b32 v111, s49, v53
    v_pk_mul_f32 v[186:187], v[110:111], v[110:111]
    v_lshlrev_b32 v112, 16, v54
    v_and_b32 v113, s49, v54
    v_pk_fma_f32 v[184:185], v[112:113], v[112:113], v[184:185]
    v_pk_add_f32 v[180:181], v[112:113], v[108:109]
    v_lshlrev_b32 v114, 16, v55
    v_and_b32 v115, s49, v55
    v_pk_fma_f32 v[186:187], v[114:115], v[114:115], v[186:187]
    v_pk_add_f32 v[182:183], v[114:115], v[110:111]
    s_waitcnt vmcnt(13)
    buffer_load_dwordx2 v[100:101], v10, s[8:11], 0 offen offset:768
    v_lshlrev_b32 v116, 16, v56
    v_and_b32 v117, s49, v56
    v_pk_fma_f32 v[184:185], v[116:117], v[116:117], v[184:185]
    v_pk_add_f32 v[180:181], v[116:117], v[180:181]
    v_lshlrev_b32 v118, 16, v57
    v_and_b32 v119, s49, v57
    v_pk_fma_f32 v[186:187], v[118:119], v[118:119], v[186:187]
    v_pk_add_f32 v[182:183], v[118:119], v[182:183]
    v_lshlrev_b32 v120, 16, v58
    v_and_b32 v121, s49, v58
    v_pk_fma_f32 v[184:185], v[120:121], v[120:121], v[184:185]
    v_pk_add_f32 v[180:181], v[120:121], v[180:181]
    v_lshlrev_b32 v122, 16, v59
    v_and_b32 v123, s49, v59
    v_pk_fma_f32 v[186:187], v[122:123], v[122:123], v[186:187]
    v_pk_add_f32 v[182:183], v[122:123], v[182:183]
    s_waitcnt vmcnt(13)
    buffer_load_dwordx2 v[102:103], v10, s[8:11], 0 offen offset:896
    v_lshlrev_b32 v124, 16, v60
    v_and_b32 v125, s49, v60
    v_pk_fma_f32 v[184:185], v[124:125], v[124:125], v[184:185]
    v_pk_add_f32 v[180:181], v[124:125], v[180:181]
    v_lshlrev_b32 v126, 16, v61
    v_and_b32 v127, s49, v61
    v_pk_fma_f32 v[186:187], v[126:127], v[126:127], v[186:187]
    v_pk_add_f32 v[182:183], v[126:127], v[182:183]
    v_lshlrev_b32 v128, 16, v62
    v_and_b32 v129, s49, v62
    v_pk_fma_f32 v[184:185], v[128:129], v[128:129], v[184:185]
    v_pk_add_f32 v[180:181], v[128:129], v[180:181]
    v_lshlrev_b32 v130, 16, v63
    v_and_b32 v131, s49, v63
    v_pk_fma_f32 v[186:187], v[130:131], v[130:131], v[186:187]
    v_pk_add_f32 v[182:183], v[130:131], v[182:183]
    s_waitcnt vmcnt(13)
    buffer_load_dwordx2 v[104:105], v10, s[8:11], 0 offen offset:1024
    v_lshlrev_b32 v132, 16, v64
    v_and_b32 v133, s49, v64
    v_pk_fma_f32 v[184:185], v[132:133], v[132:133], v[184:185]
    v_pk_add_f32 v[180:181], v[132:133], v[180:181]
    v_lshlrev_b32 v134, 16, v65
    v_and_b32 v135, s49, v65
    v_pk_fma_f32 v[186:187], v[134:135], v[134:135], v[186:187]
    v_pk_add_f32 v[182:183], v[134:135], v[182:183]
    v_lshlrev_b32 v136, 16, v66
    v_and_b32 v137, s49, v66
    v_pk_fma_f32 v[184:185], v[136:137], v[136:137], v[184:185]
    v_pk_add_f32 v[180:181], v[136:137], v[180:181]
    v_lshlrev_b32 v138, 16, v67
    v_and_b32 v139, s49, v67
    v_pk_fma_f32 v[186:187], v[138:139], v[138:139], v[186:187]
    v_pk_add_f32 v[182:183], v[138:139], v[182:183]
    s_waitcnt vmcnt(13)
    s_add_u32 m0, s57, 0
    s_mov_b32 s58, s54
    buffer_load_dwordx4 v4, s[12:15], s58 offen lds
    v_lshlrev_b32 v140, 16, v68
    v_and_b32 v141, s49, v68
    v_pk_fma_f32 v[184:185], v[140:141], v[140:141], v[184:185]
    v_pk_add_f32 v[180:181], v[140:141], v[180:181]
    v_lshlrev_b32 v142, 16, v69
    v_and_b32 v143, s49, v69
    v_pk_fma_f32 v[186:187], v[142:143], v[142:143], v[186:187]
    v_pk_add_f32 v[182:183], v[142:143], v[182:183]
    v_lshlrev_b32 v144, 16, v70
    v_and_b32 v145, s49, v70
    v_pk_fma_f32 v[184:185], v[144:145], v[144:145], v[184:185]
    v_pk_add_f32 v[180:181], v[144:145], v[180:181]
    v_lshlrev_b32 v146, 16, v71
    v_and_b32 v147, s49, v71
    v_pk_fma_f32 v[186:187], v[146:147], v[146:147], v[186:187]
    v_pk_add_f32 v[182:183], v[146:147], v[182:183]
    s_waitcnt vmcnt(13)
    buffer_load_dwordx4 v5, s[12:15], s58 offen offset:1024 lds
    v_lshlrev_b32 v148, 16, v72
    v_and_b32 v149, s49, v72
    v_pk_fma_f32 v[184:185], v[148:149], v[148:149], v[184:185]
    v_pk_add_f32 v[180:181], v[148:149], v[180:181]
    v_lshlrev_b32 v150, 16, v73
    v_and_b32 v151, s49, v73
    v_pk_fma_f32 v[186:187], v[150:151], v[150:151], v[186:187]
    v_pk_add_f32 v[182:183], v[150:151], v[182:183]
    v_lshlrev_b32 v152, 16, v74
    v_and_b32 v153, s49, v74
    v_pk_fma_f32 v[184:185], v[152:153], v[152:153], v[184:185]
    v_pk_add_f32 v[180:181], v[152:153], v[180:181]
    v_lshlrev_b32 v154, 16, v75
    v_and_b32 v155, s49, v75
    v_pk_fma_f32 v[186:187], v[154:155], v[154:155], v[186:187]
    v_pk_add_f32 v[182:183], v[154:155], v[182:183]
    s_waitcnt vmcnt(13)
    buffer_load_dwordx4 v6, s[12:15], s58 offen offset:2048 lds
    v_lshlrev_b32 v156, 16, v76
    v_and_b32 v157, s49, v76
    v_pk_fma_f32 v[184:185], v[156:157], v[156:157], v[184:185]
    v_pk_add_f32 v[180:181], v[156:157], v[180:181]
    v_lshlrev_b32 v158, 16, v77
    v_and_b32 v159, s49, v77
    v_pk_fma_f32 v[186:187], v[158:159], v[158:159], v[186:187]
    v_pk_add_f32 v[182:183], v[158:159], v[182:183]
    v_lshlrev_b32 v160, 16, v78
    v_and_b32 v161, s49, v78
    v_pk_fma_f32 v[184:185], v[160:161], v[160:161], v[184:185]
    v_pk_add_f32 v[180:181], v[160:161], v[180:181]
    v_lshlrev_b32 v162, 16, v79
    v_and_b32 v163, s49, v79
    v_pk_fma_f32 v[186:187], v[162:163], v[162:163], v[186:187]
    v_pk_add_f32 v[182:183], v[162:163], v[182:183]
    s_waitcnt vmcnt(13)
    buffer_load_dwordx4 v7, s[12:15], s58 offen offset:3072 lds
    v_lshlrev_b32 v164, 16, v80
    v_and_b32 v165, s49, v80
    v_pk_fma_f32 v[184:185], v[164:165], v[164:165], v[184:185]
    v_pk_add_f32 v[180:181], v[164:165], v[180:181]
    v_lshlrev_b32 v166, 16, v81
    v_and_b32 v167, s49, v81
    v_pk_fma_f32 v[186:187], v[166:167], v[166:167], v[186:187]
    v_pk_add_f32 v[182:183], v[166:167], v[182:183]
    v_lshlrev_b32 v168, 16, v82
    v_and_b32 v169, s49, v82
    v_pk_fma_f32 v[184:185], v[168:169], v[168:169], v[184:185]
    v_pk_add_f32 v[180:181], v[168:169], v[180:181]
    v_lshlrev_b32 v170, 16, v83
    v_and_b32 v171, s49, v83
    v_pk_fma_f32 v[186:187], v[170:171], v[170:171], v[186:187]
    v_pk_add_f32 v[182:183], v[170:171], v[182:183]
    s_waitcnt vmcnt(13)
    s_add_u32 m0, s57, 16384
    s_add_u32 s58, s54, 110592
    buffer_load_dwordx4 v4, s[12:15], s58 offen lds
    v_lshlrev_b32 v172, 16, v84
    v_and_b32 v173, s49, v84
    v_pk_fma_f32 v[184:185], v[172:173], v[172:173], v[184:185]
    v_pk_add_f32 v[180:181], v[172:173], v[180:181]
    v_lshlrev_b32 v174, 16, v85
    v_and_b32 v175, s49, v85
    v_pk_fma_f32 v[186:187], v[174:175], v[174:175], v[186:187]
    v_pk_add_f32 v[182:183], v[174:175], v[182:183]
    v_lshlrev_b32 v176, 16, v86
    v_and_b32 v177, s49, v86
    v_pk_fma_f32 v[184:185], v[176:177], v[176:177], v[184:185]
    v_pk_add_f32 v[180:181], v[176:177], v[180:181]
    v_lshlrev_b32 v178, 16, v87
    v_and_b32 v179, s49, v87
    v_pk_fma_f32 v[186:187], v[178:179], v[178:179], v[186:187]
    v_pk_add_f32 v[182:183], v[178:179], v[182:183]
    v_pk_add_f32 v[180:181], v[180:181], v[182:183]
    v_pk_add_f32 v[184:185], v[184:185], v[186:187]
    v_add_f32 v180, v180, v181
    v_add_f32 v181, v184, v185
    s_nop 0
    v_add_f32_dpp v180, v180, v180 quad_perm:[1,0,3,2] row_mask:0xf bank_mask:0xf
    v_add_f32_dpp v181, v181, v181 quad_perm:[1,0,3,2] row_mask:0xf bank_mask:0xf
    s_nop 0
    v_add_f32_dpp v180, v180, v180 quad_perm:[2,3,0,1] row_mask:0xf bank_mask:0xf
    v_add_f32_dpp v181, v181, v181 quad_perm:[2,3,0,1] row_mask:0xf bank_mask:0xf
    s_nop 0
    v_add_f32_dpp v180, v180, v180 row_half_mirror row_mask:0xf bank_mask:0xf
    v_add_f32_dpp v181, v181, v181 row_half_mirror row_mask:0xf bank_mask:0xf
    v_mul_f32 v180, 0x3ae38e39, v180
    v_mul_f32 v181, 0x3ae38e39, v181
    v_fma_f32 v181, -v180, v180, v181
    v_max_f32 v181, 0, v181
    v_add_f32 v181, 0x3727c5ac, v181
    v_rsq_f32 v182, v181
    s_nop 0
    v_mul_f32 v183, -v180, v182
    v_pk_fma_f32 v[108:109], v[108:109], v[182:183], v[182:183] op_sel:[0,0,1] op_sel_hi:[1,0,1]
    v_cvt_pk_bf16_f32 v52, v108, v109
    v_pk_fma_f32 v[110:111], v[110:111], v[182:183], v[182:183] op_sel:[0,0,1] op_sel_hi:[1,0,1]
    v_cvt_pk_bf16_f32 v53, v110, v111
    v_pk_fma_f32 v[112:113], v[112:113], v[182:183], v[182:183] op_sel:[0,0,1] op_sel_hi:[1,0,1]
    v_cvt_pk_bf16_f32 v54, v112, v113
    v_pk_fma_f32 v[114:115], v[114:115], v[182:183], v[182:183] op_sel:[0,0,1] op_sel_hi:[1,0,1]
    v_cvt_pk_bf16_f32 v55, v114, v115
    ds_write_b128 v225, v[52:55] offset:0
    v_pk_fma_f32 v[116:117], v[116:117], v[182:183], v[182:183] op_sel:[0,0,1] op_sel_hi:[1,0,1]
    v_cvt_pk_bf16_f32 v56, v116, v117
    v_pk_fma_f32 v[118:119], v[118:119], v[182:183], v[182:183] op_sel:[0,0,1] op_sel_hi:[1,0,1]
    v_cvt_pk_bf16_f32 v57, v118, v119
    v_pk_fma_f32 v[120:121], v[120:121], v[182:183], v[182:183] op_sel:[0,0,1] op_sel_hi:[1,0,1]
    v_cvt_pk_bf16_f32 v58, v120, v121
    v_pk_fma_f32 v[122:123], v[122:123], v[182:183], v[182:183] op_sel:[0,0,1] op_sel_hi:[1,0,1]
    v_cvt_pk_bf16_f32 v59, v122, v123
    ds_write_b128 v225, v[56:59] offset:128
    s_add_u32 s54, s54, 221184
    buffer_load_dwordx4 v5, s[12:15], s58 offen offset:1024 lds
    v_pk_fma_f32 v[124:125], v[124:125], v[182:183], v[182:183] op_sel:[0,0,1] op_sel_hi:[1,0,1]
    v_cvt_pk_bf16_f32 v60, v124, v125
    v_pk_fma_f32 v[126:127], v[126:127], v[182:183], v[182:183] op_sel:[0,0,1] op_sel_hi:[1,0,1]
    v_cvt_pk_bf16_f32 v61, v126, v127
    v_pk_fma_f32 v[128:129], v[128:129], v[182:183], v[182:183] op_sel:[0,0,1] op_sel_hi:[1,0,1]
    v_cvt_pk_bf16_f32 v62, v128, v129
    v_pk_fma_f32 v[130:131], v[130:131], v[182:183], v[182:183] op_sel:[0,0,1] op_sel_hi:[1,0,1]
    v_cvt_pk_bf16_f32 v63, v130, v131
    ds_write_b128 v225, v[60:63] offset:256
    s_cmp_eq_u32 s54, s56
    s_cselect_b32 s54, s53, s54
    buffer_load_dwordx4 v6, s[12:15], s58 offen offset:2048 lds
    v_pk_fma_f32 v[132:133], v[132:133], v[182:183], v[182:183] op_sel:[0,0,1] op_sel_hi:[1,0,1]
    v_cvt_pk_bf16_f32 v64, v132, v133
    v_pk_fma_f32 v[134:135], v[134:135], v[182:183], v[182:183] op_sel:[0,0,1] op_sel_hi:[1,0,1]
    v_cvt_pk_bf16_f32 v65, v134, v135
    v_pk_fma_f32 v[136:137], v[136:137], v[182:183], v[182:183] op_sel:[0,0,1] op_sel_hi:[1,0,1]
    v_cvt_pk_bf16_f32 v66, v136, v137
    v_pk_fma_f32 v[138:139], v[138:139], v[182:183], v[182:183] op_sel:[0,0,1] op_sel_hi:[1,0,1]
    v_cvt_pk_bf16_f32 v67, v138, v139
    ds_write_b128 v225, v[64:67] offset:384
    v_pk_fma_f32 v[140:141], v[140:141], v[182:183], v[182:183] op_sel:[0,0,1] op_sel_hi:[1,0,1]
    v_cvt_pk_bf16_f32 v68, v140, v141
    v_pk_fma_f32 v[142:143], v[142:143], v[182:183], v[182:183] op_sel:[0,0,1] op_sel_hi:[1,0,1]
    v_cvt_pk_bf16_f32 v69, v142, v143
    v_pk_fma_f32 v[144:145], v[144:145], v[182:183], v[182:183] op_sel:[0,0,1] op_sel_hi:[1,0,1]
    v_cvt_pk_bf16_f32 v70, v144, v145
    v_pk_fma_f32 v[146:147], v[146:147], v[182:183], v[182:183] op_sel:[0,0,1] op_sel_hi:[1,0,1]
    v_cvt_pk_bf16_f32 v71, v146, v147
    ds_write_b128 v225, v[68:71] offset:512
    buffer_load_dwordx4 v7, s[12:15], s58 offen offset:3072 lds
    v_pk_fma_f32 v[148:149], v[148:149], v[182:183], v[182:183] op_sel:[0,0,1] op_sel_hi:[1,0,1]
    v_cvt_pk_bf16_f32 v72, v148, v149
    v_pk_fma_f32 v[150:151], v[150:151], v[182:183], v[182:183] op_sel:[0,0,1] op_sel_hi:[1,0,1]
    v_cvt_pk_bf16_f32 v73, v150, v151
    v_pk_fma_f32 v[152:153], v[152:153], v[182:183], v[182:183] op_sel:[0,0,1] op_sel_hi:[1,0,1]
    v_cvt_pk_bf16_f32 v74, v152, v153
    v_pk_fma_f32 v[154:155], v[154:155], v[182:183], v[182:183] op_sel:[0,0,1] op_sel_hi:[1,0,1]
    v_cvt_pk_bf16_f32 v75, v154, v155
    ds_write_b128 v225, v[72:75] offset:640
    s_add_u32 m0, s57, 32768
    s_mov_b32 s58, s54
    buffer_load_dwordx4 v4, s[12:15], s58 offen lds
    v_pk_fma_f32 v[156:157], v[156:157], v[182:183], v[182:183] op_sel:[0,0,1] op_sel_hi:[1,0,1]
    v_cvt_pk_bf16_f32 v76, v156, v157
    v_pk_fma_f32 v[158:159], v[158:159], v[182:183], v[182:183] op_sel:[0,0,1] op_sel_hi:[1,0,1]
    v_cvt_pk_bf16_f32 v77, v158, v159
    v_pk_fma_f32 v[160:161], v[160:161], v[182:183], v[182:183] op_sel:[0,0,1] op_sel_hi:[1,0,1]
    v_cvt_pk_bf16_f32 v78, v160, v161
    v_pk_fma_f32 v[162:163], v[162:163], v[182:183], v[182:183] op_sel:[0,0,1] op_sel_hi:[1,0,1]
    v_cvt_pk_bf16_f32 v79, v162, v163
    ds_write_b128 v225, v[76:79] offset:768
    v_pk_fma_f32 v[164:165], v[164:165], v[182:183], v[182:183] op_sel:[0,0,1] op_sel_hi:[1,0,1]
    v_cvt_pk_bf16_f32 v80, v164, v165
    v_pk_fma_f32 v[166:167], v[166:167], v[182:183], v[182:183] op_sel:[0,0,1] op_sel_hi:[1,0,1]
    v_cvt_pk_bf16_f32 v81, v166, v167
    v_pk_fma_f32 v[168:169], v[168:169], v[182:183], v[182:183] op_sel:[0,0,1] op_sel_hi:[1,0,1]
    v_cvt_pk_bf16_f32 v82, v168, v169
    v_pk_fma_f32 v[170:171], v[170:171], v[182:183], v[182:183] op_sel:[0,0,1] op_sel_hi:[1,0,1]
    v_cvt_pk_bf16_f32 v83, v170, v171
    ds_write_b128 v225, v[80:83] offset:896
    buffer_load_dwordx4 v5, s[12:15], s58 offen offset:1024 lds
    v_pk_fma_f32 v[172:173], v[172:173], v[182:183], v[182:183] op_sel:[0,0,1] op_sel_hi:[1,0,1]
    v_cvt_pk_bf16_f32 v84, v172, v173
    v_pk_fma_f32 v[174:175], v[174:175], v[182:183], v[182:183] op_sel:[0,0,1] op_sel_hi:[1,0,1]
    v_cvt_pk_bf16_f32 v85, v174, v175
    v_pk_fma_f32 v[176:177], v[176:177], v[182:183], v[182:183] op_sel:[0,0,1] op_sel_hi:[1,0,1]
    v_cvt_pk_bf16_f32 v86, v176, v177
    v_pk_fma_f32 v[178:179], v[178:179], v[182:183], v[182:183] op_sel:[0,0,1] op_sel_hi:[1,0,1]
    v_cvt_pk_bf16_f32 v87, v178, v179
    ds_write_b128 v225, v[84:87] offset:1024
    buffer_load_dwordx4 v6, s[12:15], s58 offen offset:2048 lds
    s_waitcnt vmcnt(19)
    v_lshlrev_b32 v108, 16, v88
    v_and_b32 v109, s49, v88
    v_pk_mul_f32 v[184:185], v[108:109], v[108:109]
    v_lshlrev_b32 v110, 16, v89
    v_and_b32 v111, s49, v89
    v_pk_mul_f32 v[186:187], v[110:111], v[110:111]
    s_waitcnt vmcnt(18)
    buffer_load_dwordx4 v7, s[12:15], s58 offen offset:3072 lds
    v_lshlrev_b32 v112, 16, v90
    v_and_b32 v113, s49, v90
    v_pk_fma_f32 v[184:185], v[112:113], v[112:113], v[184:185]
    v_pk_add_f32 v[180:181], v[112:113], v[108:109]
    v_lshlrev_b32 v114, 16, v91
    v_and_b32 v115, s49, v91
    v_pk_fma_f32 v[186:187], v[114:115], v[114:115], v[186:187]
    v_pk_add_f32 v[182:183], v[114:115], v[110:111]
    s_waitcnt vmcnt(18)
    s_add_u32 m0, s57, 49152
    s_add_u32 s58, s54, 110592
    buffer_load_dwordx4 v4, s[12:15], s58 offen lds
    v_lshlrev_b32 v116, 16, v92
    v_and_b32 v117, s49, v92
    v_pk_fma_f32 v[184:185], v[116:117], v[116:117], v[184:185]
    v_pk_add_f32 v[180:181], v[116:117], v[180:181]
    v_lshlrev_b32 v118, 16, v93
    v_and_b32 v119, s49, v93
    v_pk_fma_f32 v[186:187], v[118:119], v[118:119], v[186:187]
    v_pk_add_f32 v[182:183], v[118:119], v[182:183]
    s_waitcnt vmcnt(18)
    v_lshlrev_b32 v120, 16, v94
    v_and_b32 v121, s49, v94
    v_pk_fma_f32 v[184:185], v[120:121], v[120:121], v[184:185]
    v_pk_add_f32 v[180:181], v[120:121], v[180:181]
    v_lshlrev_b32 v122, 16, v95
    v_and_b32 v123, s49, v95
    v_pk_fma_f32 v[186:187], v[122:123], v[122:123], v[186:187]
    v_pk_add_f32 v[182:183], v[122:123], v[182:183]
    s_waitcnt vmcnt(17)
    s_add_u32 s54, s54, 221184
    buffer_load_dwordx4 v5, s[12:15], s58 offen offset:1024 lds
    v_lshlrev_b32 v124, 16, v96
    v_and_b32 v125, s49, v96
    v_pk_fma_f32 v[184:185], v[124:125], v[124:125], v[184:185]
    v_pk_add_f32 v[180:181], v[124:125], v[180:181]
    v_lshlrev_b32 v126, 16, v97
    v_and_b32 v127, s49, v97
    v_pk_fma_f32 v[186:187], v[126:127], v[126:127], v[186:187]
    v_pk_add_f32 v[182:183], v[126:127], v[182:183]
    s_waitcnt vmcnt(17)
    s_cmp_eq_u32 s54, s56
    s_cselect_b32 s54, s53, s54
    buffer_load_dwordx4 v6, s[12:15], s58 offen offset:2048 lds
    v_lshlrev_b32 v128, 16, v98
    v_and_b32 v129, s49, v98
    v_pk_fma_f32 v[184:185], v[128:129], v[128:129], v[184:185]
    v_pk_add_f32 v[180:181], v[128:129], v[180:181]
    v_lshlrev_b32 v130, 16, v99
    v_and_b32 v131, s49, v99
    v_pk_fma_f32 v[186:187], v[130:131], v[130:131], v[186:187]
    v_pk_add_f32 v[182:183], v[130:131], v[182:183]
    s_waitcnt vmcnt(17)
    v_lshlrev_b32 v132, 16, v100
    v_and_b32 v133, s49, v100
    v_pk_fma_f32 v[184:185], v[132:133], v[132:133], v[184:185]
    v_pk_add_f32 v[180:181], v[132:133], v[180:181]
    v_lshlrev_b32 v134, 16, v101
    v_and_b32 v135, s49, v101
    v_pk_fma_f32 v[186:187], v[134:135], v[134:135], v[186:187]
    v_pk_add_f32 v[182:183], v[134:135], v[182:183]
    s_waitcnt vmcnt(16)
    buffer_load_dwordx4 v7, s[12:15], s58 offen offset:3072 lds
    v_lshlrev_b32 v136, 16, v102
    v_and_b32 v137, s49, v102
    v_pk_fma_f32 v[184:185], v[136:137], v[136:137], v[184:185]
    v_pk_add_f32 v[180:181], v[136:137], v[180:181]
    v_lshlrev_b32 v138, 16, v103
    v_and_b32 v139, s49, v103
    v_pk_fma_f32 v[186:187], v[138:139], v[138:139], v[186:187]
    v_pk_add_f32 v[182:183], v[138:139], v[182:183]
    s_waitcnt vmcnt(16)
    s_lshl_b32 s52, s2, 2
    s_add_u32 s52, s52, s3
    s_mul_i32 s52, s52, 6
    v_min_u32 v237, 5, v0
    v_add_u32 v237, s52, v237
    v_lshlrev_b32 v237, 7, v237
    buffer_load_dword v253, v237, s[16:19], 0 offen
    v_lshlrev_b32 v140, 16, v104
    v_and_b32 v141, s49, v104
    v_pk_fma_f32 v[184:185], v[140:141], v[140:141], v[184:185]
    v_pk_add_f32 v[180:181], v[140:141], v[180:181]
    v_lshlrev_b32 v142, 16, v105
    v_and_b32 v143, s49, v105
    v_pk_fma_f32 v[186:187], v[142:143], v[142:143], v[186:187]
    v_pk_add_f32 v[182:183], v[142:143], v[182:183]
    v_pk_add_f32 v[180:181], v[180:181], v[182:183]
    v_pk_add_f32 v[184:185], v[184:185], v[186:187]
    v_add_f32 v180, v180, v181
    v_add_f32 v181, v184, v185
    s_nop 0
    v_add_f32_dpp v180, v180, v180 quad_perm:[1,0,3,2] row_mask:0xf bank_mask:0xf
    v_add_f32_dpp v181, v181, v181 quad_perm:[1,0,3,2] row_mask:0xf bank_mask:0xf
    s_nop 0
    v_add_f32_dpp v180, v180, v180 quad_perm:[2,3,0,1] row_mask:0xf bank_mask:0xf
    v_add_f32_dpp v181, v181, v181 quad_perm:[2,3,0,1] row_mask:0xf bank_mask:0xf
    s_nop 0
    v_add_f32_dpp v180, v180, v180 row_half_mirror row_mask:0xf bank_mask:0xf
    v_add_f32_dpp v181, v181, v181 row_half_mirror row_mask:0xf bank_mask:0xf
    s_nop 0
    v_add_f32_dpp v180, v180, v180 row_mirror row_mask:0xf bank_mask:0xf
    v_add_f32_dpp v181, v181, v181 row_mirror row_mask:0xf bank_mask:0xf
    v_mul_f32 v180, 0x3ae38e39, v180
    v_mul_f32 v181, 0x3ae38e39, v181
    v_fma_f32 v181, -v180, v180, v181
    v_max_f32 v181, 0, v181
    v_add_f32 v181, 0x3727c5ac, v181
    v_rsq_f32 v182, v181
    s_nop 0
    v_mul_f32 v183, -v180, v182
    v_pk_fma_f32 v[108:109], v[108:109], v[182:183], v[182:183] op_sel:[0,0,1] op_sel_hi:[1,0,1]
    v_cvt_pk_bf16_f32 v88, v108, v109
    v_pk_fma_f32 v[110:111], v[110:111], v[182:183], v[182:183] op_sel:[0,0,1] op_sel_hi:[1,0,1]
    v_cvt_pk_bf16_f32 v89, v110, v111
    ds_write_b64 v226, v[88:89] offset:0
    v_pk_fma_f32 v[112:113], v[112:113], v[182:183], v[182:183] op_sel:[0,0,1] op_sel_hi:[1,0,1]
    v_cvt_pk_bf16_f32 v90, v112, v113
    v_pk_fma_f32 v[114:115], v[114:115], v[182:183], v[182:183] op_sel:[0,0,1] op_sel_hi:[1,0,1]
    v_cvt_pk_bf16_f32 v91, v114, v115
    ds_write_b64 v226, v[90:91] offset:128
    v_pk_fma_f32 v[116:117], v[116:117], v[182:183], v[182:183] op_sel:[0,0,1] op_sel_hi:[1,0,1]
    v_cvt_pk_bf16_f32 v92, v116, v117
    v_pk_fma_f32 v[118:119], v[118:119], v[182:183], v[182:183] op_sel:[0,0,1] op_sel_hi:[1,0,1]
    v_cvt_pk_bf16_f32 v93, v118, v119
    ds_write_b64 v226, v[92:93] offset:256
    v_pk_fma_f32 v[120:121], v[120:121], v[182:183], v[182:183] op_sel:[0,0,1] op_sel_hi:[1,0,1]
    v_cvt_pk_bf16_f32 v94, v120, v121
    v_pk_fma_f32 v[122:123], v[122:123], v[182:183], v[182:183] op_sel:[0,0,1] op_sel_hi:[1,0,1]
    v_cvt_pk_bf16_f32 v95, v122, v123
    ds_write_b64 v226, v[94:95] offset:384
    v_pk_fma_f32 v[124:125], v[124:125], v[182:183], v[182:183] op_sel:[0,0,1] op_sel_hi:[1,0,1]
    v_cvt_pk_bf16_f32 v96, v124, v125
    v_pk_fma_f32 v[126:127], v[126:127], v[182:183], v[182:183] op_sel:[0,0,1] op_sel_hi:[1,0,1]
    v_cvt_pk_bf16_f32 v97, v126, v127
    ds_write_b64 v226, v[96:97] offset:512
    s_getpc_b64 s[62:63]
    L_pc1:
    s_lshr_b32 s6, s2, 3
    s_lshl_b32 s6, s6, 2
    s_add_u32 s6, s6, s3
    s_lshl_b32 s6, s6, 7
    s_add_u32 s6, s6, 8192
    v_mov_b32 v238, s6
    global_load_dword v253, v238, s[62:63]
    v_pk_fma_f32 v[128:129], v[128:129], v[182:183], v[182:183] op_sel:[0,0,1] op_sel_hi:[1,0,1]
    v_cvt_pk_bf16_f32 v98, v128, v129
    v_pk_fma_f32 v[130:131], v[130:131], v[182:183], v[182:183] op_sel:[0,0,1] op_sel_hi:[1,0,1]
    v_cvt_pk_bf16_f32 v99, v130, v131
    ds_write_b64 v226, v[98:99] offset:640
    v_pk_fma_f32 v[132:133], v[132:133], v[182:183], v[182:183] op_sel:[0,0,1] op_sel_hi:[1,0,1]
    v_cvt_pk_bf16_f32 v100, v132, v133
    v_pk_fma_f32 v[134:135], v[134:135], v[182:183], v[182:183] op_sel:[0,0,1] op_sel_hi:[1,0,1]
    v_cvt_pk_bf16_f32 v101, v134, v135
    ds_write_b64 v226, v[100:101] offset:768
    v_pk_fma_f32 v[136:137], v[136:137], v[182:183], v[182:183] op_sel:[0,0,1] op_sel_hi:[1,0,1]
    v_cvt_pk_bf16_f32 v102, v136, v137
    v_pk_fma_f32 v[138:139], v[138:139], v[182:183], v[182:183] op_sel:[0,0,1] op_sel_hi:[1,0,1]
    v_cvt_pk_bf16_f32 v103, v138, v139
    ds_write_b64 v226, v[102:103] offset:896
    v_pk_fma_f32 v[140:141], v[140:141], v[182:183], v[182:183] op_sel:[0,0,1] op_sel_hi:[1,0,1]
    v_cvt_pk_bf16_f32 v104, v140, v141
    v_pk_fma_f32 v[142:143], v[142:143], v[182:183], v[182:183] op_sel:[0,0,1] op_sel_hi:[1,0,1]
    v_cvt_pk_bf16_f32 v105, v142, v143
    ds_write_b64 v226, v[104:105] offset:1024
    s_mov_b32 s62, 4096
    buffer_load_dword v253, off, s[28:31], s62
    s_lshl_b32 s52, s3, 10
    s_waitcnt vmcnt(15)
    s_waitcnt lgkmcnt(0)
    s_barrier
    ds_read_b64_tr_b16 v[20:21], v13 offset:5120
    ds_read_b64_tr_b16 v[22:23], v13 offset:7680
    ds_read_b128 v[32:35], v15 offset:0
    ds_read_b128 v[36:39], v15 offset:18944
    ds_read_b128 v[40:43], v15 offset:37888
    ds_read_b128 v[44:47], v15 offset:56832
    ds_read_b128 v[48:51], v3 offset:0
    ds_read_b64_tr_b16 v[24:25], v13 offset:10240
    ds_read_b64_tr_b16 v[26:27], v13 offset:12800
    ds_read_b64_tr_b16 v[16:17], v13 offset:0
    ds_read_b64_tr_b16 v[18:19], v13 offset:2560
    ds_read_b64_tr_b16 v[28:29], v14 offset:0
    ds_read_b64_tr_b16 v[30:31], v223 offset:0
    s_mov_b32 s46, 256
    s_mov_b32 s47, 0x20000
    s_or_b32 s6, s5, s3
    s_cbranch_scc1 L_ann_2
    s_lshl_b32 s6, s4, 2
    v_mov_b32 v232, 1
    s_mov_b64 exec, 1
    buffer_store_dword v232, off, s[44:47], s6 sc1
    s_mov_b64 exec, -1
    L_ann_2:
    s_waitcnt vmcnt(11) lgkmcnt(0)
    s_barrier
    v_mfma_f32_16x16x32_bf16 v[116:119], v[20:23], v[32:35], 0
    ds_read_b64_tr_b16 v[56:57], v13 offset:21504
    ds_read_b64_tr_b16 v[58:59], v13 offset:24064
    v_mfma_f32_16x16x32_bf16 v[120:123], v[20:23], v[36:39], 0
    ds_read_b128 v[68:71], v15 offset:64
    ds_read_b128 v[72:75], v15 offset:19008
    v_mfma_f32_16x16x32_bf16 v[124:127], v[20:23], v[40:43], 0
    s_add_u32 m0, s57, 0
    s_mov_b32 s58, s54
    ds_read_b128 v[76:79], v15 offset:37952
    v_mfma_f32_16x16x32_bf16 v[128:131], v[20:23], v[44:47], 0
    buffer_load_dwordx4 v4, s[12:15], s58 offen lds
    v_mfma_f32_16x16x32_bf16 v[132:135], v[20:23], v[48:51], 0
    ds_read_b128 v[80:83], v15 offset:56896
    ds_read_b128 v[84:87], v3 offset:64
    v_mfma_f32_16x16x32_bf16 v[136:139], v[28:31], v[32:35], 0
    ds_read_b64_tr_b16 v[60:61], v13 offset:26624
    ds_read_b64_tr_b16 v[62:63], v13 offset:29184
    v_mfma_f32_16x16x32_bf16 v[140:143], v[28:31], v[36:39], 0
    ds_read_b64_tr_b16 v[52:53], v13 offset:16384
    ds_read_b64_tr_b16 v[54:55], v13 offset:18944
    v_mfma_f32_16x16x32_bf16 v[144:147], v[28:31], v[40:43], 0
    buffer_load_dwordx4 v5, s[12:15], s58 offen offset:1024 lds
    v_mfma_f32_16x16x32_bf16 v[148:151], v[28:31], v[44:47], 0
    ds_read_b64_tr_b16 v[64:65], v14 offset:16384
    ds_read_b64_tr_b16 v[66:67], v223 offset:16384
    v_mfma_f32_16x16x32_bf16 v[152:155], v[28:31], v[48:51], 0
    s_add_u32 s55, s55, 128
    s_cmp_eq_u32 s55, 1152
    s_cselect_b32 s55, 0, s55
    v_add_u32 v15, s55, v222
    v_mfma_f32_16x16x32_bf16 v[100:103], v[16:19], v[36:39], 0
    v_add_u32 v3, 75776, v15
    s_mov_b32 s22, 5308416
    v_mfma_f32_16x16x32_bf16 v[104:107], v[16:19], v[40:43], 0
    buffer_load_dwordx4 v6, s[12:15], s58 offen offset:2048 lds
    v_mfma_f32_16x16x32_bf16 v[108:111], v[16:19], v[44:47], 0
    s_mov_b32 s23, 0x20000
    s_mov_b32 s26, 5308416
    v_mfma_f32_16x16x32_bf16 v[112:115], v[16:19], v[48:51], 0
    s_mov_b32 s27, 0x20000
    s_mov_b32 s34, 2359296
    v_mfma_f32_16x16x32_bf16 v[156:159], v[32:35], v[24:27], 0
    s_mov_b32 s35, 0x20000
    s_mov_b32 s38, 9216
    v_mfma_f32_16x16x32_bf16 v[160:163], v[36:39], v[24:27], 0
    buffer_load_dwordx4 v7, s[12:15], s58 offen offset:3072 lds
    v_mfma_f32_16x16x32_bf16 v[164:167], v[40:43], v[24:27], 0
    s_waitcnt vmcnt(11) lgkmcnt(0)
    s_barrier
    v_mfma_f32_16x16x32_bf16 v[168:171], v[44:47], v[24:27], 0
    s_mov_b32 s39, 0x20000
    s_mov_b32 s42, 1152
    v_mfma_f32_16x16x32_bf16 v[172:175], v[48:51], v[24:27], 0
    s_mov_b32 s43, 0x20000
    v_and_b32 v232, 3, v240
    v_bfe_u32 v233, v240, 4, 1
    v_mfma_f32_16x16x32_bf16 v[116:119], v[56:59], v[68:71], v[116:119]
    ds_read_b64_tr_b16 v[20:21], v13 offset:37888
    ds_read_b64_tr_b16 v[22:23], v13 offset:40448
    v_mfma_f32_16x16x32_bf16 v[120:123], v[56:59], v[72:75], v[120:123]
    ds_read_b128 v[32:35], v15 offset:0
    ds_read_b128 v[36:39], v15 offset:18944
    v_mfma_f32_16x16x32_bf16 v[124:127], v[56:59], v[76:79], v[124:127]
    s_add_u32 m0, s57, 16384
    s_add_u32 s58, s54, 110592
    ds_read_b128 v[40:43], v15 offset:37888
    v_mfma_f32_16x16x32_bf16 v[128:131], v[56:59], v[80:83], v[128:131]
    buffer_load_dwordx4 v4, s[12:15], s58 offen lds
    v_mfma_f32_16x16x32_bf16 v[132:135], v[56:59], v[84:87], v[132:135]
    ds_read_b128 v[44:47], v15 offset:56832
    ds_read_b128 v[48:51], v3 offset:0
    v_mfma_f32_16x16x32_bf16 v[136:139], v[64:67], v[68:71], v[136:139]
    ds_read_b64_tr_b16 v[24:25], v13 offset:43008
    ds_read_b64_tr_b16 v[26:27], v13 offset:45568
    v_mfma_f32_16x16x32_bf16 v[140:143], v[64:67], v[72:75], v[140:143]
    s_add_u32 s54, s54, 221184
    ds_read_b64_tr_b16 v[16:17], v13 offset:32768
    ds_read_b64_tr_b16 v[18:19], v13 offset:35328
    v_mfma_f32_16x16x32_bf16 v[144:147], v[64:67], v[76:79], v[144:147]
    buffer_load_dwordx4 v5, s[12:15], s58 offen offset:1024 lds
    v_mfma_f32_16x16x32_bf16 v[148:151], v[64:67], v[80:83], v[148:151]
    ds_read_b64_tr_b16 v[28:29], v14 offset:32768
    ds_read_b64_tr_b16 v[30:31], v223 offset:32768
    v_mfma_f32_16x16x32_bf16 v[152:155], v[64:67], v[84:87], v[152:155]
    v_bfe_u32 v234, v240, 2, 2
    v_mfma_f32_16x16x32_bf16 v[100:103], v[52:55], v[72:75], v[100:103]
    s_cmp_eq_u32 s54, s56
    s_cselect_b32 s54, s53, s54
    v_lshrrev_b32 v235, 5, v240
    v_lshl_add_u32 v236, v233, 2, v232
    v_mfma_f32_16x16x32_bf16 v[104:107], v[52:55], v[76:79], v[104:107]
    buffer_load_dwordx4 v6, s[12:15], s58 offen offset:2048 lds
    v_mfma_f32_16x16x32_bf16 v[108:111], v[52:55], v[80:83], v[108:111]
    v_lshl_add_u32 v236, v234, 3, v236
    v_lshrrev_b32 v237, 1, v234
    v_mfma_f32_16x16x32_bf16 v[112:115], v[52:55], v[84:87], v[112:115]
    v_lshl_add_u32 v236, v237, 2, v236
    v_mfma_f32_16x16x32_bf16 v[156:159], v[68:71], v[60:63], v[156:159]
    v_mad_u32_u24 v237, v235, 36, v236
    v_mad_u32_u24 v196, v237, s60, v244
    v_mfma_f32_16x16x32_bf16 v[160:163], v[72:75], v[60:63], v[160:163]
    buffer_load_dwordx4 v7, s[12:15], s58 offen offset:3072 lds
    v_mfma_f32_16x16x32_bf16 v[164:167], v[76:79], v[60:63], v[164:167]
    s_waitcnt vmcnt(11) lgkmcnt(0)
    s_barrier
    v_mfma_f32_16x16x32_bf16 v[168:171], v[80:83], v[60:63], v[168:171]
    v_cmp_eq_u32 vcc, 0, v235
    v_lshl_add_u32 v237, v234, 1, v233
    v_mfma_f32_16x16x32_bf16 v[172:175], v[84:87], v[60:63], v[172:175]
    v_lshl_add_u32 v237, v235, 3, v237
    v_mad_u32_u24 v237, v237, 36, v232
    v_mfma_f32_16x16x32_bf16 v[116:119], v[20:23], v[32:35], v[116:119]
    ds_read_b64_tr_b16 v[56:57], v13 offset:54272
    ds_read_b64_tr_b16 v[58:59], v13 offset:56832
    v_mfma_f32_16x16x32_bf16 v[120:123], v[20:23], v[36:39], v[120:123]
    ds_read_b128 v[68:71], v15 offset:64
    ds_read_b128 v[72:75], v15 offset:19008
    v_mfma_f32_16x16x32_bf16 v[124:127], v[20:23], v[40:43], v[124:127]
    s_add_u32 m0, s57, 32768
    s_mov_b32 s58, s54
    ds_read_b128 v[76:79], v15 offset:37952
    v_mfma_f32_16x16x32_bf16 v[128:131], v[20:23], v[44:47], v[128:131]
    buffer_load_dwordx4 v4, s[12:15], s58 offen lds
    v_mfma_f32_16x16x32_bf16 v[132:135], v[20:23], v[48:51], v[132:135]
    ds_read_b128 v[80:83], v15 offset:56896
    ds_read_b128 v[84:87], v3 offset:64
    v_mfma_f32_16x16x32_bf16 v[136:139], v[28:31], v[32:35], v[136:139]
    ds_read_b64_tr_b16 v[60:61], v13 offset:59392
    ds_read_b64_tr_b16 v[62:63], v13 offset:61952
    v_mfma_f32_16x16x32_bf16 v[140:143], v[28:31], v[36:39], v[140:143]
    ds_read_b64_tr_b16 v[52:53], v13 offset:49152
    ds_read_b64_tr_b16 v[54:55], v13 offset:51712
    v_mfma_f32_16x16x32_bf16 v[144:147], v[28:31], v[40:43], v[144:147]
    buffer_load_dwordx4 v5, s[12:15], s58 offen offset:1024 lds
    v_mfma_f32_16x16x32_bf16 v[148:151], v[28:31], v[44:47], v[148:151]
    ds_read_b64_tr_b16 v[64:65], v14 offset:49152
    ds_read_b64_tr_b16 v[66:67], v223 offset:49152
    v_mfma_f32_16x16x32_bf16 v[152:155], v[28:31], v[48:51], v[152:155]
    s_add_u32 s55, s55, 128
    s_cmp_eq_u32 s55, 1152
    s_cselect_b32 s55, 0, s55
    v_add_u32 v15, s55, v222
    v_mfma_f32_16x16x32_bf16 v[100:103], v[16:19], v[36:39], v[100:103]
    v_add_u32 v3, 75776, v15
    v_subrev_u32 v237, 272, v237
    v_mfma_f32_16x16x32_bf16 v[104:107], v[16:19], v[40:43], v[104:107]
    buffer_load_dwordx4 v6, s[12:15], s58 offen offset:2048 lds
    v_mfma_f32_16x16x32_bf16 v[108:111], v[16:19], v[44:47], v[108:111]
    v_add_u32 v236, 540, v236
    v_cndmask_b32 v237, v237, v236, vcc
    v_mfma_f32_16x16x32_bf16 v[112:115], v[16:19], v[48:51], v[112:115]
    v_mad_u32_u24 v200, v237, s60, v244
    v_and_b32 v232, 3, v241
    v_mfma_f32_16x16x32_bf16 v[156:159], v[32:35], v[24:27], v[156:159]
    v_bfe_u32 v233, v241, 4, 1
    v_bfe_u32 v234, v241, 2, 2
    v_mfma_f32_16x16x32_bf16 v[160:163], v[36:39], v[24:27], v[160:163]
    buffer_load_dwordx4 v7, s[12:15], s58 offen offset:3072 lds
    v_mfma_f32_16x16x32_bf16 v[164:167], v[40:43], v[24:27], v[164:167]
    s_waitcnt vmcnt(8) lgkmcnt(0)
    s_barrier
    v_mfma_f32_16x16x32_bf16 v[168:171], v[44:47], v[24:27], v[168:171]
    v_lshrrev_b32 v235, 5, v241
    v_lshl_add_u32 v236, v233, 2, v232
    v_mfma_f32_16x16x32_bf16 v[172:175], v[48:51], v[24:27], v[172:175]
    v_lshl_add_u32 v236, v234, 3, v236
    v_lshrrev_b32 v237, 1, v234
    v_lshl_add_u32 v236, v237, 2, v236
    v_mfma_f32_16x16x32_bf16 v[116:119], v[56:59], v[68:71], v[116:119]
    ds_read_b64_tr_b16 v[20:21], v13 offset:5120
    ds_read_b64_tr_b16 v[22:23], v13 offset:7680
    v_mfma_f32_16x16x32_bf16 v[120:123], v[56:59], v[72:75], v[120:123]
    ds_read_b128 v[32:35], v15 offset:0
    ds_read_b128 v[36:39], v15 offset:18944
    v_mfma_f32_16x16x32_bf16 v[124:127], v[56:59], v[76:79], v[124:127]
    s_add_u32 m0, s57, 49152
    s_add_u32 s58, s54, 110592
    ds_read_b128 v[40:43], v15 offset:37888
    v_mfma_f32_16x16x32_bf16 v[128:131], v[56:59], v[80:83], v[128:131]
    buffer_load_dwordx4 v4, s[12:15], s58 offen lds
    v_mfma_f32_16x16x32_bf16 v[132:135], v[56:59], v[84:87], v[132:135]
    ds_read_b128 v[44:47], v15 offset:56832
    ds_read_b128 v[48:51], v3 offset:0
    v_mfma_f32_16x16x32_bf16 v[136:139], v[64:67], v[68:71], v[136:139]
    ds_read_b64_tr_b16 v[24:25], v13 offset:10240
    ds_read_b64_tr_b16 v[26:27], v13 offset:12800
    v_mfma_f32_16x16x32_bf16 v[140:143], v[64:67], v[72:75], v[140:143]
    s_add_u32 s54, s54, 221184
    ds_read_b64_tr_b16 v[16:17], v13 offset:0
    ds_read_b64_tr_b16 v[18:19], v13 offset:2560
    v_mfma_f32_16x16x32_bf16 v[144:147], v[64:67], v[76:79], v[144:147]
    buffer_load_dwordx4 v5, s[12:15], s58 offen offset:1024 lds
    v_mfma_f32_16x16x32_bf16 v[148:151], v[64:67], v[80:83], v[148:151]
    ds_read_b64_tr_b16 v[28:29], v14 offset:0
    ds_read_b64_tr_b16 v[30:31], v223 offset:0
    v_mfma_f32_16x16x32_bf16 v[152:155], v[64:67], v[84:87], v[152:155]
    v_mad_u32_u24 v237, v235, 36, v236
    v_mfma_f32_16x16x32_bf16 v[100:103], v[52:55], v[72:75], v[100:103]
    s_cmp_eq_u32 s54, s56
    s_cselect_b32 s54, s53, s54
    v_mad_u32_u24 v197, v237, s60, v245
    v_cmp_eq_u32 vcc, 0, v235
    v_mfma_f32_16x16x32_bf16 v[104:107], v[52:55], v[76:79], v[104:107]
    buffer_load_dwordx4 v6, s[12:15], s58 offen offset:2048 lds
    v_mfma_f32_16x16x32_bf16 v[108:111], v[52:55], v[80:83], v[108:111]
    v_lshl_add_u32 v237, v234, 1, v233
    v_lshl_add_u32 v237, v235, 3, v237
    v_mfma_f32_16x16x32_bf16 v[112:115], v[52:55], v[84:87], v[112:115]
    v_mad_u32_u24 v237, v237, 36, v232
    v_mfma_f32_16x16x32_bf16 v[156:159], v[68:71], v[60:63], v[156:159]
    v_subrev_u32 v237, 272, v237
    v_add_u32 v236, 540, v236
    v_mfma_f32_16x16x32_bf16 v[160:163], v[72:75], v[60:63], v[160:163]
    buffer_load_dwordx4 v7, s[12:15], s58 offen offset:3072 lds
    v_mfma_f32_16x16x32_bf16 v[164:167], v[76:79], v[60:63], v[164:167]
    s_waitcnt vmcnt(8) lgkmcnt(0)
    s_barrier
    v_mfma_f32_16x16x32_bf16 v[168:171], v[80:83], v[60:63], v[168:171]
    v_cndmask_b32 v237, v237, v236, vcc
    v_mad_u32_u24 v201, v237, s60, v245
    v_mfma_f32_16x16x32_bf16 v[172:175], v[84:87], v[60:63], v[172:175]
    v_and_b32 v232, 3, v242
    v_bfe_u32 v233, v242, 4, 1
    v_mfma_f32_16x16x32_bf16 v[116:119], v[20:23], v[32:35], v[116:119]
    ds_read_b64_tr_b16 v[56:57], v13 offset:21504
    ds_read_b64_tr_b16 v[58:59], v13 offset:24064
    v_mfma_f32_16x16x32_bf16 v[120:123], v[20:23], v[36:39], v[120:123]
    ds_read_b128 v[68:71], v15 offset:64
    ds_read_b128 v[72:75], v15 offset:19008
    v_mfma_f32_16x16x32_bf16 v[124:127], v[20:23], v[40:43], v[124:127]
    s_add_u32 m0, s57, 0
    s_mov_b32 s58, s54
    ds_read_b128 v[76:79], v15 offset:37952
    v_mfma_f32_16x16x32_bf16 v[128:131], v[20:23], v[44:47], v[128:131]
    buffer_load_dwordx4 v4, s[12:15], s58 offen lds
    v_mfma_f32_16x16x32_bf16 v[132:135], v[20:23], v[48:51], v[132:135]
    ds_read_b128 v[80:83], v15 offset:56896
    ds_read_b128 v[84:87], v3 offset:64
    v_mfma_f32_16x16x32_bf16 v[136:139], v[28:31], v[32:35], v[136:139]
    ds_read_b64_tr_b16 v[60:61], v13 offset:26624
    ds_read_b64_tr_b16 v[62:63], v13 offset:29184
    v_mfma_f32_16x16x32_bf16 v[140:143], v[28:31], v[36:39], v[140:143]
    ds_read_b64_tr_b16 v[52:53], v13 offset:16384
    ds_read_b64_tr_b16 v[54:55], v13 offset:18944
    v_mfma_f32_16x16x32_bf16 v[144:147], v[28:31], v[40:43], v[144:147]
    buffer_load_dwordx4 v5, s[12:15], s58 offen offset:1024 lds
    v_mfma_f32_16x16x32_bf16 v[148:151], v[28:31], v[44:47], v[148:151]
    ds_read_b64_tr_b16 v[64:65], v14 offset:16384
    ds_read_b64_tr_b16 v[66:67], v223 offset:16384
    v_mfma_f32_16x16x32_bf16 v[152:155], v[28:31], v[48:51], v[152:155]
    s_add_u32 s55, s55, 128
    s_cmp_eq_u32 s55, 1152
    s_cselect_b32 s55, 0, s55
    v_add_u32 v15, s55, v222
    v_mfma_f32_16x16x32_bf16 v[100:103], v[16:19], v[36:39], v[100:103]
    v_add_u32 v3, 75776, v15
    v_bfe_u32 v234, v242, 2, 2
    v_mfma_f32_16x16x32_bf16 v[104:107], v[16:19], v[40:43], v[104:107]
    buffer_load_dwordx4 v6, s[12:15], s58 offen offset:2048 lds
    v_mfma_f32_16x16x32_bf16 v[108:111], v[16:19], v[44:47], v[108:111]
    v_lshrrev_b32 v235, 5, v242
    v_lshl_add_u32 v236, v233, 2, v232
    v_mfma_f32_16x16x32_bf16 v[112:115], v[16:19], v[48:51], v[112:115]
    v_lshl_add_u32 v236, v234, 3, v236
    v_lshrrev_b32 v237, 1, v234
    v_mfma_f32_16x16x32_bf16 v[156:159], v[32:35], v[24:27], v[156:159]
    v_lshl_add_u32 v236, v237, 2, v236
    v_mad_u32_u24 v237, v235, 36, v236
    v_mfma_f32_16x16x32_bf16 v[160:163], v[36:39], v[24:27], v[160:163]
    buffer_load_dwordx4 v7, s[12:15], s58 offen offset:3072 lds
    v_mfma_f32_16x16x32_bf16 v[164:167], v[40:43], v[24:27], v[164:167]
    s_waitcnt vmcnt(8) lgkmcnt(0)
    s_barrier
    v_mfma_f32_16x16x32_bf16 v[168:171], v[44:47], v[24:27], v[168:171]
    v_mad_u32_u24 v198, v237, s60, v246
    v_cmp_eq_u32 vcc, 0, v235
    v_mfma_f32_16x16x32_bf16 v[172:175], v[48:51], v[24:27], v[172:175]
    v_lshl_add_u32 v237, v234, 1, v233
    v_lshl_add_u32 v237, v235, 3, v237
    v_mad_u32_u24 v237, v237, 36, v232
    v_mfma_f32_16x16x32_bf16 v[116:119], v[56:59], v[68:71], v[116:119]
    ds_read_b64_tr_b16 v[20:21], v13 offset:37888
    ds_read_b64_tr_b16 v[22:23], v13 offset:40448
    v_mfma_f32_16x16x32_bf16 v[120:123], v[56:59], v[72:75], v[120:123]
    ds_read_b128 v[32:35], v15 offset:0
    ds_read_b128 v[36:39], v15 offset:18944
    v_mfma_f32_16x16x32_bf16 v[124:127], v[56:59], v[76:79], v[124:127]
    s_add_u32 m0, s57, 16384
    s_add_u32 s58, s54, 110592
    ds_read_b128 v[40:43], v15 offset:37888
    v_mfma_f32_16x16x32_bf16 v[128:131], v[56:59], v[80:83], v[128:131]
    buffer_load_dwordx4 v4, s[12:15], s58 offen lds
    v_mfma_f32_16x16x32_bf16 v[132:135], v[56:59], v[84:87], v[132:135]
    ds_read_b128 v[44:47], v15 offset:56832
    ds_read_b128 v[48:51], v3 offset:0
    v_mfma_f32_16x16x32_bf16 v[136:139], v[64:67], v[68:71], v[136:139]
    ds_read_b64_tr_b16 v[24:25], v13 offset:43008
    ds_read_b64_tr_b16 v[26:27], v13 offset:45568
    v_mfma_f32_16x16x32_bf16 v[140:143], v[64:67], v[72:75], v[140:143]
    s_add_u32 s54, s54, 221184
    ds_read_b64_tr_b16 v[16:17], v13 offset:32768
    ds_read_b64_tr_b16 v[18:19], v13 offset:35328
    v_mfma_f32_16x16x32_bf16 v[144:147], v[64:67], v[76:79], v[144:147]
    buffer_load_dwordx4 v5, s[12:15], s58 offen offset:1024 lds
    v_mfma_f32_16x16x32_bf16 v[148:151], v[64:67], v[80:83], v[148:151]
    ds_read_b64_tr_b16 v[28:29], v14 offset:32768
    ds_read_b64_tr_b16 v[30:31], v223 offset:32768
    v_mfma_f32_16x16x32_bf16 v[152:155], v[64:67], v[84:87], v[152:155]
    v_subrev_u32 v237, 272, v237
    v_mfma_f32_16x16x32_bf16 v[100:103], v[52:55], v[72:75], v[100:103]
    s_cmp_eq_u32 s54, s56
    s_cselect_b32 s54, s53, s54
    v_add_u32 v236, 540, v236
    v_cndmask_b32 v237, v237, v236, vcc
    v_mfma_f32_16x16x32_bf16 v[104:107], v[52:55], v[76:79], v[104:107]
    buffer_load_dwordx4 v6, s[12:15], s58 offen offset:2048 lds
    v_mfma_f32_16x16x32_bf16 v[108:111], v[52:55], v[80:83], v[108:111]
    v_mad_u32_u24 v202, v237, s60, v246
    v_and_b32 v232, 3, v243
    v_mfma_f32_16x16x32_bf16 v[112:115], v[52:55], v[84:87], v[112:115]
    v_bfe_u32 v233, v243, 4, 1
    v_mfma_f32_16x16x32_bf16 v[156:159], v[68:71], v[60:63], v[156:159]
    v_bfe_u32 v234, v243, 2, 2
    v_lshrrev_b32 v235, 5, v243
    v_mfma_f32_16x16x32_bf16 v[160:163], v[72:75], v[60:63], v[160:163]
    buffer_load_dwordx4 v7, s[12:15], s58 offen offset:3072 lds
    v_mfma_f32_16x16x32_bf16 v[164:167], v[76:79], v[60:63], v[164:167]
    s_waitcnt vmcnt(8) lgkmcnt(0)
    s_barrier
    v_mfma_f32_16x16x32_bf16 v[168:171], v[80:83], v[60:63], v[168:171]
    v_lshl_add_u32 v236, v233, 2, v232
    v_lshl_add_u32 v236, v234, 3, v236
    v_mfma_f32_16x16x32_bf16 v[172:175], v[84:87], v[60:63], v[172:175]
    v_lshrrev_b32 v237, 1, v234
    v_lshl_add_u32 v236, v237, 2, v236
    v_mfma_f32_16x16x32_bf16 v[116:119], v[20:23], v[32:35], v[116:119]
    ds_read_b64_tr_b16 v[56:57], v13 offset:54272
    ds_read_b64_tr_b16 v[58:59], v13 offset:56832
    v_mfma_f32_16x16x32_bf16 v[120:123], v[20:23], v[36:39], v[120:123]
    ds_read_b128 v[68:71], v15 offset:64
    ds_read_b128 v[72:75], v15 offset:19008
    v_mfma_f32_16x16x32_bf16 v[124:127], v[20:23], v[40:43], v[124:127]
    s_add_u32 m0, s57, 32768
    s_mov_b32 s58, s54
    ds_read_b128 v[76:79], v15 offset:37952
    v_mfma_f32_16x16x32_bf16 v[128:131], v[20:23], v[44:47], v[128:131]
    buffer_load_dwordx4 v4, s[12:15], s58 offen lds
    v_mfma_f32_16x16x32_bf16 v[132:135], v[20:23], v[48:51], v[132:135]
    ds_read_b128 v[80:83], v15 offset:56896
    ds_read_b128 v[84:87], v3 offset:64
    v_mfma_f32_16x16x32_bf16 v[136:139], v[28:31], v[32:35], v[136:139]
    ds_read_b64_tr_b16 v[60:61], v13 offset:59392
    ds_read_b64_tr_b16 v[62:63], v13 offset:61952
    v_mfma_f32_16x16x32_bf16 v[140:143], v[28:31], v[36:39], v[140:143]
    ds_read_b64_tr_b16 v[52:53], v13 offset:49152
    ds_read_b64_tr_b16 v[54:55], v13 offset:51712
    v_mfma_f32_16x16x32_bf16 v[144:147], v[28:31], v[40:43], v[144:147]
    buffer_load_dwordx4 v5, s[12:15], s58 offen offset:1024 lds
    v_mfma_f32_16x16x32_bf16 v[148:151], v[28:31], v[44:47], v[148:151]
    ds_read_b64_tr_b16 v[64:65], v14 offset:49152
    ds_read_b64_tr_b16 v[66:67], v223 offset:49152
    v_mfma_f32_16x16x32_bf16 v[152:155], v[28:31], v[48:51], v[152:155]
    s_add_u32 s55, s55, 128
    s_cmp_eq_u32 s55, 1152
    s_cselect_b32 s55, 0, s55
    v_add_u32 v15, s55, v222
    v_mfma_f32_16x16x32_bf16 v[100:103], v[16:19], v[36:39], v[100:103]
    v_add_u32 v3, 75776, v15
    v_mad_u32_u24 v237, v235, 36, v236
    v_mfma_f32_16x16x32_bf16 v[104:107], v[16:19], v[40:43], v[104:107]
    buffer_load_dwordx4 v6, s[12:15], s58 offen offset:2048 lds
    v_mfma_f32_16x16x32_bf16 v[108:111], v[16:19], v[44:47], v[108:111]
    v_mad_u32_u24 v199, v237, s60, v247
    v_cmp_eq_u32 vcc, 0, v235
    v_mfma_f32_16x16x32_bf16 v[112:115], v[16:19], v[48:51], v[112:115]
    v_lshl_add_u32 v237, v234, 1, v233
    v_lshl_add_u32 v237, v235, 3, v237
    v_mfma_f32_16x16x32_bf16 v[156:159], v[32:35], v[24:27], v[156:159]
    v_mad_u32_u24 v237, v237, 36, v232
    v_subrev_u32 v237, 272, v237
    v_mfma_f32_16x16x32_bf16 v[160:163], v[36:39], v[24:27], v[160:163]
    buffer_load_dwordx4 v7, s[12:15], s58 offen offset:3072 lds
    v_mfma_f32_16x16x32_bf16 v[164:167], v[40:43], v[24:27], v[164:167]
    s_waitcnt vmcnt(8) lgkmcnt(0)
    s_barrier
    v_mfma_f32_16x16x32_bf16 v[168:171], v[44:47], v[24:27], v[168:171]
    v_add_u32 v236, 540, v236
    v_cndmask_b32 v237, v237, v236, vcc
    v_mfma_f32_16x16x32_bf16 v[172:175], v[48:51], v[24:27], v[172:175]
    v_mad_u32_u24 v203, v237, s60, v247
    v_or_b32 v199, s71, v199
    v_or_b32 v203, s71, v203
    v_mfma_f32_16x16x32_bf16 v[116:119], v[56:59], v[68:71], v[116:119]
    ds_read_b64_tr_b16 v[20:21], v13 offset:5120
    ds_read_b64_tr_b16 v[22:23], v13 offset:7680
    v_mfma_f32_16x16x32_bf16 v[120:123], v[56:59], v[72:75], v[120:123]
    ds_read_b128 v[32:35], v15 offset:0
    ds_read_b128 v[36:39], v15 offset:18944
    v_mfma_f32_16x16x32_bf16 v[124:127], v[56:59], v[76:79], v[124:127]
    s_add_u32 m0, s57, 49152
    s_add_u32 s58, s54, 110592
    ds_read_b128 v[40:43], v15 offset:37888
    v_mfma_f32_16x16x32_bf16 v[128:131], v[56:59], v[80:83], v[128:131]
    buffer_load_dwordx4 v4, s[12:15], s58 offen lds
    v_mfma_f32_16x16x32_bf16 v[132:135], v[56:59], v[84:87], v[132:135]
    ds_read_b128 v[44:47], v15 offset:56832
    ds_read_b128 v[48:51], v3 offset:0
    v_mfma_f32_16x16x32_bf16 v[136:139], v[64:67], v[68:71], v[136:139]
    ds_read_b64_tr_b16 v[24:25], v13 offset:10240
    ds_read_b64_tr_b16 v[26:27], v13 offset:12800
    v_mfma_f32_16x16x32_bf16 v[140:143], v[64:67], v[72:75], v[140:143]
    s_add_u32 s54, s54, 221184
    ds_read_b64_tr_b16 v[16:17], v13 offset:0
    ds_read_b64_tr_b16 v[18:19], v13 offset:2560
    v_mfma_f32_16x16x32_bf16 v[144:147], v[64:67], v[76:79], v[144:147]
    buffer_load_dwordx4 v5, s[12:15], s58 offen offset:1024 lds
    v_mfma_f32_16x16x32_bf16 v[148:151], v[64:67], v[80:83], v[148:151]
    ds_read_b64_tr_b16 v[28:29], v14 offset:0
    ds_read_b64_tr_b16 v[30:31], v223 offset:0
    v_mfma_f32_16x16x32_bf16 v[152:155], v[64:67], v[84:87], v[152:155]
    v_add_u32 v229, 0x10000, v228
    v_mfma_f32_16x16x32_bf16 v[100:103], v[52:55], v[72:75], v[100:103]
    s_cmp_eq_u32 s54, s56
    s_cselect_b32 s54, s53, s54
    s_lshl_b32 s6, s4, 6
    s_lshl_b32 s7, s3, 4
    v_mfma_f32_16x16x32_bf16 v[104:107], v[52:55], v[76:79], v[104:107]
    buffer_load_dwordx4 v6, s[12:15], s58 offen offset:2048 lds
    v_mfma_f32_16x16x32_bf16 v[108:111], v[52:55], v[80:83], v[108:111]
    s_add_u32 s6, s6, s7
    v_add_u32 v227, s6, v1
    v_mfma_f32_16x16x32_bf16 v[112:115], v[52:55], v[84:87], v[112:115]
    v_mul_u32_u24 v227, 1152, v227
    v_mfma_f32_16x16x32_bf16 v[156:159], v[68:71], v[60:63], v[156:159]
    v_lshl_add_u32 v227, v2, 3, v227
    v_add_u32 v227, s53, v227
    v_mfma_f32_16x16x32_bf16 v[160:163], v[72:75], v[60:63], v[160:163]
    buffer_load_dwordx4 v7, s[12:15], s58 offen offset:3072 lds
    v_mfma_f32_16x16x32_bf16 v[164:167], v[76:79], v[60:63], v[164:167]
    s_waitcnt vmcnt(8) lgkmcnt(0)
    s_barrier
    v_mfma_f32_16x16x32_bf16 v[168:171], v[80:83], v[60:63], v[168:171]
    v_lshlrev_b32 v230, 8, v2
    v_lshl_add_u32 v230, v1, 2, v230
    v_mfma_f32_16x16x32_bf16 v[172:175], v[84:87], v[60:63], v[172:175]
    s_lshl_b32 s6, s5, 2
    s_add_u32 s50, s52, s6
    v_mfma_f32_16x16x32_bf16 v[116:119], v[20:23], v[32:35], v[116:119]
    ds_read_b64_tr_b16 v[56:57], v13 offset:21504
    ds_read_b64_tr_b16 v[58:59], v13 offset:24064
    v_mfma_f32_16x16x32_bf16 v[120:123], v[20:23], v[36:39], v[120:123]
    ds_read_b128 v[68:71], v15 offset:64
    ds_read_b128 v[72:75], v15 offset:19008
    v_mfma_f32_16x16x32_bf16 v[124:127], v[20:23], v[40:43], v[124:127]
    s_add_u32 m0, s57, 0
    s_mov_b32 s58, s54
    ds_read_b128 v[76:79], v15 offset:37952
    v_mfma_f32_16x16x32_bf16 v[128:131], v[20:23], v[44:47], v[128:131]
    buffer_load_dwordx4 v4, s[12:15], s58 offen lds
    v_mfma_f32_16x16x32_bf16 v[132:135], v[20:23], v[48:51], v[132:135]
    ds_read_b128 v[80:83], v15 offset:56896
    ds_read_b128 v[84:87], v3 offset:64
    v_mfma_f32_16x16x32_bf16 v[136:139], v[28:31], v[32:35], v[136:139]
    ds_read_b64_tr_b16 v[60:61], v13 offset:26624
    ds_read_b64_tr_b16 v[62:63], v13 offset:29184
    v_mfma_f32_16x16x32_bf16 v[140:143], v[28:31], v[36:39], v[140:143]
    ds_read_b64_tr_b16 v[52:53], v13 offset:16384
    ds_read_b64_tr_b16 v[54:55], v13 offset:18944
    v_mfma_f32_16x16x32_bf16 v[144:147], v[28:31], v[40:43], v[144:147]
    buffer_load_dwordx4 v5, s[12:15], s58 offen offset:1024 lds
    v_mfma_f32_16x16x32_bf16 v[148:151], v[28:31], v[44:47], v[148:151]
    ds_read_b64_tr_b16 v[64:65], v14 offset:16384
    ds_read_b64_tr_b16 v[66:67], v223 offset:16384
    v_mfma_f32_16x16x32_bf16 v[152:155], v[28:31], v[48:51], v[152:155]
    s_add_u32 s55, s55, 128
    s_cmp_eq_u32 s55, 1152
    s_cselect_b32 s55, 0, s55
    v_add_u32 v15, s55, v222
    v_mfma_f32_16x16x32_bf16 v[100:103], v[16:19], v[36:39], v[100:103]
    v_add_u32 v3, 75776, v15
    s_add_u32 s70, s6, s3
    v_mfma_f32_16x16x32_bf16 v[104:107], v[16:19], v[40:43], v[104:107]
    buffer_load_dwordx4 v6, s[12:15], s58 offen offset:2048 lds
    v_mfma_f32_16x16x32_bf16 v[108:111], v[16:19], v[44:47], v[108:111]
    s_mul_i32 s48, s5, 1152
    v_and_b32 v232, 1, v0
    v_mfma_f32_16x16x32_bf16 v[112:115], v[16:19], v[48:51], v[112:115]
    v_cmp_eq_u32 s[64:65], 1, v232
    v_lshl_add_u32 v234, v2, 2, v232
    v_mfma_f32_16x16x32_bf16 v[156:159], v[32:35], v[24:27], v[156:159]
    v_cmp_ge_u32 s[66:67], v1, v234
    v_add_u32 v234, 2, v234
    v_mfma_f32_16x16x32_bf16 v[160:163], v[36:39], v[24:27], v[160:163]
    buffer_load_dwordx4 v7, s[12:15], s58 offen offset:3072 lds
    v_mfma_f32_16x16x32_bf16 v[164:167], v[40:43], v[24:27], v[164:167]
    s_waitcnt vmcnt(8) lgkmcnt(0)
    s_barrier
    v_mfma_f32_16x16x32_bf16 v[168:171], v[44:47], v[24:27], v[168:171]
    v_cmp_ge_u32 s[68:69], v1, v234
    v_mov_b32 v235, 0x0c0c0c0c
    v_mfma_f32_16x16x32_bf16 v[172:175], v[48:51], v[24:27], v[172:175]
    v_mov_b32 v236, 0x0c0c0100
    v_mov_b32 v237, 0x01000c0c
    v_cndmask_b32 v236, v236, v237, s[64:65]
    v_mfma_f32_16x16x32_bf16 v[116:119], v[56:59], v[68:71], v[116:119]
    ds_read_b64_tr_b16 v[20:21], v13 offset:37888
    ds_read_b64_tr_b16 v[22:23], v13 offset:40448
    v_mfma_f32_16x16x32_bf16 v[120:123], v[56:59], v[72:75], v[120:123]
    ds_read_b128 v[32:35], v15 offset:0
    ds_read_b128 v[36:39], v15 offset:18944
    v_mfma_f32_16x16x32_bf16 v[124:127], v[56:59], v[76:79], v[124:127]
    s_add_u32 m0, s57, 16384
    s_add_u32 s58, s54, 110592
    ds_read_b128 v[40:43], v15 offset:37888
    v_mfma_f32_16x16x32_bf16 v[128:131], v[56:59], v[80:83], v[128:131]
    buffer_load_dwordx4 v4, s[12:15], s58 offen lds
    v_mfma_f32_16x16x32_bf16 v[132:135], v[56:59], v[84:87], v[132:135]
    ds_read_b128 v[44:47], v15 offset:56832
    ds_read_b128 v[48:51], v3 offset:0
    v_mfma_f32_16x16x32_bf16 v[136:139], v[64:67], v[68:71], v[136:139]
    ds_read_b64_tr_b16 v[24:25], v13 offset:43008
    ds_read_b64_tr_b16 v[26:27], v13 offset:45568
    v_mfma_f32_16x16x32_bf16 v[140:143], v[64:67], v[72:75], v[140:143]
    s_add_u32 s54, s54, 221184
    ds_read_b64_tr_b16 v[16:17], v13 offset:32768
    ds_read_b64_tr_b16 v[18:19], v13 offset:35328
    v_mfma_f32_16x16x32_bf16 v[144:147], v[64:67], v[76:79], v[144:147]
    buffer_load_dwordx4 v5, s[12:15], s58 offen offset:1024 lds
    v_mfma_f32_16x16x32_bf16 v[148:151], v[64:67], v[80:83], v[148:151]
    ds_read_b64_tr_b16 v[28:29], v14 offset:32768
    ds_read_b64_tr_b16 v[30:31], v223 offset:32768
    v_mfma_f32_16x16x32_bf16 v[152:155], v[64:67], v[84:87], v[152:155]
    v_mov_b32 v238, 0x0c0c0302
    v_mfma_f32_16x16x32_bf16 v[100:103], v[52:55], v[72:75], v[100:103]
    s_cmp_eq_u32 s54, s56
    s_cselect_b32 s54, s53, s54
    v_mov_b32 v237, 0x03020c0c
    v_cndmask_b32 v238, v238, v237, s[64:65]
    v_mfma_f32_16x16x32_bf16 v[104:107], v[52:55], v[76:79], v[104:107]
    buffer_load_dwordx4 v6, s[12:15], s58 offen offset:2048 lds
    v_mfma_f32_16x16x32_bf16 v[108:111], v[52:55], v[80:83], v[108:111]
    v_cndmask_b32 v204, v236, v235, s[66:67]
    v_cndmask_b32 v205, v238, v235, s[68:69]
    v_mfma_f32_16x16x32_bf16 v[112:115], v[52:55], v[84:87], v[112:115]
    v_cndmask_b32 v206, v235, v236, s[66:67]
    v_mfma_f32_16x16x32_bf16 v[156:159], v[68:71], v[60:63], v[156:159]
    v_cndmask_b32 v207, v235, v238, s[68:69]
    v_and_b32 v237, 0x32, v0
    v_mfma_f32_16x16x32_bf16 v[160:163], v[72:75], v[60:63], v[160:163]
    buffer_load_dwordx4 v7, s[12:15], s58 offen offset:3072 lds
    v_mfma_f32_16x16x32_bf16 v[164:167], v[76:79], v[60:63], v[164:167]
    s_waitcnt vmcnt(8) lgkmcnt(0)
    s_barrier
    v_mfma_f32_16x16x32_bf16 v[168:171], v[80:83], v[60:63], v[168:171]
    v_cmp_eq_u32 vcc, 0x30, v237
    v_mov_b32 v208, 0
    v_mfma_f32_16x16x32_bf16 v[172:175], v[84:87], v[60:63], v[172:175]
    v_mov_b32 v209, 0
    v_mov_b32 v211, 0
    v_mfma_f32_16x16x32_bf16 v[116:119], v[20:23], v[32:35], v[116:119]
    ds_read_b64_tr_b16 v[56:57], v13 offset:54272
    ds_read_b64_tr_b16 v[58:59], v13 offset:56832
    v_mfma_f32_16x16x32_bf16 v[120:123], v[20:23], v[36:39], v[120:123]
    ds_read_b128 v[68:71], v15 offset:64
    ds_read_b128 v[72:75], v15 offset:19008
    v_mfma_f32_16x16x32_bf16 v[124:127], v[20:23], v[40:43], v[124:127]
    s_add_u32 m0, s57, 32768
    s_mov_b32 s58, s54
    ds_read_b128 v[76:79], v15 offset:37952
    v_mfma_f32_16x16x32_bf16 v[128:131], v[20:23], v[44:47], v[128:131]
    buffer_load_dwordx4 v4, s[12:15], s58 offen lds
    v_mfma_f32_16x16x32_bf16 v[132:135], v[20:23], v[48:51], v[132:135]
    ds_read_b128 v[80:83], v15 offset:56896
    ds_read_b128 v[84:87], v3 offset:64
    v_mfma_f32_16x16x32_bf16 v[136:139], v[28:31], v[32:35], v[136:139]
    ds_read_b64_tr_b16 v[60:61], v13 offset:59392
    ds_read_b64_tr_b16 v[62:63], v13 offset:61952
    v_mfma_f32_16x16x32_bf16 v[140:143], v[28:31], v[36:39], v[140:143]
    ds_read_b64_tr_b16 v[52:53], v13 offset:49152
    ds_read_b64_tr_b16 v[54:55], v13 offset:51712
    v_mfma_f32_16x16x32_bf16 v[144:147], v[28:31], v[40:43], v[144:147]
    buffer_load_dwordx4 v5, s[12:15], s58 offen offset:1024 lds
    v_mfma_f32_16x16x32_bf16 v[148:151], v[28:31], v[44:47], v[148:151]
    ds_read_b64_tr_b16 v[64:65], v14 offset:49152
    ds_read_b64_tr_b16 v[66:67], v223 offset:49152
    v_mfma_f32_16x16x32_bf16 v[152:155], v[28:31], v[48:51], v[152:155]
    s_add_u32 s55, s55, 128
    s_cmp_eq_u32 s55, 1152
    s_cselect_b32 s55, 0, s55
    v_add_u32 v15, s55, v222
    v_mfma_f32_16x16x32_bf16 v[100:103], v[16:19], v[36:39], v[100:103]
    v_add_u32 v3, 75776, v15
    v_mov_b32 v236, 0x3f80
    v_mfma_f32_16x16x32_bf16 v[104:107], v[16:19], v[40:43], v[104:107]
    buffer_load_dwordx4 v6, s[12:15], s58 offen offset:2048 lds
    v_mfma_f32_16x16x32_bf16 v[108:111], v[16:19], v[44:47], v[108:111]
    v_lshlrev_b32 v237, 4, v232
    v_lshlrev_b32 v236, v237, v236
    v_mfma_f32_16x16x32_bf16 v[112:115], v[16:19], v[48:51], v[112:115]
    v_cndmask_b32 v210, 0, v236, vcc
    v_and_b32 v233, 3, v0
    v_mfma_f32_16x16x32_bf16 v[156:159], v[32:35], v[24:27], v[156:159]
    v_cmp_eq_u32 vcc, 2, v233
    s_cmp_eq_u32 s4, 0
    s_cselect_b32 s6, 0xf149f2ca, 0
    v_mfma_f32_16x16x32_bf16 v[160:163], v[36:39], v[24:27], v[160:163]
    buffer_load_dwordx4 v7, s[12:15], s58 offen offset:3072 lds
    v_mfma_f32_16x16x32_bf16 v[164:167], v[40:43], v[24:27], v[164:167]
    s_waitcnt vmcnt(8) lgkmcnt(0)
    s_barrier
    v_mfma_f32_16x16x32_bf16 v[168:171], v[44:47], v[24:27], v[168:171]
    v_mov_b32 v237, 1.0
    v_mov_b32 v216, s6
    v_mfma_f32_16x16x32_bf16 v[172:175], v[48:51], v[24:27], v[172:175]
    v_cndmask_b32 v212, 0, v237, vcc
    v_mov_b32 v217, s6
    v_mov_b32 v218, s6
    v_mfma_f32_16x16x32_bf16 v[116:119], v[56:59], v[68:71], v[116:119]
    ds_read_b64_tr_b16 v[20:21], v13 offset:5120
    ds_read_b64_tr_b16 v[22:23], v13 offset:7680
    v_mfma_f32_16x16x32_bf16 v[120:123], v[56:59], v[72:75], v[120:123]
    ds_read_b128 v[32:35], v15 offset:0
    ds_read_b128 v[36:39], v15 offset:18944
    v_mfma_f32_16x16x32_bf16 v[124:127], v[56:59], v[76:79], v[124:127]
    s_add_u32 m0, s57, 49152
    s_add_u32 s58, s54, 110592
    ds_read_b128 v[40:43], v15 offset:37888
    v_mfma_f32_16x16x32_bf16 v[128:131], v[56:59], v[80:83], v[128:131]
    buffer_load_dwordx4 v4, s[12:15], s58 offen lds
    v_mfma_f32_16x16x32_bf16 v[132:135], v[56:59], v[84:87], v[132:135]
    ds_read_b128 v[44:47], v15 offset:56832
    ds_read_b128 v[48:51], v3 offset:0
    v_mfma_f32_16x16x32_bf16 v[136:139], v[64:67], v[68:71], v[136:139]
    ds_read_b64_tr_b16 v[24:25], v13 offset:10240
    ds_read_b64_tr_b16 v[26:27], v13 offset:12800
    v_mfma_f32_16x16x32_bf16 v[140:143], v[64:67], v[72:75], v[140:143]
    s_add_u32 s54, s54, 221184
    ds_read_b64_tr_b16 v[16:17], v13 offset:0
    ds_read_b64_tr_b16 v[18:19], v13 offset:2560
    v_mfma_f32_16x16x32_bf16 v[144:147], v[64:67], v[76:79], v[144:147]
    buffer_load_dwordx4 v5, s[12:15], s58 offen offset:1024 lds
    v_mfma_f32_16x16x32_bf16 v[148:151], v[64:67], v[80:83], v[148:151]
    ds_read_b64_tr_b16 v[28:29], v14 offset:0
    ds_read_b64_tr_b16 v[30:31], v223 offset:0
    v_mfma_f32_16x16x32_bf16 v[152:155], v[64:67], v[84:87], v[152:155]
    v_mov_b32 v219, s6
    v_mfma_f32_16x16x32_bf16 v[100:103], v[52:55], v[72:75], v[100:103]
    s_cmp_eq_u32 s54, s56
    s_cselect_b32 s54, s53, s54
    v_mov_b32 v213, v212
    v_mov_b32 v214, v212
    v_mfma_f32_16x16x32_bf16 v[104:107], v[52:55], v[76:79], v[104:107]
    buffer_load_dwordx4 v6, s[12:15], s58 offen offset:2048 lds
    v_mfma_f32_16x16x32_bf16 v[108:111], v[52:55], v[80:83], v[108:111]
    v_mov_b32 v215, v212
    v_and_b32 v232, 1, v2
    v_mfma_f32_16x16x32_bf16 v[112:115], v[52:55], v[84:87], v[112:115]
    v_lshlrev_b32 v232, 14, v232
    v_mfma_f32_16x16x32_bf16 v[156:159], v[68:71], v[60:63], v[156:159]
    v_lshrrev_b32 v234, 1, v2
    v_lshlrev_b32 v234, 8, v234
    v_mfma_f32_16x16x32_bf16 v[160:163], v[72:75], v[60:63], v[160:163]
    buffer_load_dwordx4 v7, s[12:15], s58 offen offset:3072 lds
    v_mfma_f32_16x16x32_bf16 v[164:167], v[76:79], v[60:63], v[164:167]
    s_waitcnt vmcnt(8) lgkmcnt(0)
    s_barrier
    v_mfma_f32_16x16x32_bf16 v[168:171], v[80:83], v[60:63], v[168:171]
    v_lshl_add_u32 v234, v1, 4, v234
    v_add_u32 v220, v232, v234
    v_mfma_f32_16x16x32_bf16 v[172:175], v[84:87], v[60:63], v[172:175]
    v_lshlrev_b32 v234, 11, v2
    v_lshl_add_u32 v221, v1, 2, v234
    v_mfma_f32_16x16x32_bf16 v[116:119], v[20:23], v[32:35], v[116:119]
    ds_read_b64_tr_b16 v[56:57], v13 offset:21504
    ds_read_b64_tr_b16 v[58:59], v13 offset:24064
    v_mfma_f32_16x16x32_bf16 v[120:123], v[20:23], v[36:39], v[120:123]
    ds_read_b128 v[68:71], v15 offset:64
    ds_read_b128 v[72:75], v15 offset:19008
    v_mfma_f32_16x16x32_bf16 v[124:127], v[20:23], v[40:43], v[124:127]
    s_add_u32 m0, s57, 0
    s_mov_b32 s58, s54
    ds_read_b128 v[76:79], v15 offset:37952
    v_mfma_f32_16x16x32_bf16 v[128:131], v[20:23], v[44:47], v[128:131]
    buffer_load_dwordx4 v4, s[12:15], s58 offen lds
    v_mfma_f32_16x16x32_bf16 v[132:135], v[20:23], v[48:51], v[132:135]
    ds_read_b128 v[80:83], v15 offset:56896
    ds_read_b128 v[84:87], v3 offset:64
    v_mfma_f32_16x16x32_bf16 v[136:139], v[28:31], v[32:35], v[136:139]
    ds_read_b64_tr_b16 v[60:61], v13 offset:26624
    ds_read_b64_tr_b16 v[62:63], v13 offset:29184
    v_mfma_f32_16x16x32_bf16 v[140:143], v[28:31], v[36:39], v[140:143]
    ds_read_b64_tr_b16 v[52:53], v13 offset:16384
    ds_read_b64_tr_b16 v[54:55], v13 offset:18944
    v_mfma_f32_16x16x32_bf16 v[144:147], v[28:31], v[40:43], v[144:147]
    buffer_load_dwordx4 v5, s[12:15], s58 offen offset:1024 lds
    v_mfma_f32_16x16x32_bf16 v[148:151], v[28:31], v[44:47], v[148:151]
    ds_read_b64_tr_b16 v[64:65], v14 offset:16384
    ds_read_b64_tr_b16 v[66:67], v223 offset:16384
    v_mfma_f32_16x16x32_bf16 v[152:155], v[28:31], v[48:51], v[152:155]
    s_add_u32 s55, s55, 128
    s_cmp_eq_u32 s55, 1152
    s_cselect_b32 s55, 0, s55
    v_add_u32 v15, s55, v222
    v_mfma_f32_16x16x32_bf16 v[100:103], v[16:19], v[36:39], v[100:103]
    v_add_u32 v3, 75776, v15
    s_lshl_b32 s6, s70, 9
    v_mfma_f32_16x16x32_bf16 v[104:107], v[16:19], v[40:43], v[104:107]
    buffer_load_dwordx4 v6, s[12:15], s58 offen offset:2048 lds
    v_mfma_f32_16x16x32_bf16 v[108:111], v[16:19], v[44:47], v[108:111]
    s_add_u32 s61, s6, 65536
    s_add_u32 s62, s61, 32768
    v_mfma_f32_16x16x32_bf16 v[112:115], v[16:19], v[48:51], v[112:115]
    s_lshr_b32 s6, s6, 3
    s_add_u32 s63, s6, 8192
    v_mfma_f32_16x16x32_bf16 v[156:159], v[32:35], v[24:27], v[156:159]
    s_bitcmp1_b32 s3, 0
    s_cselect_b64 vcc, -1, 0
    s_lshl_b32 s6, s3, 5
    v_mfma_f32_16x16x32_bf16 v[160:163], v[36:39], v[24:27], v[160:163]
    buffer_load_dwordx4 v7, s[12:15], s58 offen offset:3072 lds
    v_mfma_f32_16x16x32_bf16 v[164:167], v[40:43], v[24:27], v[164:167]
    s_waitcnt vmcnt(8) lgkmcnt(0)
    s_barrier
    v_mfma_f32_16x16x32_bf16 v[168:171], v[44:47], v[24:27], v[168:171]
    v_min_u32 v232, 8, v1
    v_lshlrev_b32 v232, 7, v232
    v_mfma_f32_16x16x32_bf16 v[172:175], v[48:51], v[24:27], v[172:175]
    v_lshl_add_u32 v232, v2, 3, v232
    v_add_u32 v12, s6, v232
    s_mul_i32 s6, s3, 23
    v_mfma_f32_16x16x32_bf16 v[116:119], v[56:59], v[68:71], v[116:119]
    ds_read_b64_tr_b16 v[20:21], v13 offset:37888
    ds_read_b64_tr_b16 v[22:23], v13 offset:40448
    v_mfma_f32_16x16x32_bf16 v[120:123], v[56:59], v[72:75], v[120:123]
    ds_read_b128 v[32:35], v15 offset:0
    ds_read_b128 v[36:39], v15 offset:18944
    v_mfma_f32_16x16x32_bf16 v[124:127], v[56:59], v[76:79], v[124:127]
    s_add_u32 m0, s57, 16384
    s_add_u32 s58, s54, 110592
    ds_read_b128 v[40:43], v15 offset:37888
    v_mfma_f32_16x16x32_bf16 v[128:131], v[56:59], v[80:83], v[128:131]
    buffer_load_dwordx4 v4, s[12:15], s58 offen lds
    v_mfma_f32_16x16x32_bf16 v[132:135], v[56:59], v[84:87], v[132:135]
    ds_read_b128 v[44:47], v15 offset:56832
    ds_read_b128 v[48:51], v3 offset:0
    v_mfma_f32_16x16x32_bf16 v[136:139], v[64:67], v[68:71], v[136:139]
    ds_read_b64_tr_b16 v[24:25], v13 offset:43008
    ds_read_b64_tr_b16 v[26:27], v13 offset:45568
    v_mfma_f32_16x16x32_bf16 v[140:143], v[64:67], v[72:75], v[140:143]
    ds_read_b64_tr_b16 v[16:17], v13 offset:32768
    ds_read_b64_tr_b16 v[18:19], v13 offset:35328
    v_mfma_f32_16x16x32_bf16 v[144:147], v[64:67], v[76:79], v[144:147]
    buffer_load_dwordx4 v5, s[12:15], s58 offen offset:1024 lds
    v_mfma_f32_16x16x32_bf16 v[148:151], v[64:67], v[80:83], v[148:151]
    ds_read_b64_tr_b16 v[28:29], v14 offset:32768
    ds_read_b64_tr_b16 v[30:31], v223 offset:32768
    v_mfma_f32_16x16x32_bf16 v[152:155], v[64:67], v[84:87], v[152:155]
    v_min_u32 v232, 22, v0
    v_mfma_f32_16x16x32_bf16 v[100:103], v[52:55], v[72:75], v[100:103]
    v_add_u32 v232, s6, v232
    v_min_u32 v232, 89, v232
    v_mfma_f32_16x16x32_bf16 v[104:107], v[52:55], v[76:79], v[104:107]
    buffer_load_dwordx4 v6, s[12:15], s58 offen offset:2048 lds
    v_mfma_f32_16x16x32_bf16 v[108:111], v[52:55], v[80:83], v[108:111]
    v_mul_u32_u24 v233, 13108, v232
    v_lshrrev_b32 v233, 16, v233
    v_mfma_f32_16x16x32_bf16 v[112:115], v[52:55], v[84:87], v[112:115]
    v_mad_i32_i24 v232, v233, -5, v232
    v_mfma_f32_16x16x32_bf16 v[156:159], v[68:71], v[60:63], v[156:159]
    v_add_u32 v232, 0, v232
    v_mul_u32_u24 v233, 9216, v233
    v_mfma_f32_16x16x32_bf16 v[160:163], v[72:75], v[60:63], v[160:163]
    buffer_load_dwordx4 v7, s[12:15], s58 offen offset:3072 lds
    v_mfma_f32_16x16x32_bf16 v[164:167], v[76:79], v[60:63], v[164:167]
    s_waitcnt vmcnt(8) lgkmcnt(0)
    s_barrier
    v_mfma_f32_16x16x32_bf16 v[168:171], v[80:83], v[60:63], v[168:171]
    v_lshl_add_u32 v231, v232, 7, v233
    s_mul_i32 s6, s3, 18
    v_mfma_f32_16x16x32_bf16 v[172:175], v[84:87], v[60:63], v[172:175]
    v_min_u32 v232, 17, v0
    v_add_u32 v232, s6, v232
    v_mfma_f32_16x16x32_bf16 v[116:119], v[20:23], v[32:35], v[116:119]
    ds_read_b64_tr_b16 v[56:57], v13 offset:54272
    ds_read_b64_tr_b16 v[58:59], v13 offset:56832
    v_mfma_f32_16x16x32_bf16 v[120:123], v[20:23], v[36:39], v[120:123]
    ds_read_b128 v[68:71], v15 offset:64
    ds_read_b128 v[72:75], v15 offset:19008
    v_mfma_f32_16x16x32_bf16 v[124:127], v[20:23], v[40:43], v[124:127]
    s_add_u32 m0, s57, 32768
    s_add_u32 s58, s53, 0
    ds_read_b128 v[76:79], v15 offset:37952
    v_mfma_f32_16x16x32_bf16 v[128:131], v[20:23], v[44:47], v[128:131]
    buffer_load_dwordx4 v196, s[16:19], s58 offen lds
    v_mfma_f32_16x16x32_bf16 v[132:135], v[20:23], v[48:51], v[132:135]
    ds_read_b128 v[80:83], v15 offset:56896
    ds_read_b128 v[84:87], v3 offset:64
    v_mfma_f32_16x16x32_bf16 v[136:139], v[28:31], v[32:35], v[136:139]
    ds_read_b64_tr_b16 v[60:61], v13 offset:59392
    ds_read_b64_tr_b16 v[62:63], v13 offset:61952
    v_mfma_f32_16x16x32_bf16 v[140:143], v[28:31], v[36:39], v[140:143]
    ds_read_b64_tr_b16 v[52:53], v13 offset:49152
    ds_read_b64_tr_b16 v[54:55], v13 offset:51712
    v_mfma_f32_16x16x32_bf16 v[144:147], v[28:31], v[40:43], v[144:147]
    buffer_load_dwordx4 v197, s[16:19], s58 offen offset:1024 lds
    v_mfma_f32_16x16x32_bf16 v[148:151], v[28:31], v[44:47], v[148:151]
    ds_read_b64_tr_b16 v[64:65], v14 offset:49152
    ds_read_b64_tr_b16 v[66:67], v223 offset:49152
    v_mfma_f32_16x16x32_bf16 v[152:155], v[28:31], v[48:51], v[152:155]
    s_add_u32 s55, s55, 128
    s_cmp_eq_u32 s55, 1152
    s_cselect_b32 s55, 0, s55
    v_add_u32 v15, s55, v222
    v_mfma_f32_16x16x32_bf16 v[100:103], v[16:19], v[36:39], v[100:103]
    v_add_u32 v3, 75776, v15
    v_min_u32 v232, 71, v232
    v_mfma_f32_16x16x32_bf16 v[104:107], v[16:19], v[40:43], v[104:107]
    buffer_load_dwordx4 v198, s[16:19], s58 offen offset:2048 lds
    v_mfma_f32_16x16x32_bf16 v[108:111], v[16:19], v[44:47], v[108:111]
    v_mul_u32_u24 v233, 16385, v232
    v_lshrrev_b32 v233, 16, v233
    v_mfma_f32_16x16x32_bf16 v[112:115], v[16:19], v[48:51], v[112:115]
    v_mad_i32_i24 v232, v233, -4, v232
    v_add_u32 v232, 5, v232
    v_mfma_f32_16x16x32_bf16 v[156:159], v[32:35], v[24:27], v[156:159]
    v_mul_u32_u24 v233, 9216, v233
    v_lshl_add_u32 v251, v232, 7, v233
    v_mfma_f32_16x16x32_bf16 v[160:163], v[36:39], v[24:27], v[160:163]
    buffer_load_dwordx4 v199, s[16:19], s58 offen offset:3072 lds
    v_mfma_f32_16x16x32_bf16 v[164:167], v[40:43], v[24:27], v[164:167]
    s_waitcnt vmcnt(8) lgkmcnt(0)
    s_barrier
    v_mfma_f32_16x16x32_bf16 v[168:171], v[44:47], v[24:27], v[168:171]
    s_mul_i32 s6, s3, 14
    v_min_u32 v232, 13, v0
    v_mfma_f32_16x16x32_bf16 v[172:175], v[48:51], v[24:27], v[172:175]
    v_add_u32 v232, s6, v232
    v_min_u32 v232, 53, v232
    v_mfma_f32_16x16x32_bf16 v[116:119], v[56:59], v[68:71], v[116:119]
    ds_read_b64_tr_b16 v[20:21], v13 offset:5120
    ds_read_b64_tr_b16 v[22:23], v13 offset:7680
    v_mfma_f32_16x16x32_bf16 v[120:123], v[56:59], v[72:75], v[120:123]
    ds_read_b128 v[32:35], v15 offset:0
    ds_read_b128 v[36:39], v15 offset:18944
    v_mfma_f32_16x16x32_bf16 v[124:127], v[56:59], v[76:79], v[124:127]
    s_add_u32 m0, s57, 49152
    s_add_u32 s58, s53, 124416
    ds_read_b128 v[40:43], v15 offset:37888
    v_mfma_f32_16x16x32_bf16 v[128:131], v[56:59], v[80:83], v[128:131]
    buffer_load_dwordx4 v196, s[16:19], s58 offen lds
    v_mfma_f32_16x16x32_bf16 v[132:135], v[56:59], v[84:87], v[132:135]
    ds_read_b128 v[44:47], v15 offset:56832
    ds_read_b128 v[48:51], v3 offset:0
    v_mfma_f32_16x16x32_bf16 v[136:139], v[64:67], v[68:71], v[136:139]
    ds_read_b64_tr_b16 v[24:25], v13 offset:10240
    ds_read_b64_tr_b16 v[26:27], v13 offset:12800
    v_mfma_f32_16x16x32_bf16 v[140:143], v[64:67], v[72:75], v[140:143]
    ds_read_b64_tr_b16 v[16:17], v13 offset:0
    ds_read_b64_tr_b16 v[18:19], v13 offset:2560
    v_mfma_f32_16x16x32_bf16 v[144:147], v[64:67], v[76:79], v[144:147]
    buffer_load_dwordx4 v197, s[16:19], s58 offen offset:1024 lds
    v_mfma_f32_16x16x32_bf16 v[148:151], v[64:67], v[80:83], v[148:151]
    ds_read_b64_tr_b16 v[28:29], v14 offset:0
    ds_read_b64_tr_b16 v[30:31], v223 offset:0
    v_mfma_f32_16x16x32_bf16 v[152:155], v[64:67], v[84:87], v[152:155]
    v_mul_u32_u24 v233, 21846, v232
    v_mfma_f32_16x16x32_bf16 v[100:103], v[52:55], v[72:75], v[100:103]
    v_lshrrev_b32 v233, 16, v233
    v_mad_i32_i24 v232, v233, -3, v232
    v_mfma_f32_16x16x32_bf16 v[104:107], v[52:55], v[76:79], v[104:107]
    buffer_load_dwordx4 v198, s[16:19], s58 offen offset:2048 lds
    v_mfma_f32_16x16x32_bf16 v[108:111], v[52:55], v[80:83], v[108:111]
    v_add_u32 v232, 0, v232
    v_mfma_f32_16x16x32_bf16 v[112:115], v[52:55], v[84:87], v[112:115]
    v_cmp_eq_u32 s[6:7], 0, v232
    v_add_u32 v232, s5, v232
    v_and_b32 v232, 7, v232
    v_cndmask_b32 v232, v232, 8, s[6:7]
    v_mul_u32_u24 v233, 1152, v233
    v_mfma_f32_16x16x32_bf16 v[156:159], v[68:71], v[60:63], v[156:159]
    v_lshl_add_u32 v252, v232, 7, v233
    v_mfma_f32_16x16x32_bf16 v[160:163], v[72:75], v[60:63], v[160:163]
    buffer_load_dwordx4 v199, s[16:19], s58 offen offset:3072 lds
    v_mfma_f32_16x16x32_bf16 v[164:167], v[76:79], v[60:63], v[164:167]
    s_waitcnt vmcnt(8) lgkmcnt(0)
    s_barrier
    v_mfma_f32_16x16x32_bf16 v[168:171], v[80:83], v[60:63], v[168:171]
    s_mul_i32 s6, s3, 27
    v_min_u32 v232, 26, v0
    v_mfma_f32_16x16x32_bf16 v[172:175], v[84:87], v[60:63], v[172:175]
    v_add_u32 v232, s6, v232
    v_min_u32 v232, 107, v232
    v_mfma_f32_16x16x32_bf16 v[116:119], v[20:23], v[32:35], v[116:119]
    ds_read_b64_tr_b16 v[56:57], v13 offset:21504
    ds_read_b64_tr_b16 v[58:59], v13 offset:24064
    v_mfma_f32_16x16x32_bf16 v[120:123], v[20:23], v[36:39], v[120:123]
    ds_read_b128 v[68:71], v15 offset:64
    ds_read_b128 v[72:75], v15 offset:19008
    v_mfma_f32_16x16x32_bf16 v[124:127], v[20:23], v[40:43], v[124:127]
    s_add_u32 m0, s57, 0
    s_add_u32 s58, s53, 248832
    ds_read_b128 v[76:79], v15 offset:37952
    v_mfma_f32_16x16x32_bf16 v[128:131], v[20:23], v[44:47], v[128:131]
    buffer_load_dwordx4 v196, s[16:19], s58 offen lds
    v_mfma_f32_16x16x32_bf16 v[132:135], v[20:23], v[48:51], v[132:135]
    ds_read_b128 v[80:83], v15 offset:56896
    ds_read_b128 v[84:87], v3 offset:64
    v_mfma_f32_16x16x32_bf16 v[136:139], v[28:31], v[32:35], v[136:139]
    ds_read_b64_tr_b16 v[60:61], v13 offset:26624
    ds_read_b64_tr_b16 v[62:63], v13 offset:29184
    v_mfma_f32_16x16x32_bf16 v[140:143], v[28:31], v[36:39], v[140:143]
    ds_read_b64_tr_b16 v[52:53], v13 offset:16384
    ds_read_b64_tr_b16 v[54:55], v13 offset:18944
    v_mfma_f32_16x16x32_bf16 v[144:147], v[28:31], v[40:43], v[144:147]
    buffer_load_dwordx4 v197, s[16:19], s58 offen offset:1024 lds
    v_mfma_f32_16x16x32_bf16 v[148:151], v[28:31], v[44:47], v[148:151]
    ds_read_b64_tr_b16 v[64:65], v14 offset:16384
    ds_read_b64_tr_b16 v[66:67], v223 offset:16384
    v_mfma_f32_16x16x32_bf16 v[152:155], v[28:31], v[48:51], v[152:155]
    v_mul_u32_u24 v233, 10923, v232
    v_mfma_f32_16x16x32_bf16 v[100:103], v[16:19], v[36:39], v[100:103]
    v_lshrrev_b32 v233, 16, v233
    v_mad_i32_i24 v232, v233, -6, v232
    v_mfma_f32_16x16x32_bf16 v[104:107], v[16:19], v[40:43], v[104:107]
    buffer_load_dwordx4 v198, s[16:19], s58 offen offset:2048 lds
    v_mfma_f32_16x16x32_bf16 v[108:111], v[16:19], v[44:47], v[108:111]
    v_add_u32 v232, 3, v232
    v_mfma_f32_16x16x32_bf16 v[112:115], v[16:19], v[48:51], v[112:115]
    v_cmp_eq_u32 s[6:7], 0, v232
    v_add_u32 v232, s5, v232
    v_and_b32 v232, 7, v232
    v_cndmask_b32 v232, v232, 8, s[6:7]
    v_mul_u32_u24 v233, 1152, v233
    v_mfma_f32_16x16x32_bf16 v[156:159], v[32:35], v[24:27], v[156:159]
    v_lshl_add_u32 v255, v232, 7, v233
    v_mfma_f32_16x16x32_bf16 v[160:163], v[36:39], v[24:27], v[160:163]
    buffer_load_dwordx4 v199, s[16:19], s58 offen offset:3072 lds
    v_mfma_f32_16x16x32_bf16 v[164:167], v[40:43], v[24:27], v[164:167]
    s_waitcnt lgkmcnt(0)
    s_barrier
    v_mfma_f32_16x16x32_bf16 v[168:171], v[44:47], v[24:27], v[168:171]
    v_mov_b32 v96, 0
    v_mov_b32 v97, 0
    v_mfma_f32_16x16x32_bf16 v[172:175], v[48:51], v[24:27], v[172:175]
    v_mov_b32 v98, 0
    v_mov_b32 v99, 0
    v_mfma_f32_16x16x32_bf16 v[116:119], v[56:59], v[68:71], v[116:119]
    v_mov_b32 v16, 0
    v_mfma_f32_16x16x32_bf16 v[120:123], v[56:59], v[72:75], v[120:123]
    v_mov_b32 v17, 0
    v_mfma_f32_16x16x32_bf16 v[124:127], v[56:59], v[76:79], v[124:127]
    s_add_u32 m0, s57, 16384
    s_add_u32 s58, s53, 373248
    v_mov_b32 v18, 0
    v_mfma_f32_16x16x32_bf16 v[128:131], v[56:59], v[80:83], v[128:131]
    buffer_load_dwordx4 v196, s[16:19], s58 offen lds
    v_mfma_f32_16x16x32_bf16 v[132:135], v[56:59], v[84:87], v[132:135]
    v_mov_b32 v19, 0
    v_mfma_f32_16x16x32_bf16 v[136:139], v[64:67], v[68:71], v[136:139]
    v_mov_b32 v39, 0
    v_mfma_f32_16x16x32_bf16 v[140:143], v[64:67], v[72:75], v[140:143]
    v_mov_b32 v22, 0
    v_mfma_f32_16x16x32_bf16 v[144:147], v[64:67], v[76:79], v[144:147]
    buffer_load_dwordx4 v197, s[16:19], s58 offen offset:1024 lds
    v_mfma_f32_16x16x32_bf16 v[148:151], v[64:67], v[80:83], v[148:151]
    v_mov_b32 v23, 0
    v_mov_b32 v43, 0
    v_mfma_f32_16x16x32_bf16 v[152:155], v[64:67], v[84:87], v[152:155]
    v_mov_b32 v26, 0
    v_mfma_f32_16x16x32_bf16 v[100:103], v[52:55], v[72:75], v[100:103]
    v_mov_b32 v27, 0
    v_mfma_f32_16x16x32_bf16 v[104:107], v[52:55], v[76:79], v[104:107]
    buffer_load_dwordx4 v198, s[16:19], s58 offen offset:2048 lds
    v_mfma_f32_16x16x32_bf16 v[108:111], v[52:55], v[80:83], v[108:111]
    v_mov_b32 v47, 0
    v_mfma_f32_16x16x32_bf16 v[112:115], v[52:55], v[84:87], v[112:115]
    v_mov_b32 v30, 0
    v_mfma_f32_16x16x32_bf16 v[156:159], v[68:71], v[60:63], v[156:159]
    v_mov_b32 v31, 0
    v_mfma_f32_16x16x32_bf16 v[160:163], v[72:75], v[60:63], v[160:163]
    buffer_load_dwordx4 v199, s[16:19], s58 offen offset:3072 lds
    v_mfma_f32_16x16x32_bf16 v[164:167], v[76:79], v[60:63], v[164:167]
    v_mfma_f32_16x16x32_bf16 v[168:171], v[80:83], v[60:63], v[168:171]
    v_mov_b32 v51, 0
    v_mfma_f32_16x16x32_bf16 v[172:175], v[84:87], v[60:63], v[172:175]
    v_mov_b32 v34, 0
    v_mov_b32 v35, 0
    v_mov_b32 v55, 0
    v_cndmask_b32 v136, v136, v138, vcc
    v_cndmask_b32 v137, v137, v139, vcc
    v_cndmask_b32 v140, v140, v142, vcc
    v_cndmask_b32 v141, v141, v143, vcc
    v_cndmask_b32 v144, v144, v146, vcc
    v_cndmask_b32 v145, v145, v147, vcc
    v_cndmask_b32 v148, v148, v150, vcc
    v_cndmask_b32 v149, v149, v151, vcc
    v_cndmask_b32 v152, v152, v154, vcc
    v_cndmask_b32 v153, v153, v155, vcc
    s_add_u32 m0, s57, 65536
    s_add_u32 s58, s53, 497664
    buffer_load_dwordx4 v196, s[16:19], s58 offen lds
    v_cvt_pk_bf16_f32 v38, v136, v137
    v_cvt_pk_bf16_f32 v36, v116, v117
    v_cvt_pk_bf16_f32 v37, v118, v119
    v_permlane16_swap_b32 v18, v38
    v_cvt_pk_bf16_f32 v42, v140, v141
    v_cvt_pk_bf16_f32 v40, v120, v121
    v_cvt_pk_bf16_f32 v41, v122, v123
    v_cvt_pk_bf16_f32 v20, v100, v101
    v_cvt_pk_bf16_f32 v21, v102, v103
    v_permlane16_swap_b32 v22, v42
    v_cvt_pk_bf16_f32 v46, v144, v145
    v_cvt_pk_bf16_f32 v44, v124, v125
    v_cvt_pk_bf16_f32 v45, v126, v127
    v_cvt_pk_bf16_f32 v24, v104, v105
    v_cvt_pk_bf16_f32 v25, v106, v107
    v_permlane16_swap_b32 v26, v46
    buffer_load_dwordx4 v197, s[16:19], s58 offen offset:1024 lds
    v_cvt_pk_bf16_f32 v50, v148, v149
    v_cvt_pk_bf16_f32 v48, v128, v129
    v_cvt_pk_bf16_f32 v49, v130, v131
    v_cvt_pk_bf16_f32 v28, v108, v109
    v_cvt_pk_bf16_f32 v29, v110, v111
    v_permlane16_swap_b32 v30, v50
    v_cvt_pk_bf16_f32 v54, v152, v153
    v_cvt_pk_bf16_f32 v52, v132, v133
    v_cvt_pk_bf16_f32 v53, v134, v135
    v_cvt_pk_bf16_f32 v32, v112, v113
    v_cvt_pk_bf16_f32 v33, v114, v115
    v_permlane16_swap_b32 v34, v54
    v_mfma_f32_16x16x32_bf16 v[100:103], v[40:43], v[20:23], 0
    v_cvt_pk_bf16_f32 v56, v156, v157
    v_cvt_pk_bf16_f32 v57, v158, v159
    v_mfma_f32_16x16x32_bf16 v[104:107], v[36:39], v[20:23], v[216:219]
    buffer_load_dwordx4 v198, s[16:19], s58 offen offset:2048 lds
    v_cvt_pk_bf16_f32 v58, v160, v161
    v_cvt_pk_bf16_f32 v59, v162, v163
    v_mfma_f32_16x16x32_bf16 v[108:111], v[44:47], v[24:27], 0
    v_cvt_pk_bf16_f32 v60, v164, v165
    v_cvt_pk_bf16_f32 v61, v166, v167
    v_mfma_f32_16x16x32_bf16 v[112:115], v[40:43], v[24:27], 0
    v_cvt_pk_bf16_f32 v62, v168, v169
    v_cvt_pk_bf16_f32 v63, v170, v171
    v_mfma_f32_16x16x32_bf16 v[116:119], v[48:51], v[28:31], 0
    v_cvt_pk_bf16_f32 v64, v172, v173
    v_cvt_pk_bf16_f32 v65, v174, v175
    v_mfma_f32_16x16x32_bf16 v[120:123], v[44:47], v[28:31], 0
    v_cndmask_b32 v100, v100, v101, s[64:65]
    v_cndmask_b32 v102, v102, v103, s[64:65]
    v_mfma_f32_16x16x32_bf16 v[124:127], v[52:55], v[32:35], 0
    v_cndmask_b32 v104, v104, v105, s[64:65]
    buffer_load_dwordx4 v199, s[16:19], s58 offen offset:3072 lds
    v_cndmask_b32 v106, v106, v107, s[64:65]
    v_mfma_f32_16x16x32_bf16 v[128:131], v[48:51], v[32:35], 0
    v_cndmask_b32 v132, v104, v100, s[66:67]
    v_cndmask_b32 v133, v106, v102, s[68:69]
    v_mfma_f32_16x16x32_bf16 v[176:179], v[16:19], v[208:211], v[212:215]
    v_max_f32 v134, v132, v133
    v_max_f32 v135, v132, v133
    v_mfma_f32_16x16x32_bf16 v[180:183], v[20:23], v[208:211], v[212:215]
    v_cndmask_b32 v108, v108, v109, s[64:65]
    v_cndmask_b32 v110, v110, v111, s[64:65]
    v_mfma_f32_16x16x32_bf16 v[184:187], v[24:27], v[208:211], v[212:215]
    v_cndmask_b32 v112, v112, v113, s[64:65]
    v_cndmask_b32 v114, v114, v115, s[64:65]
    v_mfma_f32_16x16x32_bf16 v[188:191], v[28:31], v[208:211], v[212:215]
    v_cndmask_b32 v138, v112, v108, s[66:67]
    v_cndmask_b32 v139, v114, v110, s[68:69]
    v_mfma_f32_16x16x32_bf16 v[192:195], v[32:35], v[208:211], v[212:215]
    s_add_u32 m0, s57, 81920
    s_add_u32 s58, s53, 0
    buffer_load_dwordx4 v200, s[16:19], s58 offen lds
    v_max_f32 v140, v138, v139
    v_max_f32 v141, v138, v139
    v_cndmask_b32 v116, v116, v117, s[64:65]
    v_cndmask_b32 v118, v118, v119, s[64:65]
    v_cndmask_b32 v120, v120, v121, s[64:65]
    v_cndmask_b32 v122, v122, v123, s[64:65]
    v_cndmask_b32 v144, v120, v116, s[66:67]
    v_cndmask_b32 v145, v122, v118, s[68:69]
    v_max_f32 v146, v144, v145
    v_max_f32 v147, v144, v145
    v_cndmask_b32 v124, v124, v125, s[64:65]
    v_cndmask_b32 v126, v126, v127, s[64:65]
    v_cndmask_b32 v128, v128, v129, s[64:65]
    v_cndmask_b32 v130, v130, v131, s[64:65]
    v_cndmask_b32 v150, v128, v124, s[66:67]
    v_cndmask_b32 v151, v130, v126, s[68:69]
    buffer_load_dwordx4 v201, s[16:19], s58 offen offset:1024 lds
    v_max_f32 v152, v150, v151
    v_max_f32 v153, v150, v151
    s_mov_b32 s7, 0x3eae1a93
    v_permlane16_swap_b32 v134, v135
    v_permlane16_swap_b32 v140, v141
    v_permlane16_swap_b32 v146, v147
    v_permlane16_swap_b32 v152, v153
    v_max_f32 v136, v134, v135
    v_max_f32 v137, v134, v135
    v_max_f32 v142, v140, v141
    v_max_f32 v143, v140, v141
    v_max_f32 v148, v146, v147
    v_max_f32 v149, v146, v147
    v_max_f32 v154, v152, v153
    v_max_f32 v155, v152, v153
    v_permlane32_swap_b32 v136, v137
    buffer_load_dwordx4 v202, s[16:19], s58 offen offset:2048 lds
    v_permlane32_swap_b32 v142, v143
    v_permlane32_swap_b32 v148, v149
    v_permlane32_swap_b32 v154, v155
    v_max_f32 v134, v136, v137
    v_max_f32 v140, v142, v143
    v_max_f32 v146, v148, v149
    v_max_f32 v152, v154, v155
    v_pk_add_f32 v[132:133], v[132:133], v[134:135] op_sel_hi:[1,0] neg_lo:[0,1] neg_hi:[0,1]
    v_pk_add_f32 v[138:139], v[138:139], v[140:141] op_sel_hi:[1,0] neg_lo:[0,1] neg_hi:[0,1]
    v_pk_add_f32 v[144:145], v[144:145], v[146:147] op_sel_hi:[1,0] neg_lo:[0,1] neg_hi:[0,1]
    v_pk_add_f32 v[150:151], v[150:151], v[152:153] op_sel_hi:[1,0] neg_lo:[0,1] neg_hi:[0,1]
    v_mul_f32 v132, s7, v132
    v_mul_f32 v133, s7, v133
    v_mul_f32 v138, s7, v138
    v_mul_f32 v139, s7, v139
    v_mul_f32 v144, s7, v144
    v_mul_f32 v145, s7, v145
    buffer_load_dwordx4 v203, s[16:19], s58 offen offset:3072 lds
    v_mul_f32 v150, s7, v150
    v_mul_f32 v151, s7, v151
    v_exp_f32 v132, v132
    v_exp_f32 v133, v133
    v_exp_f32 v138, v138
    v_exp_f32 v139, v139
    v_exp_f32 v144, v144
    v_exp_f32 v145, v145
    v_exp_f32 v150, v150
    v_exp_f32 v151, v151
    v_cvt_pk_bf16_f32 v66, v176, v177
    v_cvt_pk_bf16_f32 v67, v178, v179
    v_cvt_pk_bf16_f32 v134, v132, v133
    v_cvt_pk_bf16_f32 v68, v180, v181
    v_cvt_pk_bf16_f32 v69, v182, v183
    v_perm_b32 v156, v134, v134, v204
    s_lshl_b32 s51, s3, 3
    s_add_u32 s51, s51, s5
    s_lshl_b32 s51, s51, 10
    s_add_u32 s51, s51, 32768
    v_lshlrev_b32 v249, 4, v0
    buffer_store_dwordx4 v[96:99], v249, s[28:31], s51 offen sc1
    v_perm_b32 v157, v134, v134, v205
    v_perm_b32 v158, v134, v134, v206
    v_perm_b32 v159, v134, v134, v207
    v_cvt_pk_bf16_f32 v140, v138, v139
    v_cvt_pk_bf16_f32 v70, v184, v185
    v_mfma_f32_16x16x32_bf16 v[104:107], v[66:69], v[156:159], 0
    v_cvt_pk_bf16_f32 v71, v186, v187
    v_perm_b32 v160, v140, v140, v204
    v_mfma_f32_16x16x32_bf16 v[100:103], v[56:59], v[156:159], 0
    v_perm_b32 v161, v140, v140, v205
    v_perm_b32 v162, v140, v140, v206
    v_perm_b32 v163, v140, v140, v207
    v_cvt_pk_bf16_f32 v146, v144, v145
    v_cvt_pk_bf16_f32 v72, v188, v189
    v_mfma_f32_16x16x32_bf16 v[112:115], v[68:71], v[160:163], 0
    v_cvt_pk_bf16_f32 v73, v190, v191
    s_lshl_b32 s6, s4, 2
    buffer_load_dword v250, off, s[44:47], s6 sc1
    v_perm_b32 v164, v146, v146, v204
    v_mfma_f32_16x16x32_bf16 v[108:111], v[58:61], v[160:163], 0
    v_perm_b32 v165, v146, v146, v205
    v_perm_b32 v166, v146, v146, v206
    v_perm_b32 v167, v146, v146, v207
    v_cvt_pk_bf16_f32 v152, v150, v151
    v_cvt_pk_bf16_f32 v74, v192, v193
    v_mfma_f32_16x16x32_bf16 v[120:123], v[70:73], v[164:167], 0
    v_cvt_pk_bf16_f32 v75, v194, v195
    v_perm_b32 v168, v152, v152, v204
    v_mfma_f32_16x16x32_bf16 v[116:119], v[60:63], v[164:167], 0
    v_perm_b32 v169, v152, v152, v205
    v_perm_b32 v170, v152, v152, v206
    v_perm_b32 v171, v152, v152, v207
    s_nop 1
    v_mfma_f32_16x16x32_bf16 v[128:131], v[72:75], v[168:171], 0
    v_mfma_f32_16x16x32_bf16 v[124:127], v[62:65], v[168:171], 0
    v_rcp_f32 v106, v106
    v_rcp_f32 v114, v114
    v_rcp_f32 v122, v122
    s_nop 3
    v_rcp_f32 v130, v130
    v_pk_mul_f32 v[100:101], v[100:101], v[106:107] op_sel_hi:[1,0]
    v_pk_mul_f32 v[102:103], v[102:103], v[106:107] op_sel_hi:[1,0]
    v_pk_mul_f32 v[104:105], v[104:105], v[106:107] op_sel_hi:[1,0]
    v_cvt_pk_bf16_f32 v16, v100, v101
    v_cvt_pk_bf16_f32 v17, v102, v103
    v_cvt_pk_bf16_f32 v24, v104, v105
    v_pk_mul_f32 v[108:109], v[108:109], v[114:115] op_sel_hi:[1,0]
    v_pk_mul_f32 v[110:111], v[110:111], v[114:115] op_sel_hi:[1,0]
    v_pk_mul_f32 v[112:113], v[112:113], v[114:115] op_sel_hi:[1,0]
    v_cvt_pk_bf16_f32 v18, v108, v109
    v_cvt_pk_bf16_f32 v19, v110, v111
    v_cvt_pk_bf16_f32 v25, v112, v113
    v_permlane16_swap_b32 v16, v18
    v_permlane16_swap_b32 v17, v19
    v_permlane16_swap_b32 v24, v25
    buffer_store_dwordx4 v[16:19], v220, s[28:31], s61 offen sc1
    v_pk_mul_f32 v[116:117], v[116:117], v[122:123] op_sel_hi:[1,0]
    v_pk_mul_f32 v[118:119], v[118:119], v[122:123] op_sel_hi:[1,0]
    v_pk_mul_f32 v[120:121], v[120:121], v[122:123] op_sel_hi:[1,0]
    v_cvt_pk_bf16_f32 v20, v116, v117
    v_cvt_pk_bf16_f32 v21, v118, v119
    v_cvt_pk_bf16_f32 v26, v120, v121
    v_pk_mul_f32 v[124:125], v[124:125], v[130:131] op_sel_hi:[1,0]
    v_pk_mul_f32 v[126:127], v[126:127], v[130:131] op_sel_hi:[1,0]
    v_pk_mul_f32 v[128:129], v[128:129], v[130:131] op_sel_hi:[1,0]
    v_cvt_pk_bf16_f32 v22, v124, v125
    v_cvt_pk_bf16_f32 v23, v126, v127
    v_cvt_pk_bf16_f32 v27, v128, v129
    v_permlane16_swap_b32 v20, v22
    v_permlane16_swap_b32 v21, v23
    v_permlane16_swap_b32 v26, v27
    buffer_store_dwordx4 v[20:23], v220, s[28:31], s62 offen sc1
    s_nop 0
    v_permlane32_swap_b32 v24, v26
    buffer_store_dword v24, v221, s[28:31], s63 offen sc1
    s_waitcnt vmcnt(21)
    s_barrier
    buffer_load_dwordx2 v[212:213], v227, s[8:11], 0 offen offset:0
    buffer_load_dwordx2 v[214:215], v227, s[8:11], 0 offen offset:32
    buffer_load_dwordx2 v[216:217], v227, s[8:11], 0 offen offset:64
    buffer_load_dwordx2 v[218:219], v227, s[8:11], 0 offen offset:96
    buffer_load_dwordx2 v[220:221], v227, s[8:11], 0 offen offset:128
    s_mul_i32 s6, s4, 165888
    s_add_u32 s6, s6, s48
    buffer_load_dword v231, v231, s[20:23], s6 offen
    buffer_load_dwordx2 v[222:223], v12, s[36:39], s48 offen
    s_getpc_b64 s[64:65]
    L_pc2:
    s_lshr_b32 s6, s2, 3
    s_lshl_b32 s6, s6, 2
    s_add_u32 s6, s6, s3
    s_mul_i32 s6, s6, 384
    v_min_u32 v232, 2, v0
    v_lshlrev_b32 v232, 7, v232
    v_add_u32 v232, s6, v232
    v_min_u32 v232, L_end-L_pc2, v232
    global_load_dword v253, v232, s[64:65]
    s_mul_i32 s6, s4, 73728
    s_lshl_b32 s7, s5, 7
    s_add_u32 s6, s6, s7
    s_mov_b64 exec, 1
    buffer_load_dword v253, off, s[32:35], s6
    buffer_load_dword v253, off, s[40:43], s7
    s_mov_b64 exec, -1
    s_lshl_b32 s61, s3, 10
    v_lshrrev_b32 v232, 3, v0
    v_and_b32 v233, 7, v0
    v_and_b32 v234, 6, v232
    v_xor_b32 v233, v233, v234
    v_lshlrev_b32 v233, 4, v233
    s_lshl_b32 s6, s3, 3
    v_add_u32 v234, s6, v232
    v_mul_u32_u24 v235, 9216, v234
    v_add_u32 v6, v235, v233
    v_mul_u32_u24 v235, 1152, v234
    v_add_u32 v8, v235, v233
    s_mul_i32 s6, s3, 72
    s_add_u32 s6, s6, 64
    v_add_u32 v234, s6, v232
    v_mul_u32_u24 v235, 9216, v234
    v_add_u32 v7, v235, v233
    ds_read_b64_tr_b16 a[0:1], v228 offset:32768
    ds_read_b64_tr_b16 a[2:3], v228 offset:35328
    ds_read_b64_tr_b16 a[4:5], v228 offset:32800
    ds_read_b64_tr_b16 a[6:7], v228 offset:35360
    ds_read_b64_tr_b16 a[8:9], v228 offset:32832
    ds_read_b64_tr_b16 a[10:11], v228 offset:35392
    ds_read_b64_tr_b16 a[12:13], v228 offset:32864
    ds_read_b64_tr_b16 a[14:15], v228 offset:35424
    ds_read_b64_tr_b16 a[16:17], v228 offset:32896
    ds_read_b64_tr_b16 a[18:19], v228 offset:35456
    ds_read_b64_tr_b16 a[20:21], v228 offset:37888
    ds_read_b64_tr_b16 a[22:23], v228 offset:40448
    ds_read_b64_tr_b16 a[24:25], v228 offset:37920
    ds_read_b64_tr_b16 a[26:27], v228 offset:40480
    ds_read_b64_tr_b16 a[28:29], v228 offset:37952
    ds_read_b64_tr_b16 a[30:31], v228 offset:40512
    ds_read_b64_tr_b16 a[32:33], v228 offset:37984
    ds_read_b64_tr_b16 a[34:35], v228 offset:40544
    ds_read_b64_tr_b16 a[36:37], v228 offset:38016
    ds_read_b64_tr_b16 a[38:39], v228 offset:40576
    ds_read_b64_tr_b16 a[40:41], v228 offset:43008
    ds_read_b64_tr_b16 a[42:43], v228 offset:45568
    ds_read_b64_tr_b16 a[44:45], v228 offset:43040
    ds_read_b64_tr_b16 a[46:47], v228 offset:45600
    ds_read_b64_tr_b16 a[48:49], v228 offset:43072
    ds_read_b64_tr_b16 a[50:51], v228 offset:45632
    ds_read_b64_tr_b16 a[52:53], v228 offset:43104
    ds_read_b64_tr_b16 a[54:55], v228 offset:45664
    ds_read_b64_tr_b16 a[56:57], v228 offset:43136
    ds_read_b64_tr_b16 a[58:59], v228 offset:45696
    ds_read_b64_tr_b16 a[60:61], v228 offset:49152
    ds_read_b64_tr_b16 a[62:63], v228 offset:51712
    ds_read_b64_tr_b16 a[64:65], v228 offset:49184
    ds_read_b64_tr_b16 a[66:67], v228 offset:51744
    ds_read_b64_tr_b16 a[68:69], v228 offset:49216
    ds_read_b64_tr_b16 a[70:71], v228 offset:51776
    ds_read_b64_tr_b16 a[72:73], v228 offset:49248
    ds_read_b64_tr_b16 a[74:75], v228 offset:51808
    ds_read_b64_tr_b16 a[76:77], v228 offset:49280
    ds_read_b64_tr_b16 a[78:79], v228 offset:51840
    ds_read_b64_tr_b16 a[80:81], v228 offset:54272
    ds_read_b64_tr_b16 a[82:83], v228 offset:56832
    ds_read_b64_tr_b16 a[84:85], v228 offset:54304
    ds_read_b64_tr_b16 a[86:87], v228 offset:56864
    ds_read_b64_tr_b16 a[88:89], v228 offset:54336
    ds_read_b64_tr_b16 a[90:91], v228 offset:56896
    ds_read_b64_tr_b16 a[92:93], v228 offset:54368
    ds_read_b64_tr_b16 a[94:95], v228 offset:56928
    ds_read_b64_tr_b16 a[96:97], v228 offset:54400
    ds_read_b64_tr_b16 a[98:99], v228 offset:56960
    ds_read_b64_tr_b16 a[100:101], v228 offset:59392
    ds_read_b64_tr_b16 a[102:103], v228 offset:61952
    ds_read_b64_tr_b16 a[104:105], v228 offset:59424
    ds_read_b64_tr_b16 a[106:107], v228 offset:61984
    ds_read_b64_tr_b16 a[108:109], v228 offset:59456
    ds_read_b64_tr_b16 a[110:111], v228 offset:62016
    ds_read_b64_tr_b16 a[112:113], v228 offset:59488
    ds_read_b64_tr_b16 a[114:115], v228 offset:62048
    ds_read_b64_tr_b16 a[116:117], v228 offset:59520
    ds_read_b64_tr_b16 a[118:119], v228 offset:62080
    s_waitcnt vmcnt(10)
    v_cmp_eq_u32 vcc, 0, v250
    s_cbranch_vccnz L_dslow_3
L_dback_4:
    s_barrier
    s_cmp_lg_u32 s3, 0
    s_cbranch_scc1 L_f1_5
    v_mov_b32 v249, 1
    s_mov_b64 exec, 1
    buffer_store_dword v249, off, s[28:31], s50 offset:0 sc1
    s_mov_b64 exec, -1
L_f1_5:
    v_and_b32 v3, 7, v0
    v_lshlrev_b32 v3, 2, v3
    ds_read_b64_tr_b16 a[120:121], v228 offset:0
    ds_read_b64_tr_b16 a[122:123], v228 offset:2560
    ds_read_b64_tr_b16 a[124:125], v228 offset:32
    ds_read_b64_tr_b16 a[126:127], v228 offset:2592
    ds_read_b64_tr_b16 a[128:129], v228 offset:64
    ds_read_b64_tr_b16 a[130:131], v228 offset:2624
    ds_read_b64_tr_b16 a[132:133], v228 offset:96
    ds_read_b64_tr_b16 a[134:135], v228 offset:2656
    ds_read_b64_tr_b16 a[136:137], v228 offset:128
    ds_read_b64_tr_b16 a[138:139], v228 offset:2688
    ds_read_b64_tr_b16 a[140:141], v228 offset:5120
    ds_read_b64_tr_b16 a[142:143], v228 offset:7680
    ds_read_b64_tr_b16 a[144:145], v228 offset:5152
    ds_read_b64_tr_b16 a[146:147], v228 offset:7712
    ds_read_b64_tr_b16 a[148:149], v228 offset:5184
    ds_read_b64_tr_b16 a[150:151], v228 offset:7744
    ds_read_b64_tr_b16 a[152:153], v228 offset:5216
    ds_read_b64_tr_b16 a[154:155], v228 offset:7776
    ds_read_b64_tr_b16 a[156:157], v228 offset:5248
    ds_read_b64_tr_b16 a[158:159], v228 offset:7808
    ds_read_b64_tr_b16 a[160:161], v228 offset:10240
    ds_read_b64_tr_b16 a[162:163], v228 offset:12800
    ds_read_b64_tr_b16 a[164:165], v228 offset:10272
    ds_read_b64_tr_b16 a[166:167], v228 offset:12832
    ds_read_b64_tr_b16 a[168:169], v228 offset:10304
    ds_read_b64_tr_b16 a[170:171], v228 offset:12864
    ds_read_b64_tr_b16 a[172:173], v228 offset:10336
    ds_read_b64_tr_b16 a[174:175], v228 offset:12896
    ds_read_b64_tr_b16 a[176:177], v228 offset:10368
    ds_read_b64_tr_b16 a[178:179], v228 offset:12928
    ds_read_b64_tr_b16 a[180:181], v228 offset:16384
    ds_read_b64_tr_b16 a[182:183], v228 offset:18944
    ds_read_b64_tr_b16 a[184:185], v228 offset:16416
    ds_read_b64_tr_b16 a[186:187], v228 offset:18976
    ds_read_b64_tr_b16 a[188:189], v228 offset:16448
    ds_read_b64_tr_b16 a[190:191], v228 offset:19008
    ds_read_b64_tr_b16 a[192:193], v228 offset:16480
    ds_read_b64_tr_b16 a[194:195], v228 offset:19040
    ds_read_b64_tr_b16 a[196:197], v228 offset:16512
    ds_read_b64_tr_b16 a[198:199], v228 offset:19072
    ds_read_b64_tr_b16 a[200:201], v228 offset:21504
    ds_read_b64_tr_b16 a[202:203], v228 offset:24064
    ds_read_b64_tr_b16 a[204:205], v228 offset:21536
    ds_read_b64_tr_b16 a[206:207], v228 offset:24096
    ds_read_b64_tr_b16 a[208:209], v228 offset:21568
    ds_read_b64_tr_b16 a[210:211], v228 offset:24128
    ds_read_b64_tr_b16 a[212:213], v228 offset:21600
    ds_read_b64_tr_b16 a[214:215], v228 offset:24160
    ds_read_b64_tr_b16 a[216:217], v228 offset:21632
    ds_read_b64_tr_b16 a[218:219], v228 offset:24192
    ds_read_b64_tr_b16 a[220:221], v228 offset:26624
    ds_read_b64_tr_b16 a[222:223], v228 offset:29184
    ds_read_b64_tr_b16 a[224:225], v228 offset:26656
    ds_read_b64_tr_b16 a[226:227], v228 offset:29216
    ds_read_b64_tr_b16 a[228:229], v228 offset:26688
    ds_read_b64_tr_b16 a[230:231], v228 offset:29248
    ds_read_b64_tr_b16 a[232:233], v228 offset:26720
    ds_read_b64_tr_b16 a[234:235], v228 offset:29280
    ds_read_b64_tr_b16 a[236:237], v228 offset:26752
    ds_read_b64_tr_b16 a[238:239], v228 offset:29312
    ds_read_b64_tr_b16 a[240:241], v229 offset:0
    ds_read_b64_tr_b16 a[242:243], v229 offset:2560
    ds_read_b64_tr_b16 a[244:245], v229 offset:32
    ds_read_b64_tr_b16 a[246:247], v229 offset:2592
    ds_read_b64_tr_b16 a[248:249], v229 offset:64
    ds_read_b64_tr_b16 a[250:251], v229 offset:2624
    ds_read_b64_tr_b16 a[252:253], v229 offset:96
    ds_read_b64_tr_b16 a[254:255], v229 offset:2656
    ds_read_b64_tr_b16 v[16:17], v229 offset:128
    ds_read_b64_tr_b16 v[18:19], v229 offset:2688
    ds_read_b64_tr_b16 v[20:21], v229 offset:5120
    ds_read_b64_tr_b16 v[22:23], v229 offset:7680
    ds_read_b64_tr_b16 v[24:25], v229 offset:5152
    ds_read_b64_tr_b16 v[26:27], v229 offset:7712
    ds_read_b64_tr_b16 v[28:29], v229 offset:5184
    ds_read_b64_tr_b16 v[30:31], v229 offset:7744
    ds_read_b64_tr_b16 v[32:33], v229 offset:5216
    ds_read_b64_tr_b16 v[34:35], v229 offset:7776
    ds_read_b64_tr_b16 v[36:37], v229 offset:5248
    ds_read_b64_tr_b16 v[38:39], v229 offset:7808
    ds_read_b64_tr_b16 v[40:41], v229 offset:10240
    ds_read_b64_tr_b16 v[42:43], v229 offset:12800
    ds_read_b64_tr_b16 v[44:45], v229 offset:10272
    ds_read_b64_tr_b16 v[46:47], v229 offset:12832
    ds_read_b64_tr_b16 v[48:49], v229 offset:10304
    ds_read_b64_tr_b16 v[50:51], v229 offset:12864
    ds_read_b64_tr_b16 v[52:53], v229 offset:10336
    ds_read_b64_tr_b16 v[54:55], v229 offset:12896
    ds_read_b64_tr_b16 v[56:57], v229 offset:10368
    ds_read_b64_tr_b16 v[58:59], v229 offset:12928
    ds_read_b64_tr_b16 v[60:61], v229 offset:16384
    ds_read_b64_tr_b16 v[62:63], v229 offset:18944
    ds_read_b64_tr_b16 v[64:65], v229 offset:16416
    ds_read_b64_tr_b16 v[66:67], v229 offset:18976
    ds_read_b64_tr_b16 v[68:69], v229 offset:16448
    ds_read_b64_tr_b16 v[70:71], v229 offset:19008
    ds_read_b64_tr_b16 v[72:73], v229 offset:16480
    ds_read_b64_tr_b16 v[74:75], v229 offset:19040
    ds_read_b64_tr_b16 v[76:77], v229 offset:16512
    ds_read_b64_tr_b16 v[78:79], v229 offset:19072
    v_lshlrev_b32 v15, 4, v0
    v_lshlrev_b32 v12, 3, v0
    s_lshl_b32 s6, s3, 14
    s_add_u32 s59, s6, 65536
    s_add_u32 s55, s6, 131072
    s_lshr_b32 s6, s6, 2
    s_add_u32 s57, s6, 16384
    s_lshr_b32 s6, s6, 1
    s_add_u32 s56, s6, 8192
    s_mov_b64 exec, 255
    s_mov_b32 s6, 0
L_poll_7:
    buffer_load_dword v249, v3, s[28:31], 0 offen offset:0 sc1
    s_add_u32 s6, s6, 1
    s_cmp_gt_u32 s6, 0x200000
    s_cbranch_scc1 L_polle_8
    s_waitcnt vmcnt(0)
    v_cmp_gt_u32 vcc, 1, v249
    s_cbranch_vccnz L_poll_7
L_polle_8:
    s_mov_b64 exec, -1
L_ep_6:
    buffer_load_dwordx4 v[120:123], v15, s[28:31], s59 offen offset:0 sc1
    buffer_load_dwordx4 v[124:127], v15, s[28:31], s59 offen offset:1024 sc1
    buffer_load_dwordx4 v[128:131], v15, s[28:31], s59 offen offset:2048 sc1
    buffer_load_dwordx4 v[132:135], v15, s[28:31], s59 offen offset:3072 sc1
    s_add_u32 s59, s59, 4096
    buffer_load_dwordx4 v[136:139], v15, s[28:31], s59 offen offset:0 sc1
    buffer_load_dwordx4 v[140:143], v15, s[28:31], s59 offen offset:1024 sc1
    buffer_load_dwordx4 v[144:147], v15, s[28:31], s59 offen offset:2048 sc1
    buffer_load_dwordx4 v[148:151], v15, s[28:31], s59 offen offset:3072 sc1
    s_add_u32 s59, s59, 4096
    buffer_load_dwordx4 v[152:155], v15, s[28:31], s59 offen offset:0 sc1
    buffer_load_dwordx4 v[156:159], v15, s[28:31], s59 offen offset:1024 sc1
    buffer_load_dwordx4 v[160:163], v15, s[28:31], s59 offen offset:2048 sc1
    buffer_load_dwordx4 v[164:167], v15, s[28:31], s59 offen offset:3072 sc1
    s_waitcnt vmcnt(12)
    ds_read_b64_tr_b16 v[80:81], v229 offset:21504
    ds_read_b64_tr_b16 v[82:83], v229 offset:24064
    ds_read_b64_tr_b16 v[84:85], v229 offset:21536
    ds_read_b64_tr_b16 v[86:87], v229 offset:24096
    ds_read_b64_tr_b16 v[88:89], v229 offset:21568
    ds_read_b64_tr_b16 v[90:91], v229 offset:24128
    ds_read_b64_tr_b16 v[92:93], v229 offset:21600
    ds_read_b64_tr_b16 v[94:95], v229 offset:24160
    ds_read_b64_tr_b16 v[96:97], v229 offset:21632
    ds_read_b64_tr_b16 v[98:99], v229 offset:24192
    ds_read_b64_tr_b16 v[100:101], v229 offset:26624
    ds_read_b64_tr_b16 v[102:103], v229 offset:29184
    ds_read_b64_tr_b16 v[104:105], v229 offset:26656
    ds_read_b64_tr_b16 v[106:107], v229 offset:29216
    ds_read_b64_tr_b16 v[108:109], v229 offset:26688
    ds_read_b64_tr_b16 v[110:111], v229 offset:29248
    ds_read_b64_tr_b16 v[112:113], v229 offset:26720
    ds_read_b64_tr_b16 v[114:115], v229 offset:29280
    ds_read_b64_tr_b16 v[116:117], v229 offset:26752
    ds_read_b64_tr_b16 v[118:119], v229 offset:29312
    v_lshlrev_b32 v192, 16, v212
    v_and_b32 v193, s49, v212
    v_lshlrev_b32 v194, 16, v213
    v_and_b32 v195, s49, v213
    v_lshlrev_b32 v196, 16, v214
    v_and_b32 v197, s49, v214
    v_lshlrev_b32 v198, 16, v215
    v_and_b32 v199, s49, v215
    v_lshlrev_b32 v200, 16, v216
    v_and_b32 v201, s49, v216
    v_lshlrev_b32 v202, 16, v217
    v_and_b32 v203, s49, v217
    v_lshlrev_b32 v204, 16, v218
    v_and_b32 v205, s49, v218
    v_lshlrev_b32 v206, 16, v219
    v_and_b32 v207, s49, v219
    v_lshlrev_b32 v208, 16, v220
    v_and_b32 v209, s49, v220
    v_lshlrev_b32 v210, 16, v221
    v_and_b32 v211, s49, v221
    s_waitcnt lgkmcnt(15)
    s_waitcnt vmcnt(11)
    v_mfma_f32_16x16x32_bf16 v[192:195], a[0:3], v[120:123], v[192:195]
    s_add_u32 s59, s59, 4096
    buffer_load_dwordx4 v[168:171], v15, s[28:31], s59 offen offset:0 sc1
    v_mfma_f32_16x16x32_bf16 v[196:199], a[4:7], v[120:123], v[196:199]
    v_mfma_f32_16x16x32_bf16 v[200:203], a[8:11], v[120:123], v[200:203]
    buffer_load_dwordx4 v[172:175], v15, s[28:31], s59 offen offset:1024 sc1
    v_mfma_f32_16x16x32_bf16 v[204:207], a[12:15], v[120:123], v[204:207]
    v_mfma_f32_16x16x32_bf16 v[208:211], a[16:19], v[120:123], v[208:211]
    s_waitcnt vmcnt(12)
    v_mfma_f32_16x16x32_bf16 v[192:195], a[20:23], v[124:127], v[192:195]
    buffer_load_dwordx4 v[176:179], v15, s[28:31], s59 offen offset:2048 sc1
    v_mfma_f32_16x16x32_bf16 v[196:199], a[24:27], v[124:127], v[196:199]
    v_mfma_f32_16x16x32_bf16 v[200:203], a[28:31], v[124:127], v[200:203]
    buffer_load_dwordx4 v[180:183], v15, s[28:31], s59 offen offset:3072 sc1
    v_mfma_f32_16x16x32_bf16 v[204:207], a[32:35], v[124:127], v[204:207]
    v_mfma_f32_16x16x32_bf16 v[208:211], a[36:39], v[124:127], v[208:211]
    s_waitcnt vmcnt(13)
    v_mfma_f32_16x16x32_bf16 v[192:195], a[40:43], v[128:131], v[192:195]
    buffer_load_dword v184, v230, s[28:31], s56 offen offset:0 sc1
    v_mfma_f32_16x16x32_bf16 v[196:199], a[44:47], v[128:131], v[196:199]
    v_mfma_f32_16x16x32_bf16 v[200:203], a[48:51], v[128:131], v[200:203]
    buffer_load_dword v185, v230, s[28:31], s56 offen offset:64 sc1
    v_mfma_f32_16x16x32_bf16 v[204:207], a[52:55], v[128:131], v[204:207]
    v_mfma_f32_16x16x32_bf16 v[208:211], a[56:59], v[128:131], v[208:211]
    s_waitcnt vmcnt(14)
    v_mfma_f32_16x16x32_bf16 v[192:195], a[60:63], v[132:135], v[192:195]
    buffer_load_dword v186, v230, s[28:31], s56 offen offset:128 sc1
    v_mfma_f32_16x16x32_bf16 v[196:199], a[64:67], v[132:135], v[196:199]
    v_mfma_f32_16x16x32_bf16 v[200:203], a[68:71], v[132:135], v[200:203]
    buffer_load_dword v187, v230, s[28:31], s56 offen offset:192 sc1
    v_mfma_f32_16x16x32_bf16 v[204:207], a[72:75], v[132:135], v[204:207]
    v_mfma_f32_16x16x32_bf16 v[208:211], a[76:79], v[132:135], v[208:211]
    s_waitcnt lgkmcnt(0)
    s_barrier
    s_waitcnt vmcnt(15)
    v_mfma_f32_16x16x32_bf16 v[192:195], a[80:83], v[136:139], v[192:195]
    buffer_load_dword v188, v230, s[28:31], s56 offen offset:1024 sc1
    v_mfma_f32_16x16x32_bf16 v[196:199], a[84:87], v[136:139], v[196:199]
    v_mfma_f32_16x16x32_bf16 v[200:203], a[88:91], v[136:139], v[200:203]
    buffer_load_dword v189, v230, s[28:31], s56 offen offset:1088 sc1
    v_mfma_f32_16x16x32_bf16 v[204:207], a[92:95], v[136:139], v[204:207]
    v_mfma_f32_16x16x32_bf16 v[208:211], a[96:99], v[136:139], v[208:211]
    s_waitcnt vmcnt(16)
    v_mfma_f32_16x16x32_bf16 v[192:195], a[100:103], v[140:143], v[192:195]
    buffer_load_dword v190, v230, s[28:31], s56 offen offset:1152 sc1
    v_mfma_f32_16x16x32_bf16 v[196:199], a[104:107], v[140:143], v[196:199]
    v_mfma_f32_16x16x32_bf16 v[200:203], a[108:111], v[140:143], v[200:203]
    buffer_load_dword v191, v230, s[28:31], s56 offen offset:1216 sc1
    v_mfma_f32_16x16x32_bf16 v[204:207], a[112:115], v[140:143], v[204:207]
    v_mfma_f32_16x16x32_bf16 v[208:211], a[116:119], v[140:143], v[208:211]
    s_waitcnt vmcnt(17)
    v_mfma_f32_16x16x32_bf16 v[192:195], a[120:123], v[144:147], v[192:195]
    v_mfma_f32_16x16x32_bf16 v[196:199], a[124:127], v[144:147], v[196:199]
    v_mfma_f32_16x16x32_bf16 v[200:203], a[128:131], v[144:147], v[200:203]
    v_mfma_f32_16x16x32_bf16 v[204:207], a[132:135], v[144:147], v[204:207]
    v_mfma_f32_16x16x32_bf16 v[208:211], a[136:139], v[144:147], v[208:211]
    s_waitcnt vmcnt(16)
    v_mfma_f32_16x16x32_bf16 v[192:195], a[140:143], v[148:151], v[192:195]
    v_mfma_f32_16x16x32_bf16 v[196:199], a[144:147], v[148:151], v[196:199]
    v_mfma_f32_16x16x32_bf16 v[200:203], a[148:151], v[148:151], v[200:203]
    v_mfma_f32_16x16x32_bf16 v[204:207], a[152:155], v[148:151], v[204:207]
    v_mfma_f32_16x16x32_bf16 v[208:211], a[156:159], v[148:151], v[208:211]
    s_waitcnt vmcnt(15)
    v_mfma_f32_16x16x32_bf16 v[192:195], a[160:163], v[152:155], v[192:195]
    v_mfma_f32_16x16x32_bf16 v[196:199], a[164:167], v[152:155], v[196:199]
    v_mfma_f32_16x16x32_bf16 v[200:203], a[168:171], v[152:155], v[200:203]
    v_mfma_f32_16x16x32_bf16 v[204:207], a[172:175], v[152:155], v[204:207]
    v_mfma_f32_16x16x32_bf16 v[208:211], a[176:179], v[152:155], v[208:211]
    s_waitcnt vmcnt(14)
    v_mfma_f32_16x16x32_bf16 v[192:195], a[180:183], v[156:159], v[192:195]
    v_mfma_f32_16x16x32_bf16 v[196:199], a[184:187], v[156:159], v[196:199]
    v_mfma_f32_16x16x32_bf16 v[200:203], a[188:191], v[156:159], v[200:203]
    v_mfma_f32_16x16x32_bf16 v[204:207], a[192:195], v[156:159], v[204:207]
    v_mfma_f32_16x16x32_bf16 v[208:211], a[196:199], v[156:159], v[208:211]
    s_waitcnt vmcnt(13)
    v_mfma_f32_16x16x32_bf16 v[192:195], a[200:203], v[160:163], v[192:195]
    v_mfma_f32_16x16x32_bf16 v[196:199], a[204:207], v[160:163], v[196:199]
    v_mfma_f32_16x16x32_bf16 v[200:203], a[208:211], v[160:163], v[200:203]
    v_mfma_f32_16x16x32_bf16 v[204:207], a[212:215], v[160:163], v[204:207]
    v_mfma_f32_16x16x32_bf16 v[208:211], a[216:219], v[160:163], v[208:211]
    s_waitcnt vmcnt(12)
    v_mfma_f32_16x16x32_bf16 v[192:195], a[220:223], v[164:167], v[192:195]
    v_mfma_f32_16x16x32_bf16 v[196:199], a[224:227], v[164:167], v[196:199]
    v_mfma_f32_16x16x32_bf16 v[200:203], a[228:231], v[164:167], v[200:203]
    v_mfma_f32_16x16x32_bf16 v[204:207], a[232:235], v[164:167], v[204:207]
    v_mfma_f32_16x16x32_bf16 v[208:211], a[236:239], v[164:167], v[208:211]
    s_waitcnt vmcnt(11)
    v_mfma_f32_16x16x32_bf16 v[192:195], a[240:243], v[168:171], v[192:195]
    v_mfma_f32_16x16x32_bf16 v[196:199], a[244:247], v[168:171], v[196:199]
    v_mfma_f32_16x16x32_bf16 v[200:203], a[248:251], v[168:171], v[200:203]
    v_mfma_f32_16x16x32_bf16 v[204:207], a[252:255], v[168:171], v[204:207]
    v_mfma_f32_16x16x32_bf16 v[208:211], v[16:19], v[168:171], v[208:211]
    s_waitcnt vmcnt(10)
    v_mfma_f32_16x16x32_bf16 v[192:195], v[20:23], v[172:175], v[192:195]
    v_mfma_f32_16x16x32_bf16 v[196:199], v[24:27], v[172:175], v[196:199]
    v_mfma_f32_16x16x32_bf16 v[200:203], v[28:31], v[172:175], v[200:203]
    v_mfma_f32_16x16x32_bf16 v[204:207], v[32:35], v[172:175], v[204:207]
    v_mfma_f32_16x16x32_bf16 v[208:211], v[36:39], v[172:175], v[208:211]
    s_waitcnt vmcnt(9)
    v_mfma_f32_16x16x32_bf16 v[192:195], v[40:43], v[176:179], v[192:195]
    v_mfma_f32_16x16x32_bf16 v[196:199], v[44:47], v[176:179], v[196:199]
    v_mfma_f32_16x16x32_bf16 v[200:203], v[48:51], v[176:179], v[200:203]
    v_mfma_f32_16x16x32_bf16 v[204:207], v[52:55], v[176:179], v[204:207]
    v_mfma_f32_16x16x32_bf16 v[208:211], v[56:59], v[176:179], v[208:211]
    s_waitcnt vmcnt(8)
    v_mfma_f32_16x16x32_bf16 v[192:195], v[60:63], v[180:183], v[192:195]
    v_mfma_f32_16x16x32_bf16 v[196:199], v[64:67], v[180:183], v[196:199]
    v_mfma_f32_16x16x32_bf16 v[200:203], v[68:71], v[180:183], v[200:203]
    v_mfma_f32_16x16x32_bf16 v[204:207], v[72:75], v[180:183], v[204:207]
    v_mfma_f32_16x16x32_bf16 v[208:211], v[76:79], v[180:183], v[208:211]
    s_waitcnt vmcnt(4)
    v_mfma_f32_16x16x32_bf16 v[192:195], v[80:83], v[184:187], v[192:195]
    v_mfma_f32_16x16x32_bf16 v[196:199], v[84:87], v[184:187], v[196:199]
    v_mfma_f32_16x16x32_bf16 v[200:203], v[88:91], v[184:187], v[200:203]
    v_mfma_f32_16x16x32_bf16 v[204:207], v[92:95], v[184:187], v[204:207]
    v_mfma_f32_16x16x32_bf16 v[208:211], v[96:99], v[184:187], v[208:211]
    s_waitcnt vmcnt(0)
    v_mfma_f32_16x16x32_bf16 v[192:195], v[100:103], v[188:191], v[192:195]
    v_mfma_f32_16x16x32_bf16 v[196:199], v[104:107], v[188:191], v[196:199]
    v_mfma_f32_16x16x32_bf16 v[200:203], v[108:111], v[188:191], v[200:203]
    v_mfma_f32_16x16x32_bf16 v[204:207], v[112:115], v[188:191], v[204:207]
    v_mfma_f32_16x16x32_bf16 v[208:211], v[116:119], v[188:191], v[208:211]
    s_lshl_b32 s6, s5, 11
    s_add_u32 s6, s6, s55
    s_lshl_b32 s7, s5, 9
    s_add_u32 s7, s7, s57
    v_cvt_pk_bf16_f32 v212, v192, v193
    v_cvt_pk_bf16_f32 v213, v194, v195
    v_cvt_pk_bf16_f32 v214, v196, v197
    v_cvt_pk_bf16_f32 v215, v198, v199
    buffer_store_dwordx4 v[212:215], v15, s[28:31], s6 offen offset:0 sc1
    v_cvt_pk_bf16_f32 v216, v200, v201
    v_cvt_pk_bf16_f32 v217, v202, v203
    v_cvt_pk_bf16_f32 v218, v204, v205
    v_cvt_pk_bf16_f32 v219, v206, v207
    buffer_store_dwordx4 v[216:219], v15, s[28:31], s6 offen offset:1024 sc1
    v_cvt_pk_bf16_f32 v220, v208, v209
    v_cvt_pk_bf16_f32 v221, v210, v211
    v_pk_mul_f32 v[122:123], v[192:193], v[192:193]
    v_pk_fma_f32 v[122:123], v[194:195], v[194:195], v[122:123]
    v_pk_add_f32 v[120:121], v[194:195], v[192:193]
    v_pk_fma_f32 v[122:123], v[196:197], v[196:197], v[122:123]
    v_pk_add_f32 v[120:121], v[196:197], v[120:121]
    v_pk_fma_f32 v[122:123], v[198:199], v[198:199], v[122:123]
    v_pk_add_f32 v[120:121], v[198:199], v[120:121]
    v_pk_fma_f32 v[122:123], v[200:201], v[200:201], v[122:123]
    v_pk_add_f32 v[120:121], v[200:201], v[120:121]
    v_pk_fma_f32 v[122:123], v[202:203], v[202:203], v[122:123]
    v_pk_add_f32 v[120:121], v[202:203], v[120:121]
    v_pk_fma_f32 v[122:123], v[204:205], v[204:205], v[122:123]
    v_pk_add_f32 v[120:121], v[204:205], v[120:121]
    v_pk_fma_f32 v[122:123], v[206:207], v[206:207], v[122:123]
    v_pk_add_f32 v[120:121], v[206:207], v[120:121]
    s_mov_b32 exec_hi, 0
    v_pk_fma_f32 v[122:123], v[208:209], v[208:209], v[122:123]
    v_pk_add_f32 v[120:121], v[208:209], v[120:121]
    v_pk_fma_f32 v[122:123], v[210:211], v[210:211], v[122:123]
    v_pk_add_f32 v[120:121], v[210:211], v[120:121]
    s_mov_b32 exec_hi, -1
    v_add_f32 v124, v120, v121
    v_add_f32 v125, v122, v123
    v_add_f32 v120, v120, v121
    v_add_f32 v121, v122, v123
    s_nop 0
    v_permlane16_swap_b32 v120, v124
    v_permlane16_swap_b32 v121, v125
    v_pk_add_f32 v[120:121], v[120:121], v[124:125]
    s_nop 1
    v_permlane32_swap_b32 v220, v120
    v_permlane32_swap_b32 v221, v121
    s_mov_b32 exec_lo, 0
    v_pk_add_f32 v[220:221], v[220:221], v[120:121]
    s_mov_b32 exec_lo, -1
    buffer_store_dwordx2 v[220:221], v12, s[28:31], s7 offen sc1
    s_add_u32 m0, s61, 98304
    s_add_u32 s58, s48, 0
    buffer_load_dwordx4 v6, s[20:23], s58 offen lds
    s_add_u32 m0, s61, 102400
    s_add_u32 s58, s48, 294912
    buffer_load_dwordx4 v6, s[20:23], s58 offen lds
    s_add_u32 m0, s61, 106496
    s_add_u32 s58, s48, 663552
    buffer_load_dwordx4 v6, s[20:23], s58 offen lds
    s_add_u32 m0, s61, 110592
    s_add_u32 s58, s48, 958464
    buffer_load_dwordx4 v6, s[20:23], s58 offen lds
    s_add_u32 m0, s61, 114688
    s_add_u32 s58, s48, 1327104
    buffer_load_dwordx4 v6, s[20:23], s58 offen lds
    s_add_u32 m0, s61, 118784
    s_add_u32 s58, s48, 1622016
    buffer_load_dwordx4 v6, s[20:23], s58 offen lds
    s_add_u32 m0, s61, 122880
    s_add_u32 s58, s48, 1990656
    buffer_load_dwordx4 v6, s[20:23], s58 offen lds
    s_add_u32 m0, s61, 126976
    s_add_u32 s58, s48, 2285568
    buffer_load_dwordx4 v6, s[20:23], s58 offen lds
    v_add_u32 v20, s61, v15
    v_add_u32 v21, 0x10000, v20
    v_lshrrev_b32 v16, 5, v0
    v_lshl_add_u32 v12, v16, 8, v12
    v_lshlrev_b32 v19, 10, v2
    v_lshl_add_u32 v19, v1, 3, v19
    v_mov_b32 v124, v251
    v_mov_b32 v125, v252
    v_lshlrev_b32 v96, 16, v222
    v_and_b32 v97, s49, v222
    v_lshlrev_b32 v98, 16, v223
    v_and_b32 v99, s49, v223
    v_mov_b32 v100, 0xbeeff558
    s_nop 1
    v_mul_f32_dpp v128, v96, v100 row_newbcast:0 row_mask:0xf bank_mask:0xf
    v_mul_f32_dpp v129, v97, v100 row_newbcast:0 row_mask:0xf bank_mask:0xf
    v_mul_f32_dpp v130, v98, v100 row_newbcast:0 row_mask:0xf bank_mask:0xf
    v_mul_f32_dpp v131, v99, v100 row_newbcast:0 row_mask:0xf bank_mask:0xf
    v_mul_f32_dpp v132, v96, v100 row_newbcast:1 row_mask:0xf bank_mask:0xf
    v_mul_f32_dpp v133, v97, v100 row_newbcast:1 row_mask:0xf bank_mask:0xf
    v_mul_f32_dpp v134, v98, v100 row_newbcast:1 row_mask:0xf bank_mask:0xf
    v_mul_f32_dpp v135, v99, v100 row_newbcast:1 row_mask:0xf bank_mask:0xf
    v_mul_f32_dpp v136, v96, v100 row_newbcast:2 row_mask:0xf bank_mask:0xf
    v_mul_f32_dpp v137, v97, v100 row_newbcast:2 row_mask:0xf bank_mask:0xf
    v_mul_f32_dpp v138, v98, v100 row_newbcast:2 row_mask:0xf bank_mask:0xf
    v_mul_f32_dpp v139, v99, v100 row_newbcast:2 row_mask:0xf bank_mask:0xf
    v_mul_f32_dpp v140, v96, v100 row_newbcast:3 row_mask:0xf bank_mask:0xf
    v_mul_f32_dpp v141, v97, v100 row_newbcast:3 row_mask:0xf bank_mask:0xf
    v_mul_f32_dpp v142, v98, v100 row_newbcast:3 row_mask:0xf bank_mask:0xf
    v_mul_f32_dpp v143, v99, v100 row_newbcast:3 row_mask:0xf bank_mask:0xf
    v_mul_f32_dpp v144, v96, v100 row_newbcast:4 row_mask:0xf bank_mask:0xf
    v_mul_f32_dpp v145, v97, v100 row_newbcast:4 row_mask:0xf bank_mask:0xf
    v_mul_f32_dpp v146, v98, v100 row_newbcast:4 row_mask:0xf bank_mask:0xf
    v_mul_f32_dpp v147, v99, v100 row_newbcast:4 row_mask:0xf bank_mask:0xf
    v_mul_f32_dpp v148, v96, v100 row_newbcast:5 row_mask:0xf bank_mask:0xf
    v_mul_f32_dpp v149, v97, v100 row_newbcast:5 row_mask:0xf bank_mask:0xf
    v_mul_f32_dpp v150, v98, v100 row_newbcast:5 row_mask:0xf bank_mask:0xf
    v_mul_f32_dpp v151, v99, v100 row_newbcast:5 row_mask:0xf bank_mask:0xf
    v_mul_f32_dpp v152, v96, v100 row_newbcast:6 row_mask:0xf bank_mask:0xf
    v_mul_f32_dpp v153, v97, v100 row_newbcast:6 row_mask:0xf bank_mask:0xf
    v_mul_f32_dpp v154, v98, v100 row_newbcast:6 row_mask:0xf bank_mask:0xf
    v_mul_f32_dpp v155, v99, v100 row_newbcast:6 row_mask:0xf bank_mask:0xf
    v_mul_f32_dpp v156, v96, v100 row_newbcast:7 row_mask:0xf bank_mask:0xf
    v_mul_f32_dpp v157, v97, v100 row_newbcast:7 row_mask:0xf bank_mask:0xf
    v_mul_f32_dpp v158, v98, v100 row_newbcast:7 row_mask:0xf bank_mask:0xf
    v_mul_f32_dpp v159, v99, v100 row_newbcast:7 row_mask:0xf bank_mask:0xf
    v_mul_f32_dpp v160, v96, v100 row_newbcast:8 row_mask:0xf bank_mask:0xf
    v_mul_f32_dpp v161, v97, v100 row_newbcast:8 row_mask:0xf bank_mask:0xf
    v_mul_f32_dpp v162, v98, v100 row_newbcast:8 row_mask:0xf bank_mask:0xf
    v_mul_f32_dpp v163, v99, v100 row_newbcast:8 row_mask:0xf bank_mask:0xf
    s_waitcnt vmcnt(8)
    v_mov_b32 v22, 1
    s_mov_b64 exec, 1
    buffer_store_dword v22, off, s[28:31], s50 offset:128 sc1
    s_mov_b64 exec, -1
    s_add_u32 m0, s61, 131072
    s_add_u32 s58, s48, 2654208
    buffer_load_dwordx4 v6, s[20:23], s58 offen lds
    s_add_u32 m0, s61, 135168
    s_add_u32 s58, s48, 2949120
    buffer_load_dwordx4 v6, s[20:23], s58 offen lds
    s_add_u32 m0, s61, 139264
    s_add_u32 s58, s48, 3317760
    buffer_load_dwordx4 v6, s[20:23], s58 offen lds
    s_add_u32 m0, s61, 143360
    s_add_u32 s58, s48, 3612672
    buffer_load_dwordx4 v6, s[20:23], s58 offen lds
    s_add_u32 m0, s61, 147456
    s_add_u32 s58, s48, 3981312
    buffer_load_dwordx4 v6, s[20:23], s58 offen lds
    s_add_u32 m0, s61, 151552
    s_add_u32 s58, s48, 4276224
    buffer_load_dwordx4 v6, s[20:23], s58 offen lds
    s_add_u32 m0, s61, 155648
    s_add_u32 s58, s48, 4644864
    buffer_load_dwordx4 v6, s[20:23], s58 offen lds
    s_add_u32 m0, s61, 159744
    s_add_u32 s58, s48, 4939776
    buffer_load_dwordx4 v6, s[20:23], s58 offen lds
    s_add_u32 m0, s61, 73728
    s_add_u32 s58, s48, 0
    buffer_load_dwordx4 v7, s[20:23], s58 offen lds
    s_add_u32 m0, s61, 77824
    s_add_u32 s58, s48, 2654208
    buffer_load_dwordx4 v7, s[20:23], s58 offen lds
    s_add_u32 m0, s61, 81920
    s_add_u32 s58, s48, 128
    buffer_load_dwordx4 v6, s[20:23], s58 offen lds
    s_add_u32 m0, s61, 86016
    s_add_u32 s58, s48, 295040
    buffer_load_dwordx4 v6, s[20:23], s58 offen lds
    s_add_u32 m0, s61, 90112
    s_add_u32 s58, s48, 663680
    buffer_load_dwordx4 v6, s[20:23], s58 offen lds
    s_add_u32 m0, s61, 94208
    s_add_u32 s58, s48, 958592
    buffer_load_dwordx4 v6, s[20:23], s58 offen lds
    v_lshrrev_b32 v96, 2, v0
    v_bfe_u32 v97, v96, 1, 2
    v_xor_b32 v97, s3, v97
    v_lshlrev_b32 v97, 5, v97
    v_lshl_add_u32 v97, v96, 7, v97
    v_and_b32 v98, 3, v0
    v_lshl_add_u32 v4, v98, 3, v97
    v_add_u32 v5, 0x10000, v4
    v_add_u32 v240, 0x20000, v4
    s_lshr_b32 s6, s3, 1
    s_lshl_b32 s6, s6, 12
    s_and_b32 s7, s3, 1
    s_lshl_b32 s7, s7, 3
    s_add_u32 s6, s6, s7
    s_add_u32 s6, s6, 65536
    v_add_u32 v10, s6, v15
    s_lshl_b32 s6, s3, 12
    v_add_u32 v9, s6, v15
    v_add_u32 v11, 0x10000, v15
    s_lshr_b32 s6, s3, 1
    s_mul_i32 s6, s6, 55296
    v_add_u32 v242, s6, v8
    v_and_b32 v96, 3, v1
    v_lshlrev_b32 v96, 4, v96
    v_lshl_add_u32 v96, v2, 6, v96
    v_lshrrev_b32 v97, 2, v1
    v_lshl_add_u32 v243, v97, 8, v96
    v_mul_u32_u24 v97, 73728, v97
    v_add_u32 v244, v97, v96
    v_sub_u32 v96, s5, v0
    v_and_b32 v96, 7, v96
    v_lshlrev_b32 v245, 10, v96
    s_lshl_b32 s6, s5, 4
    s_lshl_b32 s7, s3, 2
    s_add_u32 s6, s6, s7
    v_add_u32 v96, s6, v2
    v_mul_u32_u24 v97, 3641, v96
    v_lshrrev_b32 v97, 16, v97
    v_mul_u32_u24 v98, 18, v97
    v_sub_u32 v98, v96, v98
    v_lshrrev_b32 v99, 3, v98
    v_lshl_add_u32 v99, v97, 1, v99
    v_lshlrev_b32 v99, 10, v99
    v_and_b32 v100, 3, v98
    v_lshl_add_u32 v100, v100, 4, v1
    v_lshl_add_u32 v99, v100, 4, v99
    v_bfe_u32 v101, v98, 2, 1
    v_lshl_add_u32 v99, v101, 3, v99
    v_add_u32 v99, 131072, v99
    v_lshlrev_b32 v100, 3, v100
    v_lshl_add_u32 v100, v97, 9, v100
    v_add_u32 v100, 16384, v100
    v_cmp_gt_u32 vcc, 16, v98
    v_mov_b32 v101, 4096
    v_mov_b32 v102, 16384
    v_cndmask_b32 v248, v100, v99, vcc
    v_cndmask_b32 v101, v101, v102, vcc
    v_add_u32 v249, v248, v101
    v_add_u32 v250, v249, v101
    v_add_u32 v251, v250, v101
    v_lshlrev_b32 v13, 3, v96
    s_and_b32 s6, s5, 3
    s_lshl_b32 s6, s6, 2
    v_and_b32 v104, 3, v1
    v_add_u32 v104, s6, v104
    s_lshr_b32 s6, s5, 2
    s_lshl_b32 s6, s6, 1
    v_bfe_u32 v105, v1, 2, 1
    v_add_u32 v105, s6, v105
    s_mov_b32 s6, 128
    s_lshl_b32 s7, s3, 2
    s_add_u32 s6, s6, s7
    v_add_u32 v96, s6, v2
    v_mul_u32_u24 v97, 3641, v96
    v_lshrrev_b32 v97, 16, v97
    v_mul_u32_u24 v98, 18, v97
    v_sub_u32 v98, v96, v98
    v_lshrrev_b32 v99, 3, v98
    v_lshl_add_u32 v99, v97, 1, v99
    v_lshlrev_b32 v99, 10, v99
    v_and_b32 v100, 3, v98
    v_lshl_add_u32 v100, v100, 4, v104
    v_lshl_add_u32 v99, v100, 4, v99
    v_bfe_u32 v101, v98, 2, 1
    v_lshl_add_u32 v99, v101, 3, v99
    v_add_u32 v99, 131072, v99
    v_lshlrev_b32 v100, 3, v100
    v_lshl_add_u32 v100, v97, 9, v100
    v_add_u32 v100, 16384, v100
    v_cmp_gt_u32 vcc, 16, v98
    v_mov_b32 v101, 4096
    v_mov_b32 v102, 16384
    v_cndmask_b32 v252, v100, v99, vcc
    v_cndmask_b32 v101, v101, v102, vcc
    v_mad_u32_u24 v252, v101, v105, v252
    v_lshlrev_b32 v14, 3, v96
    s_mov_b32 s62, 0x409d30fc
    s_mov_b32 s63, s62
    s_lshl_b32 s6, s4, 6
    v_add_u32 v96, s6, v1
    v_mul_u32_u24 v96, 1152, v96
    v_add_u32 v253, v96, v13
    v_lshl_add_u32 v104, v105, 4, v104
    v_add_u32 v104, s6, v104
    v_mul_u32_u24 v104, 1152, v104
    v_add_u32 v254, v104, v14
    s_mov_b64 exec, 255
    s_mov_b32 s6, 0
L_poll_9:
    buffer_load_dword v22, v3, s[28:31], s52 offen offset:128 sc1
    s_add_u32 s6, s6, 1
    s_cmp_gt_u32 s6, 0x200000
    s_cbranch_scc1 L_polle_10
    s_waitcnt vmcnt(0)
    v_cmp_gt_u32 vcc, 1, v22
    s_cbranch_vccnz L_poll_9
L_polle_10:
    s_mov_b64 exec, -1
    buffer_load_dwordx2 v[116:117], v19, s[28:31], s57 offen offset:256 sc1
    buffer_load_dwordx2 v[118:119], v19, s[28:31], s57 offen offset:768 sc1
    buffer_load_dwordx4 v[24:27], v15, s[28:31], s55 offen offset:0 sc1
    buffer_load_dwordx4 v[28:31], v15, s[28:31], s55 offen offset:1024 sc1
    buffer_load_dwordx4 v[32:35], v15, s[28:31], s55 offen offset:2048 sc1
    buffer_load_dwordx4 v[36:39], v15, s[28:31], s55 offen offset:3072 sc1
    s_add_u32 s55, s55, 4096
    buffer_load_dwordx4 v[40:43], v15, s[28:31], s55 offen offset:0 sc1
    buffer_load_dwordx4 v[44:47], v15, s[28:31], s55 offen offset:1024 sc1
    buffer_load_dwordx4 v[48:51], v15, s[28:31], s55 offen offset:2048 sc1
    buffer_load_dwordx4 v[52:55], v15, s[28:31], s55 offen offset:3072 sc1
    s_add_u32 s55, s55, 4096
    buffer_load_dwordx4 v[56:59], v15, s[28:31], s55 offen offset:0 sc1
    buffer_load_dwordx4 v[60:63], v15, s[28:31], s55 offen offset:1024 sc1
    s_waitcnt vmcnt(10)
    buffer_load_dwordx4 v[64:67], v15, s[28:31], s55 offen offset:2048 sc1
    buffer_load_dwordx4 v[68:71], v15, s[28:31], s55 offen offset:3072 sc1
    v_pk_add_f32 v[112:113], v[116:117], v[118:119]
    v_pk_add_f32 v[114:115], v[116:117], v[118:119]
    s_nop 1
    v_permlane16_swap_b32 v112, v114
    v_permlane16_swap_b32 v113, v115
    v_pk_add_f32 v[116:117], v[112:113], v[114:115]
    v_pk_add_f32 v[118:119], v[112:113], v[114:115]
    s_nop 1
    v_permlane32_swap_b32 v116, v118
    v_permlane32_swap_b32 v117, v119
    v_pk_add_f32 v[112:113], v[116:117], v[118:119]
    v_mul_f32 v112, 0x3ae38e39, v112
    v_mul_f32 v113, 0x3ae38e39, v113
    v_fma_f32 v113, -v112, v112, v113
    v_max_f32 v113, 0, v113
    v_add_f32 v113, 0x3727c5ac, v113
    v_rsq_f32 v114, v113
    s_nop 0
    v_mul_f32 v114, 0xbeeff558, v114
    v_mul_f32 v115, -v112, v114
    s_waitcnt vmcnt(11)
    s_add_u32 s55, s55, 4096
    buffer_load_dwordx4 v[72:75], v15, s[28:31], s55 offen offset:0 sc1
    v_lshlrev_b32 v96, 16, v24
    v_and_b32 v97, s49, v24
    v_lshlrev_b32 v98, 16, v25
    v_and_b32 v99, s49, v25
    v_lshlrev_b32 v100, 16, v26
    v_and_b32 v101, s49, v26
    v_lshlrev_b32 v102, 16, v27
    v_and_b32 v103, s49, v27
    v_pk_fma_f32 v[96:97], v[96:97], v[114:115], v[114:115] op_sel:[0,0,1] op_sel_hi:[1,0,1]
    v_cvt_pk_bf16_f32 v24, v96, v97
    v_pk_fma_f32 v[98:99], v[98:99], v[114:115], v[114:115] op_sel:[0,0,1] op_sel_hi:[1,0,1]
    v_cvt_pk_bf16_f32 v25, v98, v99
    v_pk_fma_f32 v[100:101], v[100:101], v[114:115], v[114:115] op_sel:[0,0,1] op_sel_hi:[1,0,1]
    v_cvt_pk_bf16_f32 v26, v100, v101
    v_pk_fma_f32 v[102:103], v[102:103], v[114:115], v[114:115] op_sel:[0,0,1] op_sel_hi:[1,0,1]
    v_cvt_pk_bf16_f32 v27, v102, v103
    ds_write_b128 v20, v[24:27] offset:0
    s_waitcnt vmcnt(11)
    buffer_load_dwordx4 v[76:79], v15, s[28:31], s55 offen offset:1024 sc1
    v_lshlrev_b32 v96, 16, v28
    v_and_b32 v97, s49, v28
    v_lshlrev_b32 v98, 16, v29
    v_and_b32 v99, s49, v29
    v_lshlrev_b32 v100, 16, v30
    v_and_b32 v101, s49, v30
    v_lshlrev_b32 v102, 16, v31
    v_and_b32 v103, s49, v31
    v_pk_fma_f32 v[96:97], v[96:97], v[114:115], v[114:115] op_sel:[0,0,1] op_sel_hi:[1,0,1]
    v_cvt_pk_bf16_f32 v28, v96, v97
    v_pk_fma_f32 v[98:99], v[98:99], v[114:115], v[114:115] op_sel:[0,0,1] op_sel_hi:[1,0,1]
    v_cvt_pk_bf16_f32 v29, v98, v99
    v_pk_fma_f32 v[100:101], v[100:101], v[114:115], v[114:115] op_sel:[0,0,1] op_sel_hi:[1,0,1]
    v_cvt_pk_bf16_f32 v30, v100, v101
    v_pk_fma_f32 v[102:103], v[102:103], v[114:115], v[114:115] op_sel:[0,0,1] op_sel_hi:[1,0,1]
    v_cvt_pk_bf16_f32 v31, v102, v103
    ds_write_b128 v20, v[28:31] offset:4096
    s_waitcnt vmcnt(11)
    buffer_load_dwordx4 v[80:83], v15, s[28:31], s55 offen offset:2048 sc1
    v_lshlrev_b32 v96, 16, v32
    v_and_b32 v97, s49, v32
    v_lshlrev_b32 v98, 16, v33
    v_and_b32 v99, s49, v33
    v_lshlrev_b32 v100, 16, v34
    v_and_b32 v101, s49, v34
    v_lshlrev_b32 v102, 16, v35
    v_and_b32 v103, s49, v35
    v_pk_fma_f32 v[96:97], v[96:97], v[114:115], v[114:115] op_sel:[0,0,1] op_sel_hi:[1,0,1]
    v_cvt_pk_bf16_f32 v32, v96, v97
    v_pk_fma_f32 v[98:99], v[98:99], v[114:115], v[114:115] op_sel:[0,0,1] op_sel_hi:[1,0,1]
    v_cvt_pk_bf16_f32 v33, v98, v99
    v_pk_fma_f32 v[100:101], v[100:101], v[114:115], v[114:115] op_sel:[0,0,1] op_sel_hi:[1,0,1]
    v_cvt_pk_bf16_f32 v34, v100, v101
    v_pk_fma_f32 v[102:103], v[102:103], v[114:115], v[114:115] op_sel:[0,0,1] op_sel_hi:[1,0,1]
    v_cvt_pk_bf16_f32 v35, v102, v103
    ds_write_b128 v20, v[32:35] offset:8192
    s_waitcnt vmcnt(11)
    buffer_load_dwordx4 v[84:87], v15, s[28:31], s55 offen offset:3072 sc1
    v_lshlrev_b32 v96, 16, v36
    v_and_b32 v97, s49, v36
    v_lshlrev_b32 v98, 16, v37
    v_and_b32 v99, s49, v37
    v_lshlrev_b32 v100, 16, v38
    v_and_b32 v101, s49, v38
    v_lshlrev_b32 v102, 16, v39
    v_and_b32 v103, s49, v39
    v_pk_fma_f32 v[96:97], v[96:97], v[114:115], v[114:115] op_sel:[0,0,1] op_sel_hi:[1,0,1]
    v_cvt_pk_bf16_f32 v36, v96, v97
    v_pk_fma_f32 v[98:99], v[98:99], v[114:115], v[114:115] op_sel:[0,0,1] op_sel_hi:[1,0,1]
    v_cvt_pk_bf16_f32 v37, v98, v99
    v_pk_fma_f32 v[100:101], v[100:101], v[114:115], v[114:115] op_sel:[0,0,1] op_sel_hi:[1,0,1]
    v_cvt_pk_bf16_f32 v38, v100, v101
    v_pk_fma_f32 v[102:103], v[102:103], v[114:115], v[114:115] op_sel:[0,0,1] op_sel_hi:[1,0,1]
    v_cvt_pk_bf16_f32 v39, v102, v103
    ds_write_b128 v20, v[36:39] offset:12288
    s_waitcnt vmcnt(11)
    buffer_load_dwordx2 v[88:89], v12, s[28:31], s57 offen offset:0 sc1
    v_lshlrev_b32 v96, 16, v40
    v_and_b32 v97, s49, v40
    v_lshlrev_b32 v98, 16, v41
    v_and_b32 v99, s49, v41
    v_lshlrev_b32 v100, 16, v42
    v_and_b32 v101, s49, v42
    v_lshlrev_b32 v102, 16, v43
    v_and_b32 v103, s49, v43
    v_pk_fma_f32 v[96:97], v[96:97], v[114:115], v[114:115] op_sel:[0,0,1] op_sel_hi:[1,0,1]
    v_cvt_pk_bf16_f32 v40, v96, v97
    v_pk_fma_f32 v[98:99], v[98:99], v[114:115], v[114:115] op_sel:[0,0,1] op_sel_hi:[1,0,1]
    v_cvt_pk_bf16_f32 v41, v98, v99
    v_pk_fma_f32 v[100:101], v[100:101], v[114:115], v[114:115] op_sel:[0,0,1] op_sel_hi:[1,0,1]
    v_cvt_pk_bf16_f32 v42, v100, v101
    v_pk_fma_f32 v[102:103], v[102:103], v[114:115], v[114:115] op_sel:[0,0,1] op_sel_hi:[1,0,1]
    v_cvt_pk_bf16_f32 v43, v102, v103
    ds_write_b128 v20, v[40:43] offset:16384
    s_waitcnt vmcnt(11)
    buffer_load_dwordx2 v[90:91], v12, s[28:31], s57 offen offset:1024 sc1
    v_lshlrev_b32 v96, 16, v44
    v_and_b32 v97, s49, v44
    v_lshlrev_b32 v98, 16, v45
    v_and_b32 v99, s49, v45
    v_lshlrev_b32 v100, 16, v46
    v_and_b32 v101, s49, v46
    v_lshlrev_b32 v102, 16, v47
    v_and_b32 v103, s49, v47
    v_pk_fma_f32 v[96:97], v[96:97], v[114:115], v[114:115] op_sel:[0,0,1] op_sel_hi:[1,0,1]
    v_cvt_pk_bf16_f32 v44, v96, v97
    v_pk_fma_f32 v[98:99], v[98:99], v[114:115], v[114:115] op_sel:[0,0,1] op_sel_hi:[1,0,1]
    v_cvt_pk_bf16_f32 v45, v98, v99
    v_pk_fma_f32 v[100:101], v[100:101], v[114:115], v[114:115] op_sel:[0,0,1] op_sel_hi:[1,0,1]
    v_cvt_pk_bf16_f32 v46, v100, v101
    v_pk_fma_f32 v[102:103], v[102:103], v[114:115], v[114:115] op_sel:[0,0,1] op_sel_hi:[1,0,1]
    v_cvt_pk_bf16_f32 v47, v102, v103
    ds_write_b128 v20, v[44:47] offset:20480
    s_waitcnt vmcnt(11)
    buffer_load_dwordx2 v[92:93], v12, s[28:31], s57 offen offset:2048 sc1
    v_lshlrev_b32 v96, 16, v48
    v_and_b32 v97, s49, v48
    v_lshlrev_b32 v98, 16, v49
    v_and_b32 v99, s49, v49
    v_lshlrev_b32 v100, 16, v50
    v_and_b32 v101, s49, v50
    v_lshlrev_b32 v102, 16, v51
    v_and_b32 v103, s49, v51
    v_pk_fma_f32 v[96:97], v[96:97], v[114:115], v[114:115] op_sel:[0,0,1] op_sel_hi:[1,0,1]
    v_cvt_pk_bf16_f32 v48, v96, v97
    v_pk_fma_f32 v[98:99], v[98:99], v[114:115], v[114:115] op_sel:[0,0,1] op_sel_hi:[1,0,1]
    v_cvt_pk_bf16_f32 v49, v98, v99
    v_pk_fma_f32 v[100:101], v[100:101], v[114:115], v[114:115] op_sel:[0,0,1] op_sel_hi:[1,0,1]
    v_cvt_pk_bf16_f32 v50, v100, v101
    v_pk_fma_f32 v[102:103], v[102:103], v[114:115], v[114:115] op_sel:[0,0,1] op_sel_hi:[1,0,1]
    v_cvt_pk_bf16_f32 v51, v102, v103
    ds_write_b128 v20, v[48:51] offset:24576
    s_waitcnt vmcnt(11)
    buffer_load_dwordx2 v[94:95], v12, s[28:31], s57 offen offset:3072 sc1
    v_lshlrev_b32 v96, 16, v52
    v_and_b32 v97, s49, v52
    v_lshlrev_b32 v98, 16, v53
    v_and_b32 v99, s49, v53
    v_lshlrev_b32 v100, 16, v54
    v_and_b32 v101, s49, v54
    v_lshlrev_b32 v102, 16, v55
    v_and_b32 v103, s49, v55
    v_pk_fma_f32 v[96:97], v[96:97], v[114:115], v[114:115] op_sel:[0,0,1] op_sel_hi:[1,0,1]
    v_cvt_pk_bf16_f32 v52, v96, v97
    v_pk_fma_f32 v[98:99], v[98:99], v[114:115], v[114:115] op_sel:[0,0,1] op_sel_hi:[1,0,1]
    v_cvt_pk_bf16_f32 v53, v98, v99
    v_pk_fma_f32 v[100:101], v[100:101], v[114:115], v[114:115] op_sel:[0,0,1] op_sel_hi:[1,0,1]
    v_cvt_pk_bf16_f32 v54, v100, v101
    v_pk_fma_f32 v[102:103], v[102:103], v[114:115], v[114:115] op_sel:[0,0,1] op_sel_hi:[1,0,1]
    v_cvt_pk_bf16_f32 v55, v102, v103
    ds_write_b128 v20, v[52:55] offset:28672
    s_waitcnt vmcnt(11)
    v_lshlrev_b32 v96, 16, v56
    v_and_b32 v97, s49, v56
    v_lshlrev_b32 v98, 16, v57
    v_and_b32 v99, s49, v57
    v_lshlrev_b32 v100, 16, v58
    v_and_b32 v101, s49, v58
    v_lshlrev_b32 v102, 16, v59
    v_and_b32 v103, s49, v59
    v_pk_fma_f32 v[96:97], v[96:97], v[114:115], v[114:115] op_sel:[0,0,1] op_sel_hi:[1,0,1]
    v_cvt_pk_bf16_f32 v56, v96, v97
    v_pk_fma_f32 v[98:99], v[98:99], v[114:115], v[114:115] op_sel:[0,0,1] op_sel_hi:[1,0,1]
    v_cvt_pk_bf16_f32 v57, v98, v99
    v_pk_fma_f32 v[100:101], v[100:101], v[114:115], v[114:115] op_sel:[0,0,1] op_sel_hi:[1,0,1]
    v_cvt_pk_bf16_f32 v58, v100, v101
    v_pk_fma_f32 v[102:103], v[102:103], v[114:115], v[114:115] op_sel:[0,0,1] op_sel_hi:[1,0,1]
    v_cvt_pk_bf16_f32 v59, v102, v103
    ds_write_b128 v20, v[56:59] offset:32768
    s_waitcnt vmcnt(10)
    v_lshlrev_b32 v96, 16, v60
    v_and_b32 v97, s49, v60
    v_lshlrev_b32 v98, 16, v61
    v_and_b32 v99, s49, v61
    v_lshlrev_b32 v100, 16, v62
    v_and_b32 v101, s49, v62
    v_lshlrev_b32 v102, 16, v63
    v_and_b32 v103, s49, v63
    v_pk_fma_f32 v[96:97], v[96:97], v[114:115], v[114:115] op_sel:[0,0,1] op_sel_hi:[1,0,1]
    v_cvt_pk_bf16_f32 v60, v96, v97
    v_pk_fma_f32 v[98:99], v[98:99], v[114:115], v[114:115] op_sel:[0,0,1] op_sel_hi:[1,0,1]
    v_cvt_pk_bf16_f32 v61, v98, v99
    v_pk_fma_f32 v[100:101], v[100:101], v[114:115], v[114:115] op_sel:[0,0,1] op_sel_hi:[1,0,1]
    v_cvt_pk_bf16_f32 v62, v100, v101
    v_pk_fma_f32 v[102:103], v[102:103], v[114:115], v[114:115] op_sel:[0,0,1] op_sel_hi:[1,0,1]
    v_cvt_pk_bf16_f32 v63, v102, v103
    ds_write_b128 v20, v[60:63] offset:36864
    s_waitcnt vmcnt(9)
    v_lshlrev_b32 v96, 16, v64
    v_and_b32 v97, s49, v64
    v_lshlrev_b32 v98, 16, v65
    v_and_b32 v99, s49, v65
    v_lshlrev_b32 v100, 16, v66
    v_and_b32 v101, s49, v66
    v_lshlrev_b32 v102, 16, v67
    v_and_b32 v103, s49, v67
    v_pk_fma_f32 v[96:97], v[96:97], v[114:115], v[114:115] op_sel:[0,0,1] op_sel_hi:[1,0,1]
    v_cvt_pk_bf16_f32 v64, v96, v97
    v_pk_fma_f32 v[98:99], v[98:99], v[114:115], v[114:115] op_sel:[0,0,1] op_sel_hi:[1,0,1]
    v_cvt_pk_bf16_f32 v65, v98, v99
    v_pk_fma_f32 v[100:101], v[100:101], v[114:115], v[114:115] op_sel:[0,0,1] op_sel_hi:[1,0,1]
    v_cvt_pk_bf16_f32 v66, v100, v101
    v_pk_fma_f32 v[102:103], v[102:103], v[114:115], v[114:115] op_sel:[0,0,1] op_sel_hi:[1,0,1]
    v_cvt_pk_bf16_f32 v67, v102, v103
    ds_write_b128 v20, v[64:67] offset:40960
    s_waitcnt vmcnt(8)
    s_mul_i32 s6, s4, 165888
    s_add_u32 s6, s6, s48
    buffer_load_dword v241, v124, s[20:23], s6 offen
    s_lshl_b32 s6, s5, 5
    s_add_u32 s6, s6, s4
    s_mul_i32 s6, s6, 20736
    buffer_load_dword v241, v125, s[24:27], s6 offen
    v_lshlrev_b32 v96, 16, v68
    v_and_b32 v97, s49, v68
    v_lshlrev_b32 v98, 16, v69
    v_and_b32 v99, s49, v69
    v_lshlrev_b32 v100, 16, v70
    v_and_b32 v101, s49, v70
    v_lshlrev_b32 v102, 16, v71
    v_and_b32 v103, s49, v71
    v_pk_fma_f32 v[96:97], v[96:97], v[114:115], v[114:115] op_sel:[0,0,1] op_sel_hi:[1,0,1]
    v_cvt_pk_bf16_f32 v68, v96, v97
    v_pk_fma_f32 v[98:99], v[98:99], v[114:115], v[114:115] op_sel:[0,0,1] op_sel_hi:[1,0,1]
    v_cvt_pk_bf16_f32 v69, v98, v99
    v_pk_fma_f32 v[100:101], v[100:101], v[114:115], v[114:115] op_sel:[0,0,1] op_sel_hi:[1,0,1]
    v_cvt_pk_bf16_f32 v70, v100, v101
    v_pk_fma_f32 v[102:103], v[102:103], v[114:115], v[114:115] op_sel:[0,0,1] op_sel_hi:[1,0,1]
    v_cvt_pk_bf16_f32 v71, v102, v103
    ds_write_b128 v20, v[68:71] offset:45056
    s_waitcnt vmcnt(9)
    v_lshlrev_b32 v96, 16, v72
    v_and_b32 v97, s49, v72
    v_lshlrev_b32 v98, 16, v73
    v_and_b32 v99, s49, v73
    v_lshlrev_b32 v100, 16, v74
    v_and_b32 v101, s49, v74
    v_lshlrev_b32 v102, 16, v75
    v_and_b32 v103, s49, v75
    v_pk_fma_f32 v[96:97], v[96:97], v[114:115], v[114:115] op_sel:[0,0,1] op_sel_hi:[1,0,1]
    v_cvt_pk_bf16_f32 v72, v96, v97
    v_pk_fma_f32 v[98:99], v[98:99], v[114:115], v[114:115] op_sel:[0,0,1] op_sel_hi:[1,0,1]
    v_cvt_pk_bf16_f32 v73, v98, v99
    v_pk_fma_f32 v[100:101], v[100:101], v[114:115], v[114:115] op_sel:[0,0,1] op_sel_hi:[1,0,1]
    v_cvt_pk_bf16_f32 v74, v100, v101
    v_pk_fma_f32 v[102:103], v[102:103], v[114:115], v[114:115] op_sel:[0,0,1] op_sel_hi:[1,0,1]
    v_cvt_pk_bf16_f32 v75, v102, v103
    ds_write_b128 v20, v[72:75] offset:49152
    s_waitcnt vmcnt(8)
    v_lshlrev_b32 v96, 16, v76
    v_and_b32 v97, s49, v76
    v_lshlrev_b32 v98, 16, v77
    v_and_b32 v99, s49, v77
    v_lshlrev_b32 v100, 16, v78
    v_and_b32 v101, s49, v78
    v_lshlrev_b32 v102, 16, v79
    v_and_b32 v103, s49, v79
    v_pk_fma_f32 v[96:97], v[96:97], v[114:115], v[114:115] op_sel:[0,0,1] op_sel_hi:[1,0,1]
    v_cvt_pk_bf16_f32 v76, v96, v97
    v_pk_fma_f32 v[98:99], v[98:99], v[114:115], v[114:115] op_sel:[0,0,1] op_sel_hi:[1,0,1]
    v_cvt_pk_bf16_f32 v77, v98, v99
    v_pk_fma_f32 v[100:101], v[100:101], v[114:115], v[114:115] op_sel:[0,0,1] op_sel_hi:[1,0,1]
    v_cvt_pk_bf16_f32 v78, v100, v101
    v_pk_fma_f32 v[102:103], v[102:103], v[114:115], v[114:115] op_sel:[0,0,1] op_sel_hi:[1,0,1]
    v_cvt_pk_bf16_f32 v79, v102, v103
    ds_write_b128 v20, v[76:79] offset:53248
    s_waitcnt vmcnt(7)
    v_lshlrev_b32 v96, 16, v80
    v_and_b32 v97, s49, v80
    v_lshlrev_b32 v98, 16, v81
    v_and_b32 v99, s49, v81
    v_lshlrev_b32 v100, 16, v82
    v_and_b32 v101, s49, v82
    v_lshlrev_b32 v102, 16, v83
    v_and_b32 v103, s49, v83
    v_pk_fma_f32 v[96:97], v[96:97], v[114:115], v[114:115] op_sel:[0,0,1] op_sel_hi:[1,0,1]
    v_cvt_pk_bf16_f32 v80, v96, v97
    v_pk_fma_f32 v[98:99], v[98:99], v[114:115], v[114:115] op_sel:[0,0,1] op_sel_hi:[1,0,1]
    v_cvt_pk_bf16_f32 v81, v98, v99
    v_pk_fma_f32 v[100:101], v[100:101], v[114:115], v[114:115] op_sel:[0,0,1] op_sel_hi:[1,0,1]
    v_cvt_pk_bf16_f32 v82, v100, v101
    v_pk_fma_f32 v[102:103], v[102:103], v[114:115], v[114:115] op_sel:[0,0,1] op_sel_hi:[1,0,1]
    v_cvt_pk_bf16_f32 v83, v102, v103
    ds_write_b128 v20, v[80:83] offset:57344
    s_waitcnt vmcnt(6)
    v_lshlrev_b32 v96, 16, v84
    v_and_b32 v97, s49, v84
    v_lshlrev_b32 v98, 16, v85
    v_and_b32 v99, s49, v85
    v_lshlrev_b32 v100, 16, v86
    v_and_b32 v101, s49, v86
    v_lshlrev_b32 v102, 16, v87
    v_and_b32 v103, s49, v87
    v_pk_fma_f32 v[96:97], v[96:97], v[114:115], v[114:115] op_sel:[0,0,1] op_sel_hi:[1,0,1]
    v_cvt_pk_bf16_f32 v84, v96, v97
    v_pk_fma_f32 v[98:99], v[98:99], v[114:115], v[114:115] op_sel:[0,0,1] op_sel_hi:[1,0,1]
    v_cvt_pk_bf16_f32 v85, v98, v99
    v_pk_fma_f32 v[100:101], v[100:101], v[114:115], v[114:115] op_sel:[0,0,1] op_sel_hi:[1,0,1]
    v_cvt_pk_bf16_f32 v86, v100, v101
    v_pk_fma_f32 v[102:103], v[102:103], v[114:115], v[114:115] op_sel:[0,0,1] op_sel_hi:[1,0,1]
    v_cvt_pk_bf16_f32 v87, v102, v103
    ds_write_b128 v20, v[84:87] offset:61440
    s_waitcnt vmcnt(4)
    v_lshlrev_b32 v96, 16, v88
    v_and_b32 v97, s49, v88
    v_lshlrev_b32 v98, 16, v89
    v_and_b32 v99, s49, v89
    v_lshlrev_b32 v100, 16, v90
    v_and_b32 v101, s49, v90
    v_lshlrev_b32 v102, 16, v91
    v_and_b32 v103, s49, v91
    v_pk_fma_f32 v[96:97], v[96:97], v[114:115], v[114:115] op_sel:[0,0,1] op_sel_hi:[1,0,1]
    v_cvt_pk_bf16_f32 v88, v96, v97
    v_pk_fma_f32 v[98:99], v[98:99], v[114:115], v[114:115] op_sel:[0,0,1] op_sel_hi:[1,0,1]
    v_cvt_pk_bf16_f32 v89, v98, v99
    v_pk_fma_f32 v[100:101], v[100:101], v[114:115], v[114:115] op_sel:[0,0,1] op_sel_hi:[1,0,1]
    v_cvt_pk_bf16_f32 v90, v100, v101
    v_pk_fma_f32 v[102:103], v[102:103], v[114:115], v[114:115] op_sel:[0,0,1] op_sel_hi:[1,0,1]
    v_cvt_pk_bf16_f32 v91, v102, v103
    ds_write_b128 v21, v[88:91] offset:0
    s_waitcnt vmcnt(2)
    v_lshlrev_b32 v96, 16, v92
    v_and_b32 v97, s49, v92
    v_lshlrev_b32 v98, 16, v93
    v_and_b32 v99, s49, v93
    v_lshlrev_b32 v100, 16, v94
    v_and_b32 v101, s49, v94
    v_lshlrev_b32 v102, 16, v95
    v_and_b32 v103, s49, v95
    v_pk_fma_f32 v[96:97], v[96:97], v[114:115], v[114:115] op_sel:[0,0,1] op_sel_hi:[1,0,1]
    v_cvt_pk_bf16_f32 v92, v96, v97
    v_pk_fma_f32 v[98:99], v[98:99], v[114:115], v[114:115] op_sel:[0,0,1] op_sel_hi:[1,0,1]
    v_cvt_pk_bf16_f32 v93, v98, v99
    v_pk_fma_f32 v[100:101], v[100:101], v[114:115], v[114:115] op_sel:[0,0,1] op_sel_hi:[1,0,1]
    v_cvt_pk_bf16_f32 v94, v100, v101
    v_pk_fma_f32 v[102:103], v[102:103], v[114:115], v[114:115] op_sel:[0,0,1] op_sel_hi:[1,0,1]
    v_cvt_pk_bf16_f32 v95, v102, v103
    ds_write_b128 v21, v[92:95] offset:4096
    s_waitcnt lgkmcnt(0)
    s_barrier
    ds_read_b64_tr_b16 v[48:49], v5 offset:32768
    ds_read_b64_tr_b16 v[50:51], v5 offset:34816
    ds_read_b128 a[0:3], v15 offset:0
    ds_read_b128 a[4:7], v15 offset:1024
    ds_read_b128 a[8:11], v15 offset:2048
    ds_read_b128 a[12:15], v15 offset:3072
    ds_read_b64_tr_b16 v[52:53], v5 offset:36864
    ds_read_b64_tr_b16 v[54:55], v5 offset:38912
    ds_read_b128 a[16:19], v15 offset:4096
    ds_read_b128 a[20:23], v15 offset:5120
    ds_read_b128 a[24:27], v15 offset:6144
    ds_read_b128 a[28:31], v15 offset:7168
    ds_read_b64_tr_b16 v[56:57], v5 offset:40960
    ds_read_b64_tr_b16 v[58:59], v5 offset:43008
    s_mul_i32 s57, s5, 663552
    s_lshl_b32 s69, s3, 11
    s_add_u32 s69, s69, 196608
    s_mul_i32 s55, s5, 73728
    s_add_u32 s55, s55, s69
    s_lshl_b32 s6, s5, 13
    s_add_u32 s59, s69, s6
    s_lshl_b32 s70, s3, 13
    s_add_u32 s70, s70, 32768
    s_waitcnt lgkmcnt(8)
    v_mfma_f32_16x16x32_bf16 v[72:75], v[48:51], a[0:3], v[128:131]
    v_mfma_f32_16x16x32_bf16 v[76:79], v[48:51], a[4:7], v[128:131]
    s_add_u32 m0, s61, 0
    ds_read_b64_tr_b16 v[60:61], v5 offset:45056
    ds_read_b64_tr_b16 v[62:63], v5 offset:47104
    s_add_u32 s6, s5, 1
    s_and_b32 s6, s6, 7
    v_mfma_f32_16x16x32_bf16 v[80:83], v[48:51], a[8:11], v[128:131]
    s_waitcnt vmcnt(17) lgkmcnt(8)
    s_barrier
    ds_read_b128 a[32:35], v15 offset:8192
    ds_read_b128 a[36:39], v15 offset:9216
    v_mfma_f32_16x16x32_bf16 v[84:87], v[48:51], a[12:15], v[128:131]
    s_waitcnt lgkmcnt(6)
    s_add_u32 s58, s48, 1327232
    ds_read_b128 a[40:43], v15 offset:10240
    ds_read_b128 a[44:47], v15 offset:11264
    v_mfma_f32_16x16x32_bf16 v[72:75], v[52:55], a[16:19], v[72:75]
    buffer_load_dwordx4 v6, s[20:23], s58 offen lds
    s_add_u32 m0, s61, 98304
    s_add_u32 s58, s48, 1622144
    buffer_load_dwordx4 v6, s[20:23], s58 offen lds
    v_mfma_f32_16x16x32_bf16 v[76:79], v[52:55], a[20:23], v[76:79]
    s_add_u32 m0, s61, 102400
    ds_read_b64_tr_b16 v[64:65], v5 offset:49152
    ds_read_b64_tr_b16 v[66:67], v5 offset:51200
    s_lshl_b32 s6, s6, 7
    s_add_u32 s8, s6, s57
    v_mfma_f32_16x16x32_bf16 v[80:83], v[52:55], a[24:27], v[80:83]
    s_add_u32 s58, s48, 1990784
    ds_read_b128 a[48:51], v15 offset:12288
    ds_read_b128 a[52:55], v15 offset:13312
    v_mfma_f32_16x16x32_bf16 v[84:87], v[52:55], a[28:31], v[84:87]
    s_waitcnt lgkmcnt(4)
    ds_read_b128 a[56:59], v15 offset:14336
    ds_read_b128 a[60:63], v15 offset:15360
    v_mfma_f32_16x16x32_bf16 v[72:75], v[56:59], a[32:35], v[72:75]
    buffer_load_dwordx4 v6, s[20:23], s58 offen lds
    v_mfma_f32_16x16x32_bf16 v[76:79], v[56:59], a[36:39], v[76:79]
    ds_read_b64_tr_b16 v[68:69], v5 offset:53248
    ds_read_b64_tr_b16 v[70:71], v5 offset:55296
    s_add_u32 s6, s5, 2
    s_and_b32 s6, s6, 7
    v_mfma_f32_16x16x32_bf16 v[80:83], v[56:59], a[40:43], v[80:83]
    ds_read_b128 a[64:67], v15 offset:16384
    ds_read_b128 a[68:71], v15 offset:17408
    v_mfma_f32_16x16x32_bf16 v[84:87], v[56:59], a[44:47], v[84:87]
    s_waitcnt lgkmcnt(4)
    ds_read_b128 a[72:75], v15 offset:18432
    ds_read_b128 a[76:79], v15 offset:19456
    v_mfma_f32_16x16x32_bf16 v[72:75], v[60:63], a[48:51], v[72:75]
    v_mfma_f32_16x16x32_bf16 v[76:79], v[60:63], a[52:55], v[76:79]
    s_add_u32 m0, s61, 4096
    ds_read_b64_tr_b16 v[48:49], v5 offset:57344
    ds_read_b64_tr_b16 v[50:51], v5 offset:59392
    s_lshl_b32 s6, s6, 7
    s_add_u32 s9, s6, s57
    v_mfma_f32_16x16x32_bf16 v[80:83], v[60:63], a[56:59], v[80:83]
    s_waitcnt vmcnt(17) lgkmcnt(12)
    s_barrier
    ds_read_b128 a[80:83], v15 offset:20480
    ds_read_b128 a[84:87], v15 offset:21504
    v_mfma_f32_16x16x32_bf16 v[84:87], v[60:63], a[60:63], v[84:87]
    s_waitcnt lgkmcnt(4)
    s_add_u32 s58, s48, 2285696
    ds_read_b128 a[88:91], v15 offset:22528
    ds_read_b128 a[92:95], v15 offset:23552
    v_mfma_f32_16x16x32_bf16 v[72:75], v[64:67], a[64:67], v[72:75]
    buffer_load_dwordx4 v6, s[20:23], s58 offen lds
    s_add_u32 m0, s61, 8192
    s_add_u32 s58, s48, 2654336
    buffer_load_dwordx4 v6, s[20:23], s58 offen lds
    v_mfma_f32_16x16x32_bf16 v[76:79], v[64:67], a[68:71], v[76:79]
    s_add_u32 m0, s61, 12288
    ds_read_b64_tr_b16 v[52:53], v5 offset:61440
    ds_read_b64_tr_b16 v[54:55], v5 offset:63488
    s_add_u32 s6, s5, 3
    s_and_b32 s6, s6, 7
    v_mfma_f32_16x16x32_bf16 v[80:83], v[64:67], a[72:75], v[80:83]
    s_add_u32 s58, s48, 2949248
    ds_read_b128 a[96:99], v15 offset:24576
    ds_read_b128 a[100:103], v15 offset:25600
    v_mfma_f32_16x16x32_bf16 v[84:87], v[64:67], a[76:79], v[84:87]
    s_waitcnt lgkmcnt(4)
    ds_read_b128 a[104:107], v15 offset:26624
    ds_read_b128 a[108:111], v15 offset:27648
    v_mfma_f32_16x16x32_bf16 v[72:75], v[68:71], a[80:83], v[72:75]
    buffer_load_dwordx4 v6, s[20:23], s58 offen lds
    v_mfma_f32_16x16x32_bf16 v[76:79], v[68:71], a[84:87], v[76:79]
    s_add_u32 m0, s61, 106496
    ds_read_b64_tr_b16 v[56:57], v240 offset:0
    ds_read_b64_tr_b16 v[58:59], v240 offset:2048
    s_lshl_b32 s6, s6, 7
    s_add_u32 s10, s6, s57
    v_mfma_f32_16x16x32_bf16 v[80:83], v[68:71], a[88:91], v[80:83]
    s_add_u32 s58, s48, 3317888
    ds_read_b128 a[112:115], v15 offset:28672
    ds_read_b128 a[116:119], v15 offset:29696
    v_mfma_f32_16x16x32_bf16 v[84:87], v[68:71], a[92:95], v[84:87]
    s_waitcnt lgkmcnt(4)
    ds_read_b128 a[120:123], v15 offset:30720
    ds_read_b128 a[124:127], v15 offset:31744
    v_mfma_f32_16x16x32_bf16 v[72:75], v[48:51], a[96:99], v[72:75]
    buffer_load_dwordx4 v6, s[20:23], s58 offen lds
    v_mfma_f32_16x16x32_bf16 v[76:79], v[48:51], a[100:103], v[76:79]
    s_add_u32 m0, s61, 16384
    ds_read_b64_tr_b16 v[60:61], v240 offset:4096
    ds_read_b64_tr_b16 v[62:63], v240 offset:6144
    s_add_u32 s6, s5, 4
    s_and_b32 s6, s6, 7
    v_mfma_f32_16x16x32_bf16 v[80:83], v[48:51], a[104:107], v[80:83]
    s_waitcnt vmcnt(15) lgkmcnt(12)
    s_barrier
    ds_read_b128 a[128:131], v15 offset:32768
    ds_read_b128 a[132:135], v15 offset:33792
    v_mfma_f32_16x16x32_bf16 v[84:87], v[48:51], a[108:111], v[84:87]
    s_waitcnt lgkmcnt(4)
    s_add_u32 s58, s48, 3612800
    ds_read_b128 a[136:139], v15 offset:34816
    ds_read_b128 a[140:143], v15 offset:35840
    v_mfma_f32_16x16x32_bf16 v[72:75], v[52:55], a[112:115], v[72:75]
    buffer_load_dwordx4 v6, s[20:23], s58 offen lds
    v_mfma_f32_16x16x32_bf16 v[76:79], v[52:55], a[116:119], v[76:79]
    s_add_u32 m0, s61, 20480
    ds_read_b64_tr_b16 v[64:65], v240 offset:8192
    ds_read_b64_tr_b16 v[66:67], v240 offset:10240
    s_lshl_b32 s6, s6, 7
    s_add_u32 s11, s6, s57
    v_mfma_f32_16x16x32_bf16 v[80:83], v[52:55], a[120:123], v[80:83]
    s_add_u32 s58, s48, 3981440
    ds_read_b128 a[144:147], v15 offset:36864
    ds_read_b128 a[148:151], v15 offset:37888
    v_mfma_f32_16x16x32_bf16 v[84:87], v[52:55], a[124:127], v[84:87]
    s_waitcnt lgkmcnt(4)
    ds_read_b128 a[152:155], v15 offset:38912
    ds_read_b128 a[156:159], v15 offset:39936
    v_mfma_f32_16x16x32_bf16 v[72:75], v[56:59], a[128:131], v[72:75]
    buffer_load_dwordx4 v6, s[20:23], s58 offen lds
    v_mfma_f32_16x16x32_bf16 v[76:79], v[56:59], a[132:135], v[76:79]
    s_add_u32 m0, s61, 24576
    ds_read_b64_tr_b16 v[68:69], v240 offset:12288
    ds_read_b64_tr_b16 v[70:71], v240 offset:14336
    s_add_u32 s6, s5, 5
    s_and_b32 s6, s6, 7
    v_mfma_f32_16x16x32_bf16 v[80:83], v[56:59], a[136:139], v[80:83]
    s_add_u32 s58, s48, 4276352
    ds_read_b128 a[160:163], v15 offset:40960
    ds_read_b128 a[164:167], v15 offset:41984
    v_mfma_f32_16x16x32_bf16 v[84:87], v[56:59], a[140:143], v[84:87]
    s_waitcnt lgkmcnt(4)
    ds_read_b128 a[168:171], v15 offset:43008
    ds_read_b128 a[172:175], v15 offset:44032
    v_mfma_f32_16x16x32_bf16 v[72:75], v[60:63], a[144:147], v[72:75]
    buffer_load_dwordx4 v6, s[20:23], s58 offen lds
    v_mfma_f32_16x16x32_bf16 v[76:79], v[60:63], a[148:151], v[76:79]
    s_add_u32 m0, s61, 110592
    ds_read_b64_tr_b16 v[48:49], v240 offset:16384
    ds_read_b64_tr_b16 v[50:51], v240 offset:18432
    s_lshl_b32 s6, s6, 7
    s_add_u32 s12, s6, s57
    v_mfma_f32_16x16x32_bf16 v[80:83], v[60:63], a[152:155], v[80:83]
    s_add_u32 s58, s48, 4644992
    ds_read_b128 a[176:179], v15 offset:45056
    ds_read_b128 a[180:183], v15 offset:46080
    v_mfma_f32_16x16x32_bf16 v[84:87], v[60:63], a[156:159], v[84:87]
    s_waitcnt lgkmcnt(4)
    ds_read_b128 a[184:187], v15 offset:47104
    ds_read_b128 a[188:191], v15 offset:48128
    v_mfma_f32_16x16x32_bf16 v[72:75], v[64:67], a[160:163], v[72:75]
    buffer_load_dwordx4 v6, s[20:23], s58 offen lds
    v_mfma_f32_16x16x32_bf16 v[76:79], v[64:67], a[164:167], v[76:79]
    s_add_u32 m0, s61, 114688
    ds_read_b64_tr_b16 v[52:53], v240 offset:20480
    ds_read_b64_tr_b16 v[54:55], v240 offset:22528
    s_add_u32 s6, s5, 6
    s_and_b32 s6, s6, 7
    v_mfma_f32_16x16x32_bf16 v[80:83], v[64:67], a[168:171], v[80:83]
    s_add_u32 s58, s48, 4939904
    ds_read_b128 a[192:195], v15 offset:49152
    ds_read_b128 a[196:199], v15 offset:50176
    v_mfma_f32_16x16x32_bf16 v[84:87], v[64:67], a[172:175], v[84:87]
    s_waitcnt lgkmcnt(4)
    ds_read_b128 a[200:203], v15 offset:51200
    ds_read_b128 a[204:207], v15 offset:52224
    v_mfma_f32_16x16x32_bf16 v[72:75], v[68:71], a[176:179], v[72:75]
    buffer_load_dwordx4 v6, s[20:23], s58 offen lds
    v_mfma_f32_16x16x32_bf16 v[76:79], v[68:71], a[180:183], v[76:79]
    s_add_u32 m0, s61, 118784
    ds_read_b64_tr_b16 v[56:57], v240 offset:24576
    ds_read_b64_tr_b16 v[58:59], v240 offset:26624
    s_lshl_b32 s6, s6, 7
    s_add_u32 s13, s6, s57
    v_mfma_f32_16x16x32_bf16 v[80:83], v[68:71], a[184:187], v[80:83]
    s_add_u32 s58, s48, 128
    ds_read_b128 a[208:211], v15 offset:53248
    ds_read_b128 a[212:215], v15 offset:54272
    v_mfma_f32_16x16x32_bf16 v[84:87], v[68:71], a[188:191], v[84:87]
    s_waitcnt lgkmcnt(4)
    ds_read_b128 a[216:219], v15 offset:55296
    ds_read_b128 a[220:223], v15 offset:56320
    v_mfma_f32_16x16x32_bf16 v[72:75], v[48:51], a[192:195], v[72:75]
    buffer_load_dwordx4 v7, s[20:23], s58 offen lds
    v_mfma_f32_16x16x32_bf16 v[76:79], v[48:51], a[196:199], v[76:79]
    s_add_u32 m0, s61, 28672
    ds_read_b64_tr_b16 v[60:61], v240 offset:28672
    ds_read_b64_tr_b16 v[62:63], v240 offset:30720
    s_add_u32 s6, s5, 7
    s_and_b32 s6, s6, 7
    v_mfma_f32_16x16x32_bf16 v[80:83], v[48:51], a[200:203], v[80:83]
    s_waitcnt vmcnt(15) lgkmcnt(12)
    s_barrier
    ds_read_b128 a[224:227], v15 offset:57344
    ds_read_b128 a[228:231], v15 offset:58368
    v_mfma_f32_16x16x32_bf16 v[84:87], v[48:51], a[204:207], v[84:87]
    s_waitcnt lgkmcnt(4)
    s_add_u32 s58, s48, 2654336
    ds_read_b128 a[232:235], v15 offset:59392
    ds_read_b128 a[236:239], v15 offset:60416
    v_mfma_f32_16x16x32_bf16 v[72:75], v[52:55], a[208:211], v[72:75]
    buffer_load_dwordx4 v7, s[20:23], s58 offen lds
    v_mfma_f32_16x16x32_bf16 v[76:79], v[52:55], a[212:215], v[76:79]
    s_add_u32 m0, s61, 32768
    ds_read_b64_tr_b16 v[64:65], v5 offset:8192
    ds_read_b64_tr_b16 v[66:67], v5 offset:10240
    s_lshl_b32 s6, s6, 7
    s_add_u32 s14, s6, s57
    v_mfma_f32_16x16x32_bf16 v[80:83], v[52:55], a[216:219], v[80:83]
    s_add_u32 s58, s48, 256
    ds_read_b128 a[240:243], v15 offset:61440
    ds_read_b128 a[244:247], v15 offset:62464
    v_mfma_f32_16x16x32_bf16 v[84:87], v[52:55], a[220:223], v[84:87]
    s_waitcnt lgkmcnt(4)
    ds_read_b128 a[248:251], v15 offset:63488
    ds_read_b128 a[252:255], v15 offset:64512
    v_mfma_f32_16x16x32_bf16 v[72:75], v[56:59], a[224:227], v[72:75]
    buffer_load_dwordx4 v6, s[20:23], s58 offen lds
    v_mfma_f32_16x16x32_bf16 v[76:79], v[56:59], a[228:231], v[76:79]
    s_add_u32 m0, s61, 36864
    ds_read_b64_tr_b16 v[68:69], v5 offset:12288
    ds_read_b64_tr_b16 v[70:71], v5 offset:14336
    s_add_u32 s6, s5, 8
    s_and_b32 s6, s6, 7
    v_mfma_f32_16x16x32_bf16 v[80:83], v[56:59], a[232:235], v[80:83]
    s_add_u32 s58, s48, 295168
    ds_read_b128 v[16:19], v11 offset:0
    ds_read_b128 v[20:23], v11 offset:1024
    v_mfma_f32_16x16x32_bf16 v[84:87], v[56:59], a[236:239], v[84:87]
    s_waitcnt lgkmcnt(4)
    ds_read_b128 v[24:27], v11 offset:2048
    ds_read_b128 v[28:31], v11 offset:3072
    v_mfma_f32_16x16x32_bf16 v[72:75], v[60:63], a[240:243], v[72:75]
    buffer_load_dwordx4 v6, s[20:23], s58 offen lds
    v_mfma_f32_16x16x32_bf16 v[76:79], v[60:63], a[244:247], v[76:79]
    s_add_u32 m0, s61, 40960
    ds_read_b64_tr_b16 v[48:49], v5 offset:16384
    ds_read_b64_tr_b16 v[50:51], v5 offset:18432
    s_lshl_b32 s6, s6, 7
    s_add_u32 s15, s6, s57
    v_mfma_f32_16x16x32_bf16 v[80:83], v[60:63], a[248:251], v[80:83]
    s_add_u32 s58, s48, 663808
    ds_read_b128 v[32:35], v11 offset:4096
    ds_read_b128 v[36:39], v11 offset:5120
    v_mfma_f32_16x16x32_bf16 v[84:87], v[60:63], a[252:255], v[84:87]
    s_waitcnt lgkmcnt(4)
    ds_read_b128 v[40:43], v11 offset:6144
    ds_read_b128 v[44:47], v11 offset:7168
    v_mfma_f32_16x16x32_bf16 v[72:75], v[64:67], v[16:19], v[72:75]
    buffer_load_dwordx4 v6, s[20:23], s58 offen lds
    v_mfma_f32_16x16x32_bf16 v[76:79], v[64:67], v[20:23], v[76:79]
    s_add_u32 m0, s61, 45056
    ds_read_b64_tr_b16 v[52:53], v5 offset:20480
    ds_read_b64_tr_b16 v[54:55], v5 offset:22528
    v_mfma_f32_16x16x32_bf16 v[80:83], v[64:67], v[24:27], v[80:83]
    s_add_u32 s58, s48, 958720
    v_mfma_f32_16x16x32_bf16 v[84:87], v[64:67], v[28:31], v[84:87]
    s_waitcnt lgkmcnt(2)
    v_mfma_f32_16x16x32_bf16 v[72:75], v[68:71], v[32:35], v[72:75]
    buffer_load_dwordx4 v6, s[20:23], s58 offen lds
    v_mfma_f32_16x16x32_bf16 v[76:79], v[68:71], v[36:39], v[76:79]
    s_add_u32 m0, s61, 49152
    ds_read_b64_tr_b16 v[56:57], v5 offset:24576
    ds_read_b64_tr_b16 v[58:59], v5 offset:26624
    v_mfma_f32_16x16x32_bf16 v[80:83], v[68:71], v[40:43], v[80:83]
    s_add_u32 s58, s48, 1327360
    v_mfma_f32_16x16x32_bf16 v[84:87], v[68:71], v[44:47], v[84:87]
    s_waitcnt lgkmcnt(2)
    v_mfma_f32_16x16x32_bf16 v[88:91], v[48:51], a[0:3], v[132:135]
    buffer_load_dwordx4 v6, s[20:23], s58 offen lds
    v_mfma_f32_16x16x32_bf16 v[88:91], v[52:55], a[16:19], v[88:91]
    s_add_u32 m0, s61, 53248
    ds_read_b64_tr_b16 v[60:61], v5 offset:28672
    ds_read_b64_tr_b16 v[62:63], v5 offset:30720
    v_mfma_f32_16x16x32_bf16 v[92:95], v[48:51], a[4:7], v[132:135]
    s_waitcnt vmcnt(13) lgkmcnt(4)
    s_barrier
    v_pk_fma_f32 v[112:113], v[72:73], v[72:73], s[62:63]
    v_pk_fma_f32 v[114:115], v[74:75], v[74:75], s[62:63]
    v_pk_fma_f32 v[116:117], v[76:77], v[76:77], s[62:63]
    v_pk_fma_f32 v[118:119], v[78:79], v[78:79], s[62:63]
    v_pk_fma_f32 v[120:121], v[80:81], v[80:81], s[62:63]
    v_pk_fma_f32 v[122:123], v[82:83], v[82:83], s[62:63]
    v_pk_fma_f32 v[124:125], v[84:85], v[84:85], s[62:63]
    v_pk_fma_f32 v[126:127], v[86:87], v[86:87], s[62:63]
    v_pk_mul_f32 v[112:113], v[72:73], v[112:113]
    v_pk_mul_f32 v[114:115], v[74:75], v[114:115]
    v_pk_mul_f32 v[116:117], v[76:77], v[116:117]
    v_pk_mul_f32 v[118:119], v[78:79], v[118:119]
    v_pk_mul_f32 v[120:121], v[80:81], v[120:121]
    v_pk_mul_f32 v[122:123], v[82:83], v[122:123]
    v_pk_mul_f32 v[124:125], v[84:85], v[124:125]
    v_pk_mul_f32 v[126:127], v[86:87], v[126:127]
    v_mfma_f32_16x16x32_bf16 v[92:95], v[52:55], a[20:23], v[92:95]
    s_add_u32 s58, s48, 1622272
    v_exp_f32 v112, v112
    v_mfma_f32_16x16x32_bf16 v[96:99], v[48:51], a[8:11], v[132:135]
    buffer_load_dwordx4 v6, s[20:23], s58 offen lds
    v_mfma_f32_16x16x32_bf16 v[96:99], v[52:55], a[24:27], v[96:99]
    s_add_u32 m0, s61, 57344
    ds_read_b64_tr_b16 v[64:65], v4 offset:0
    ds_read_b64_tr_b16 v[66:67], v4 offset:2048
    v_mfma_f32_16x16x32_bf16 v[100:103], v[48:51], a[12:15], v[132:135]
    s_add_u32 s58, s48, 1990912
    v_exp_f32 v113, v113
    v_mfma_f32_16x16x32_bf16 v[100:103], v[52:55], a[28:31], v[100:103]
    s_waitcnt lgkmcnt(2)
    v_exp_f32 v114, v114
    v_mfma_f32_16x16x32_bf16 v[88:91], v[56:59], a[32:35], v[88:91]
    buffer_load_dwordx4 v6, s[20:23], s58 offen lds
    v_mfma_f32_16x16x32_bf16 v[88:91], v[60:63], a[48:51], v[88:91]
    s_add_u32 m0, s61, 61440
    ds_read_b64_tr_b16 v[68:69], v5 offset:32768
    ds_read_b64_tr_b16 v[70:71], v5 offset:34816
    v_mfma_f32_16x16x32_bf16 v[92:95], v[56:59], a[36:39], v[92:95]
    s_add_u32 s58, s48, 2285824
    v_exp_f32 v115, v115
    v_mfma_f32_16x16x32_bf16 v[92:95], v[60:63], a[52:55], v[92:95]
    v_exp_f32 v116, v116
    v_mfma_f32_16x16x32_bf16 v[96:99], v[56:59], a[40:43], v[96:99]
    buffer_load_dwordx4 v6, s[20:23], s58 offen lds
    v_mfma_f32_16x16x32_bf16 v[96:99], v[60:63], a[56:59], v[96:99]
    s_add_u32 m0, s61, 65536
    ds_read_b64_tr_b16 v[48:49], v5 offset:36864
    ds_read_b64_tr_b16 v[50:51], v5 offset:38912
    v_mfma_f32_16x16x32_bf16 v[100:103], v[56:59], a[44:47], v[100:103]
    s_add_u32 s58, s48, 2654464
    v_exp_f32 v117, v117
    v_mfma_f32_16x16x32_bf16 v[100:103], v[60:63], a[60:63], v[100:103]
    s_waitcnt lgkmcnt(2)
    v_exp_f32 v118, v118
    v_mfma_f32_16x16x32_bf16 v[88:91], v[64:67], a[64:67], v[88:91]
    buffer_load_dwordx4 v6, s[20:23], s58 offen lds
    v_mfma_f32_16x16x32_bf16 v[88:91], v[68:71], a[80:83], v[88:91]
    s_add_u32 m0, s61, 69632
    ds_read_b64_tr_b16 v[52:53], v4 offset:4096
    ds_read_b64_tr_b16 v[54:55], v4 offset:6144
    v_mfma_f32_16x16x32_bf16 v[92:95], v[64:67], a[68:71], v[92:95]
    s_add_u32 s58, s48, 2949376
    v_exp_f32 v119, v119
    v_mfma_f32_16x16x32_bf16 v[92:95], v[68:71], a[84:87], v[92:95]
    v_exp_f32 v120, v120
    v_mfma_f32_16x16x32_bf16 v[96:99], v[64:67], a[72:75], v[96:99]
    buffer_load_dwordx4 v6, s[20:23], s58 offen lds
    v_mfma_f32_16x16x32_bf16 v[96:99], v[68:71], a[88:91], v[96:99]
    s_add_u32 m0, s61, 73728
    ds_read_b64_tr_b16 v[56:57], v4 offset:8192
    ds_read_b64_tr_b16 v[58:59], v4 offset:10240
    v_mfma_f32_16x16x32_bf16 v[100:103], v[64:67], a[76:79], v[100:103]
    s_add_u32 s58, s48, 3318016
    v_exp_f32 v121, v121
    v_mfma_f32_16x16x32_bf16 v[100:103], v[68:71], a[92:95], v[100:103]
    s_waitcnt lgkmcnt(2)
    v_exp_f32 v122, v122
    v_mfma_f32_16x16x32_bf16 v[88:91], v[48:51], a[96:99], v[88:91]
    buffer_load_dwordx4 v6, s[20:23], s58 offen lds
    v_mfma_f32_16x16x32_bf16 v[88:91], v[52:55], a[112:115], v[88:91]
    s_add_u32 m0, s61, 0
    ds_read_b64_tr_b16 v[60:61], v4 offset:12288
    ds_read_b64_tr_b16 v[62:63], v4 offset:14336
    v_mfma_f32_16x16x32_bf16 v[92:95], v[48:51], a[100:103], v[92:95]
    s_waitcnt vmcnt(13) lgkmcnt(4)
    s_barrier
    v_exp_f32 v123, v123
    v_mfma_f32_16x16x32_bf16 v[92:95], v[52:55], a[116:119], v[92:95]
    s_add_u32 s58, s48, 3612928
    v_exp_f32 v124, v124
    v_mfma_f32_16x16x32_bf16 v[96:99], v[48:51], a[104:107], v[96:99]
    buffer_load_dwordx4 v6, s[20:23], s58 offen lds
    v_mfma_f32_16x16x32_bf16 v[96:99], v[52:55], a[120:123], v[96:99]
    s_add_u32 m0, s61, 4096
    ds_read_b64_tr_b16 v[64:65], v5 offset:40960
    ds_read_b64_tr_b16 v[66:67], v5 offset:43008
    v_mfma_f32_16x16x32_bf16 v[100:103], v[48:51], a[108:111], v[100:103]
    s_add_u32 s58, s48, 3981568
    v_exp_f32 v125, v125
    v_mfma_f32_16x16x32_bf16 v[100:103], v[52:55], a[124:127], v[100:103]
    s_waitcnt lgkmcnt(2)
    v_exp_f32 v126, v126
    v_exp_f32 v127, v127
    v_pk_add_f32 v[112:113], v[112:113], 1.0 op_sel_hi:[1,0]
    v_pk_add_f32 v[114:115], v[114:115], 1.0 op_sel_hi:[1,0]
    v_pk_add_f32 v[116:117], v[116:117], 1.0 op_sel_hi:[1,0]
    v_pk_add_f32 v[118:119], v[118:119], 1.0 op_sel_hi:[1,0]
    v_pk_add_f32 v[120:121], v[120:121], 1.0 op_sel_hi:[1,0]
    v_pk_add_f32 v[122:123], v[122:123], 1.0 op_sel_hi:[1,0]
    v_pk_add_f32 v[124:125], v[124:125], 1.0 op_sel_hi:[1,0]
    v_pk_add_f32 v[126:127], v[126:127], 1.0 op_sel_hi:[1,0]
    v_mfma_f32_16x16x32_bf16 v[88:91], v[56:59], a[128:131], v[88:91]
    buffer_load_dwordx4 v6, s[20:23], s58 offen lds
    v_mfma_f32_16x16x32_bf16 v[88:91], v[60:63], a[144:147], v[88:91]
    s_add_u32 m0, s61, 77824
    ds_read_b64_tr_b16 v[68:69], v4 offset:16384
    ds_read_b64_tr_b16 v[70:71], v4 offset:18432
    v_mfma_f32_16x16x32_bf16 v[92:95], v[56:59], a[132:135], v[92:95]
    s_add_u32 s58, s48, 4276480
    v_rcp_f32 v112, v112
    v_mfma_f32_16x16x32_bf16 v[92:95], v[60:63], a[148:151], v[92:95]
    v_rcp_f32 v113, v113
    v_mfma_f32_16x16x32_bf16 v[96:99], v[56:59], a[136:139], v[96:99]
    buffer_load_dwordx4 v6, s[20:23], s58 offen lds
    v_mfma_f32_16x16x32_bf16 v[96:99], v[60:63], a[152:155], v[96:99]
    s_add_u32 m0, s61, 81920
    ds_read_b64_tr_b16 v[48:49], v4 offset:20480
    ds_read_b64_tr_b16 v[50:51], v4 offset:22528
    v_mfma_f32_16x16x32_bf16 v[100:103], v[56:59], a[140:143], v[100:103]
    s_add_u32 s58, s48, 4645120
    v_rcp_f32 v114, v114
    v_mfma_f32_16x16x32_bf16 v[100:103], v[60:63], a[156:159], v[100:103]
    s_waitcnt lgkmcnt(2)
    v_rcp_f32 v115, v115
    v_mfma_f32_16x16x32_bf16 v[88:91], v[64:67], a[160:163], v[88:91]
    buffer_load_dwordx4 v6, s[20:23], s58 offen lds
    v_mfma_f32_16x16x32_bf16 v[88:91], v[68:71], a[176:179], v[88:91]
    s_add_u32 m0, s61, 86016
    ds_read_b64_tr_b16 v[52:53], v4 offset:24576
    ds_read_b64_tr_b16 v[54:55], v4 offset:26624
    v_mfma_f32_16x16x32_bf16 v[92:95], v[64:67], a[164:167], v[92:95]
    s_add_u32 s58, s48, 4940032
    v_rcp_f32 v116, v116
    v_mfma_f32_16x16x32_bf16 v[92:95], v[68:71], a[180:183], v[92:95]
    v_rcp_f32 v117, v117
    v_mfma_f32_16x16x32_bf16 v[96:99], v[64:67], a[168:171], v[96:99]
    buffer_load_dwordx4 v6, s[20:23], s58 offen lds
    v_mfma_f32_16x16x32_bf16 v[96:99], v[68:71], a[184:187], v[96:99]
    s_add_u32 m0, s61, 90112
    ds_read_b64_tr_b16 v[56:57], v5 offset:45056
    ds_read_b64_tr_b16 v[58:59], v5 offset:47104
    v_mfma_f32_16x16x32_bf16 v[100:103], v[64:67], a[172:175], v[100:103]
    s_add_u32 s58, s48, 256
    v_rcp_f32 v118, v118
    v_mfma_f32_16x16x32_bf16 v[100:103], v[68:71], a[188:191], v[100:103]
    s_waitcnt lgkmcnt(2)
    v_rcp_f32 v119, v119
    v_mfma_f32_16x16x32_bf16 v[88:91], v[48:51], a[192:195], v[88:91]
    buffer_load_dwordx4 v7, s[20:23], s58 offen lds
    v_mfma_f32_16x16x32_bf16 v[88:91], v[52:55], a[208:211], v[88:91]
    s_add_u32 m0, s61, 8192
    ds_read_b64_tr_b16 v[60:61], v5 offset:49152
    ds_read_b64_tr_b16 v[62:63], v5 offset:51200
    v_mfma_f32_16x16x32_bf16 v[92:95], v[48:51], a[196:199], v[92:95]
    s_waitcnt vmcnt(13) lgkmcnt(4)
    s_barrier
    v_rcp_f32 v120, v120
    v_mfma_f32_16x16x32_bf16 v[92:95], v[52:55], a[212:215], v[92:95]
    s_add_u32 s58, s48, 2654464
    v_rcp_f32 v121, v121
    v_mfma_f32_16x16x32_bf16 v[96:99], v[48:51], a[200:203], v[96:99]
    buffer_load_dwordx4 v7, s[20:23], s58 offen lds
    v_mfma_f32_16x16x32_bf16 v[96:99], v[52:55], a[216:219], v[96:99]
    s_add_u32 m0, s61, 12288
    ds_read_b64_tr_b16 v[64:65], v5 offset:53248
    ds_read_b64_tr_b16 v[66:67], v5 offset:55296
    v_mfma_f32_16x16x32_bf16 v[100:103], v[48:51], a[204:207], v[100:103]
    s_add_u32 s58, s48, 384
    v_rcp_f32 v122, v122
    v_mfma_f32_16x16x32_bf16 v[100:103], v[52:55], a[220:223], v[100:103]
    s_waitcnt lgkmcnt(2)
    v_rcp_f32 v123, v123
    v_mfma_f32_16x16x32_bf16 v[88:91], v[56:59], a[224:227], v[88:91]
    buffer_load_dwordx4 v6, s[20:23], s58 offen lds
    v_mfma_f32_16x16x32_bf16 v[88:91], v[60:63], a[240:243], v[88:91]
    s_add_u32 m0, s61, 16384
    ds_read_b64_tr_b16 v[68:69], v4 offset:28672
    ds_read_b64_tr_b16 v[70:71], v4 offset:30720
    v_mfma_f32_16x16x32_bf16 v[92:95], v[56:59], a[228:231], v[92:95]
    s_add_u32 s58, s48, 295296
    v_rcp_f32 v124, v124
    v_mfma_f32_16x16x32_bf16 v[92:95], v[60:63], a[244:247], v[92:95]
    v_rcp_f32 v125, v125
    v_mfma_f32_16x16x32_bf16 v[96:99], v[56:59], a[232:235], v[96:99]
    buffer_load_dwordx4 v6, s[20:23], s58 offen lds
    v_mfma_f32_16x16x32_bf16 v[96:99], v[60:63], a[248:251], v[96:99]
    s_add_u32 m0, s61, 20480
    ds_read_b64_tr_b16 v[48:49], v4 offset:32768
    ds_read_b64_tr_b16 v[50:51], v4 offset:34816
    v_mfma_f32_16x16x32_bf16 v[100:103], v[56:59], a[236:239], v[100:103]
    s_add_u32 s58, s48, 663936
    v_rcp_f32 v126, v126
    v_rcp_f32 v127, v127
    v_pk_mul_f32 v[112:113], v[72:73], v[112:113]
    v_pk_mul_f32 v[114:115], v[74:75], v[114:115]
    v_pk_mul_f32 v[116:117], v[76:77], v[116:117]
    v_pk_mul_f32 v[118:119], v[78:79], v[118:119]
    v_pk_mul_f32 v[120:121], v[80:81], v[120:121]
    v_pk_mul_f32 v[122:123], v[82:83], v[122:123]
    v_pk_mul_f32 v[124:125], v[84:85], v[124:125]
    v_pk_mul_f32 v[126:127], v[86:87], v[126:127]
    v_mfma_f32_16x16x32_bf16 v[100:103], v[60:63], a[252:255], v[100:103]
    s_waitcnt lgkmcnt(2)
    v_cvt_pk_bf16_f32 v164, v112, v113
    v_cvt_pk_bf16_f32 v165, v114, v115
    v_mfma_f32_16x16x32_bf16 v[88:91], v[64:67], v[16:19], v[88:91]
    buffer_load_dwordx4 v6, s[20:23], s58 offen lds
    v_mfma_f32_16x16x32_bf16 v[88:91], v[68:71], v[32:35], v[88:91]
    s_add_u32 m0, s61, 24576
    ds_read_b64_tr_b16 v[52:53], v4 offset:36864
    ds_read_b64_tr_b16 v[54:55], v4 offset:38912
    v_mfma_f32_16x16x32_bf16 v[92:95], v[64:67], v[20:23], v[92:95]
    s_add_u32 s58, s48, 958848
    v_cvt_pk_bf16_f32 v168, v116, v117
    v_cvt_pk_bf16_f32 v169, v118, v119
    v_mfma_f32_16x16x32_bf16 v[92:95], v[68:71], v[36:39], v[92:95]
    v_cvt_pk_bf16_f32 v172, v120, v121
    v_cvt_pk_bf16_f32 v173, v122, v123
    v_mfma_f32_16x16x32_bf16 v[96:99], v[64:67], v[24:27], v[96:99]
    buffer_load_dwordx4 v6, s[20:23], s58 offen lds
    v_mfma_f32_16x16x32_bf16 v[96:99], v[68:71], v[40:43], v[96:99]
    s_add_u32 m0, s61, 94208
    ds_read_b64_tr_b16 v[56:57], v4 offset:40960
    ds_read_b64_tr_b16 v[58:59], v4 offset:43008
    v_mfma_f32_16x16x32_bf16 v[100:103], v[64:67], v[28:31], v[100:103]
    s_add_u32 s58, s48, 1327488
    v_cvt_pk_bf16_f32 v176, v124, v125
    v_cvt_pk_bf16_f32 v177, v126, v127
    v_mfma_f32_16x16x32_bf16 v[100:103], v[68:71], v[44:47], v[100:103]
    s_waitcnt lgkmcnt(2)
    v_mfma_f32_16x16x32_bf16 v[72:75], v[48:51], a[0:3], v[136:139]
    buffer_load_dwordx4 v6, s[20:23], s58 offen lds
    v_mfma_f32_16x16x32_bf16 v[72:75], v[52:55], a[16:19], v[72:75]
    s_add_u32 m0, s61, 28672
    ds_read_b64_tr_b16 v[60:61], v4 offset:45056
    ds_read_b64_tr_b16 v[62:63], v4 offset:47104
    v_mfma_f32_16x16x32_bf16 v[76:79], v[48:51], a[4:7], v[136:139]
    s_waitcnt vmcnt(13) lgkmcnt(4)
    s_barrier
    v_pk_fma_f32 v[112:113], v[88:89], v[88:89], s[62:63]
    v_pk_fma_f32 v[114:115], v[90:91], v[90:91], s[62:63]
    v_pk_fma_f32 v[116:117], v[92:93], v[92:93], s[62:63]
    v_pk_fma_f32 v[118:119], v[94:95], v[94:95], s[62:63]
    v_pk_fma_f32 v[120:121], v[96:97], v[96:97], s[62:63]
    v_pk_fma_f32 v[122:123], v[98:99], v[98:99], s[62:63]
    v_pk_fma_f32 v[124:125], v[100:101], v[100:101], s[62:63]
    v_pk_fma_f32 v[126:127], v[102:103], v[102:103], s[62:63]
    v_pk_mul_f32 v[112:113], v[88:89], v[112:113]
    v_pk_mul_f32 v[114:115], v[90:91], v[114:115]
    v_pk_mul_f32 v[116:117], v[92:93], v[116:117]
    v_pk_mul_f32 v[118:119], v[94:95], v[118:119]
    v_pk_mul_f32 v[120:121], v[96:97], v[120:121]
    v_pk_mul_f32 v[122:123], v[98:99], v[122:123]
    v_pk_mul_f32 v[124:125], v[100:101], v[124:125]
    v_pk_mul_f32 v[126:127], v[102:103], v[126:127]
    v_mfma_f32_16x16x32_bf16 v[76:79], v[52:55], a[20:23], v[76:79]
    s_add_u32 s58, s48, 1622400
    v_exp_f32 v112, v112
    v_mfma_f32_16x16x32_bf16 v[80:83], v[48:51], a[8:11], v[136:139]
    buffer_load_dwordx4 v6, s[20:23], s58 offen lds
    v_mfma_f32_16x16x32_bf16 v[80:83], v[52:55], a[24:27], v[80:83]
    s_add_u32 m0, s61, 32768
    ds_read_b64_tr_b16 v[64:65], v4 offset:49152
    ds_read_b64_tr_b16 v[66:67], v4 offset:51200
    v_mfma_f32_16x16x32_bf16 v[84:87], v[48:51], a[12:15], v[136:139]
    s_add_u32 s58, s48, 1991040
    v_exp_f32 v113, v113
    v_mfma_f32_16x16x32_bf16 v[84:87], v[52:55], a[28:31], v[84:87]
    s_waitcnt lgkmcnt(2)
    v_exp_f32 v114, v114
    v_mfma_f32_16x16x32_bf16 v[72:75], v[56:59], a[32:35], v[72:75]
    buffer_load_dwordx4 v6, s[20:23], s58 offen lds
    v_mfma_f32_16x16x32_bf16 v[72:75], v[60:63], a[48:51], v[72:75]
    s_add_u32 m0, s61, 36864
    ds_read_b64_tr_b16 v[68:69], v4 offset:53248
    ds_read_b64_tr_b16 v[70:71], v4 offset:55296
    v_mfma_f32_16x16x32_bf16 v[76:79], v[56:59], a[36:39], v[76:79]
    s_add_u32 s58, s48, 2285952
    v_exp_f32 v115, v115
    v_mfma_f32_16x16x32_bf16 v[76:79], v[60:63], a[52:55], v[76:79]
    v_exp_f32 v116, v116
    v_mfma_f32_16x16x32_bf16 v[80:83], v[56:59], a[40:43], v[80:83]
    buffer_load_dwordx4 v6, s[20:23], s58 offen lds
    v_mfma_f32_16x16x32_bf16 v[80:83], v[60:63], a[56:59], v[80:83]
    s_add_u32 m0, s61, 98304
    ds_read_b64_tr_b16 v[48:49], v4 offset:57344
    ds_read_b64_tr_b16 v[50:51], v4 offset:59392
    v_mfma_f32_16x16x32_bf16 v[84:87], v[56:59], a[44:47], v[84:87]
    s_add_u32 s58, s48, 2654592
    v_exp_f32 v117, v117
    v_mfma_f32_16x16x32_bf16 v[84:87], v[60:63], a[60:63], v[84:87]
    s_waitcnt lgkmcnt(2)
    v_exp_f32 v118, v118
    v_mfma_f32_16x16x32_bf16 v[72:75], v[64:67], a[64:67], v[72:75]
    buffer_load_dwordx4 v6, s[20:23], s58 offen lds
    v_mfma_f32_16x16x32_bf16 v[72:75], v[68:71], a[80:83], v[72:75]
    s_add_u32 m0, s61, 102400
    ds_read_b64_tr_b16 v[52:53], v4 offset:61440
    ds_read_b64_tr_b16 v[54:55], v4 offset:63488
    v_mfma_f32_16x16x32_bf16 v[76:79], v[64:67], a[68:71], v[76:79]
    s_add_u32 s58, s48, 2949504
    v_exp_f32 v119, v119
    v_mfma_f32_16x16x32_bf16 v[76:79], v[68:71], a[84:87], v[76:79]
    v_exp_f32 v120, v120
    v_mfma_f32_16x16x32_bf16 v[80:83], v[64:67], a[72:75], v[80:83]
    buffer_load_dwordx4 v6, s[20:23], s58 offen lds
    v_mfma_f32_16x16x32_bf16 v[80:83], v[68:71], a[88:91], v[80:83]
    s_add_u32 m0, s61, 106496
    ds_read_b64_tr_b16 v[56:57], v5 offset:0
    ds_read_b64_tr_b16 v[58:59], v5 offset:2048
    v_mfma_f32_16x16x32_bf16 v[84:87], v[64:67], a[76:79], v[84:87]
    s_add_u32 s58, s48, 3318144
    v_exp_f32 v121, v121
    v_mfma_f32_16x16x32_bf16 v[84:87], v[68:71], a[92:95], v[84:87]
    s_waitcnt lgkmcnt(2)
    v_exp_f32 v122, v122
    v_mfma_f32_16x16x32_bf16 v[72:75], v[48:51], a[96:99], v[72:75]
    buffer_load_dwordx4 v6, s[20:23], s58 offen lds
    v_mfma_f32_16x16x32_bf16 v[72:75], v[52:55], a[112:115], v[72:75]
    s_add_u32 m0, s61, 40960
    ds_read_b64_tr_b16 v[60:61], v5 offset:4096
    ds_read_b64_tr_b16 v[62:63], v5 offset:6144
    v_mfma_f32_16x16x32_bf16 v[76:79], v[48:51], a[100:103], v[76:79]
    s_waitcnt vmcnt(13) lgkmcnt(4)
    s_barrier
    v_exp_f32 v123, v123
    v_mfma_f32_16x16x32_bf16 v[76:79], v[52:55], a[116:119], v[76:79]
    s_add_u32 s58, s48, 3613056
    v_exp_f32 v124, v124
    v_mfma_f32_16x16x32_bf16 v[80:83], v[48:51], a[104:107], v[80:83]
    buffer_load_dwordx4 v6, s[20:23], s58 offen lds
    v_mfma_f32_16x16x32_bf16 v[80:83], v[52:55], a[120:123], v[80:83]
    s_add_u32 m0, s61, 45056
    ds_read_b64_tr_b16 v[64:65], v5 offset:8192
    ds_read_b64_tr_b16 v[66:67], v5 offset:10240
    v_mfma_f32_16x16x32_bf16 v[84:87], v[48:51], a[108:111], v[84:87]
    s_add_u32 s58, s48, 3981696
    v_exp_f32 v125, v125
    v_mfma_f32_16x16x32_bf16 v[84:87], v[52:55], a[124:127], v[84:87]
    s_waitcnt lgkmcnt(2)
    v_exp_f32 v126, v126
    v_exp_f32 v127, v127
    v_pk_add_f32 v[112:113], v[112:113], 1.0 op_sel_hi:[1,0]
    v_pk_add_f32 v[114:115], v[114:115], 1.0 op_sel_hi:[1,0]
    v_pk_add_f32 v[116:117], v[116:117], 1.0 op_sel_hi:[1,0]
    v_pk_add_f32 v[118:119], v[118:119], 1.0 op_sel_hi:[1,0]
    v_pk_add_f32 v[120:121], v[120:121], 1.0 op_sel_hi:[1,0]
    v_pk_add_f32 v[122:123], v[122:123], 1.0 op_sel_hi:[1,0]
    v_pk_add_f32 v[124:125], v[124:125], 1.0 op_sel_hi:[1,0]
    v_pk_add_f32 v[126:127], v[126:127], 1.0 op_sel_hi:[1,0]
    v_mfma_f32_16x16x32_bf16 v[72:75], v[56:59], a[128:131], v[72:75]
    buffer_load_dwordx4 v6, s[20:23], s58 offen lds
    v_mfma_f32_16x16x32_bf16 v[72:75], v[60:63], a[144:147], v[72:75]
    s_add_u32 m0, s61, 49152
    ds_read_b64_tr_b16 v[68:69], v4 offset:0
    ds_read_b64_tr_b16 v[70:71], v4 offset:2048
    v_mfma_f32_16x16x32_bf16 v[76:79], v[56:59], a[132:135], v[76:79]
    s_add_u32 s58, s48, 4276608
    v_rcp_f32 v112, v112
    v_mfma_f32_16x16x32_bf16 v[76:79], v[60:63], a[148:151], v[76:79]
    v_rcp_f32 v113, v113
    v_mfma_f32_16x16x32_bf16 v[80:83], v[56:59], a[136:139], v[80:83]
    buffer_load_dwordx4 v6, s[20:23], s58 offen lds
    v_mfma_f32_16x16x32_bf16 v[80:83], v[60:63], a[152:155], v[80:83]
    s_add_u32 m0, s61, 53248
    ds_read_b64_tr_b16 v[48:49], v4 offset:4096
    ds_read_b64_tr_b16 v[50:51], v4 offset:6144
    v_mfma_f32_16x16x32_bf16 v[84:87], v[56:59], a[140:143], v[84:87]
    s_add_u32 s58, s48, 4645248
    v_rcp_f32 v114, v114
    v_mfma_f32_16x16x32_bf16 v[84:87], v[60:63], a[156:159], v[84:87]
    s_waitcnt lgkmcnt(2)
    v_rcp_f32 v115, v115
    v_mfma_f32_16x16x32_bf16 v[72:75], v[64:67], a[160:163], v[72:75]
    buffer_load_dwordx4 v6, s[20:23], s58 offen lds
    v_mfma_f32_16x16x32_bf16 v[72:75], v[68:71], a[176:179], v[72:75]
    s_add_u32 m0, s61, 57344
    ds_read_b64_tr_b16 v[52:53], v5 offset:12288
    ds_read_b64_tr_b16 v[54:55], v5 offset:14336
    v_mfma_f32_16x16x32_bf16 v[76:79], v[64:67], a[164:167], v[76:79]
    s_add_u32 s58, s48, 4940160
    v_rcp_f32 v116, v116
    v_mfma_f32_16x16x32_bf16 v[76:79], v[68:71], a[180:183], v[76:79]
    v_rcp_f32 v117, v117
    v_mfma_f32_16x16x32_bf16 v[80:83], v[64:67], a[168:171], v[80:83]
    buffer_load_dwordx4 v6, s[20:23], s58 offen lds
    v_mfma_f32_16x16x32_bf16 v[80:83], v[68:71], a[184:187], v[80:83]
    s_add_u32 m0, s61, 61440
    ds_read_b64_tr_b16 v[56:57], v5 offset:16384
    ds_read_b64_tr_b16 v[58:59], v5 offset:18432
    v_mfma_f32_16x16x32_bf16 v[84:87], v[64:67], a[172:175], v[84:87]
    s_add_u32 s58, s48, 384
    v_rcp_f32 v118, v118
    v_mfma_f32_16x16x32_bf16 v[84:87], v[68:71], a[188:191], v[84:87]
    s_waitcnt lgkmcnt(2)
    v_rcp_f32 v119, v119
    v_mfma_f32_16x16x32_bf16 v[72:75], v[48:51], a[192:195], v[72:75]
    buffer_load_dwordx4 v7, s[20:23], s58 offen lds
    v_mfma_f32_16x16x32_bf16 v[72:75], v[52:55], a[208:211], v[72:75]
    s_add_u32 m0, s61, 0
    ds_read_b64_tr_b16 v[60:61], v5 offset:20480
    ds_read_b64_tr_b16 v[62:63], v5 offset:22528
    v_mfma_f32_16x16x32_bf16 v[76:79], v[48:51], a[196:199], v[76:79]
    s_waitcnt vmcnt(13) lgkmcnt(4)
    s_barrier
    v_rcp_f32 v120, v120
    v_mfma_f32_16x16x32_bf16 v[76:79], v[52:55], a[212:215], v[76:79]
    s_add_u32 s58, s48, 2654592
    v_rcp_f32 v121, v121
    v_mfma_f32_16x16x32_bf16 v[80:83], v[48:51], a[200:203], v[80:83]
    buffer_load_dwordx4 v7, s[20:23], s58 offen lds
    v_mfma_f32_16x16x32_bf16 v[80:83], v[52:55], a[216:219], v[80:83]
    s_add_u32 m0, s61, 4096
    ds_read_b64_tr_b16 v[64:65], v5 offset:24576
    ds_read_b64_tr_b16 v[66:67], v5 offset:26624
    v_mfma_f32_16x16x32_bf16 v[84:87], v[48:51], a[204:207], v[84:87]
    s_add_u32 s58, s48, 512
    v_rcp_f32 v122, v122
    v_mfma_f32_16x16x32_bf16 v[84:87], v[52:55], a[220:223], v[84:87]
    s_waitcnt lgkmcnt(2)
    v_rcp_f32 v123, v123
    v_mfma_f32_16x16x32_bf16 v[72:75], v[56:59], a[224:227], v[72:75]
    buffer_load_dwordx4 v6, s[20:23], s58 offen lds
    v_mfma_f32_16x16x32_bf16 v[72:75], v[60:63], a[240:243], v[72:75]
    s_add_u32 m0, s61, 65536
    ds_read_b64_tr_b16 v[68:69], v4 offset:8192
    ds_read_b64_tr_b16 v[70:71], v4 offset:10240
    v_mfma_f32_16x16x32_bf16 v[76:79], v[56:59], a[228:231], v[76:79]
    s_add_u32 s58, s48, 295424
    v_rcp_f32 v124, v124
    v_mfma_f32_16x16x32_bf16 v[76:79], v[60:63], a[244:247], v[76:79]
    v_rcp_f32 v125, v125
    v_mfma_f32_16x16x32_bf16 v[80:83], v[56:59], a[232:235], v[80:83]
    buffer_load_dwordx4 v6, s[20:23], s58 offen lds
    v_mfma_f32_16x16x32_bf16 v[80:83], v[60:63], a[248:251], v[80:83]
    s_add_u32 m0, s61, 69632
    ds_read_b64_tr_b16 v[48:49], v4 offset:12288
    ds_read_b64_tr_b16 v[50:51], v4 offset:14336
    v_mfma_f32_16x16x32_bf16 v[84:87], v[56:59], a[236:239], v[84:87]
    s_add_u32 s58, s48, 664064
    v_rcp_f32 v126, v126
    v_rcp_f32 v127, v127
    v_pk_mul_f32 v[112:113], v[88:89], v[112:113]
    v_pk_mul_f32 v[114:115], v[90:91], v[114:115]
    v_pk_mul_f32 v[116:117], v[92:93], v[116:117]
    v_pk_mul_f32 v[118:119], v[94:95], v[118:119]
    v_pk_mul_f32 v[120:121], v[96:97], v[120:121]
    v_pk_mul_f32 v[122:123], v[98:99], v[122:123]
    v_pk_mul_f32 v[124:125], v[100:101], v[124:125]
    v_pk_mul_f32 v[126:127], v[102:103], v[126:127]
    v_mfma_f32_16x16x32_bf16 v[84:87], v[60:63], a[252:255], v[84:87]
    s_waitcnt lgkmcnt(2)
    v_cvt_pk_bf16_f32 v166, v112, v113
    v_cvt_pk_bf16_f32 v167, v114, v115
    v_mfma_f32_16x16x32_bf16 v[72:75], v[64:67], v[16:19], v[72:75]
    buffer_load_dwordx4 v6, s[20:23], s58 offen lds
    v_mfma_f32_16x16x32_bf16 v[72:75], v[68:71], v[32:35], v[72:75]
    s_add_u32 m0, s61, 73728
    ds_read_b64_tr_b16 v[52:53], v4 offset:16384
    ds_read_b64_tr_b16 v[54:55], v4 offset:18432
    v_mfma_f32_16x16x32_bf16 v[76:79], v[64:67], v[20:23], v[76:79]
    s_add_u32 s58, s48, 958976
    v_cvt_pk_bf16_f32 v170, v116, v117
    v_cvt_pk_bf16_f32 v171, v118, v119
    v_mfma_f32_16x16x32_bf16 v[76:79], v[68:71], v[36:39], v[76:79]
    v_cvt_pk_bf16_f32 v174, v120, v121
    v_cvt_pk_bf16_f32 v175, v122, v123
    v_mfma_f32_16x16x32_bf16 v[80:83], v[64:67], v[24:27], v[80:83]
    buffer_load_dwordx4 v6, s[20:23], s58 offen lds
    v_mfma_f32_16x16x32_bf16 v[80:83], v[68:71], v[40:43], v[80:83]
    s_add_u32 m0, s61, 77824
    ds_read_b64_tr_b16 v[56:57], v4 offset:20480
    ds_read_b64_tr_b16 v[58:59], v4 offset:22528
    v_mfma_f32_16x16x32_bf16 v[84:87], v[64:67], v[28:31], v[84:87]
    s_add_u32 s58, s48, 1327616
    v_cvt_pk_bf16_f32 v178, v124, v125
    v_cvt_pk_bf16_f32 v179, v126, v127
    v_mfma_f32_16x16x32_bf16 v[84:87], v[68:71], v[44:47], v[84:87]
    s_waitcnt lgkmcnt(2)
    v_mfma_f32_16x16x32_bf16 v[88:91], v[48:51], a[0:3], v[140:143]
    buffer_load_dwordx4 v6, s[20:23], s58 offen lds
    v_mfma_f32_16x16x32_bf16 v[88:91], v[52:55], a[16:19], v[88:91]
    s_add_u32 m0, s61, 8192
    ds_read_b64_tr_b16 v[60:61], v4 offset:24576
    ds_read_b64_tr_b16 v[62:63], v4 offset:26624
    v_mfma_f32_16x16x32_bf16 v[92:95], v[48:51], a[4:7], v[140:143]
    s_waitcnt vmcnt(13) lgkmcnt(4)
    s_barrier
    v_pk_fma_f32 v[112:113], v[72:73], v[72:73], s[62:63]
    v_pk_fma_f32 v[114:115], v[74:75], v[74:75], s[62:63]
    v_pk_fma_f32 v[116:117], v[76:77], v[76:77], s[62:63]
    v_pk_fma_f32 v[118:119], v[78:79], v[78:79], s[62:63]
    v_pk_fma_f32 v[120:121], v[80:81], v[80:81], s[62:63]
    v_pk_fma_f32 v[122:123], v[82:83], v[82:83], s[62:63]
    v_pk_fma_f32 v[124:125], v[84:85], v[84:85], s[62:63]
    v_pk_fma_f32 v[126:127], v[86:87], v[86:87], s[62:63]
    v_pk_mul_f32 v[112:113], v[72:73], v[112:113]
    v_pk_mul_f32 v[114:115], v[74:75], v[114:115]
    v_pk_mul_f32 v[116:117], v[76:77], v[116:117]
    v_pk_mul_f32 v[118:119], v[78:79], v[118:119]
    v_pk_mul_f32 v[120:121], v[80:81], v[120:121]
    v_pk_mul_f32 v[122:123], v[82:83], v[122:123]
    v_pk_mul_f32 v[124:125], v[84:85], v[124:125]
    v_pk_mul_f32 v[126:127], v[86:87], v[126:127]
    v_mfma_f32_16x16x32_bf16 v[92:95], v[52:55], a[20:23], v[92:95]
    s_add_u32 s58, s48, 1622528
    v_exp_f32 v112, v112
    v_mfma_f32_16x16x32_bf16 v[96:99], v[48:51], a[8:11], v[140:143]
    buffer_load_dwordx4 v6, s[20:23], s58 offen lds
    v_mfma_f32_16x16x32_bf16 v[96:99], v[52:55], a[24:27], v[96:99]
    s_add_u32 m0, s61, 12288
    ds_read_b64_tr_b16 v[64:65], v5 offset:28672
    ds_read_b64_tr_b16 v[66:67], v5 offset:30720
    v_mfma_f32_16x16x32_bf16 v[100:103], v[48:51], a[12:15], v[140:143]
    s_add_u32 s58, s48, 1991168
    v_exp_f32 v113, v113
    v_mfma_f32_16x16x32_bf16 v[100:103], v[52:55], a[28:31], v[100:103]
    s_waitcnt lgkmcnt(2)
    v_exp_f32 v114, v114
    v_mfma_f32_16x16x32_bf16 v[88:91], v[56:59], a[32:35], v[88:91]
    buffer_load_dwordx4 v6, s[20:23], s58 offen lds
    v_mfma_f32_16x16x32_bf16 v[88:91], v[60:63], a[48:51], v[88:91]
    s_add_u32 m0, s61, 16384
    ds_read_b64_tr_b16 v[68:69], v4 offset:28672
    ds_read_b64_tr_b16 v[70:71], v4 offset:30720
    v_mfma_f32_16x16x32_bf16 v[92:95], v[56:59], a[36:39], v[92:95]
    s_add_u32 s58, s48, 2286080
    v_exp_f32 v115, v115
    v_mfma_f32_16x16x32_bf16 v[92:95], v[60:63], a[52:55], v[92:95]
    v_exp_f32 v116, v116
    v_mfma_f32_16x16x32_bf16 v[96:99], v[56:59], a[40:43], v[96:99]
    buffer_load_dwordx4 v6, s[20:23], s58 offen lds
    v_mfma_f32_16x16x32_bf16 v[96:99], v[60:63], a[56:59], v[96:99]
    s_add_u32 m0, s61, 81920
    ds_read_b64_tr_b16 v[48:49], v4 offset:32768
    ds_read_b64_tr_b16 v[50:51], v4 offset:34816
    v_mfma_f32_16x16x32_bf16 v[100:103], v[56:59], a[44:47], v[100:103]
    s_add_u32 s58, s48, 2654720
    v_exp_f32 v117, v117
    v_mfma_f32_16x16x32_bf16 v[100:103], v[60:63], a[60:63], v[100:103]
    s_waitcnt lgkmcnt(2)
    v_exp_f32 v118, v118
    v_mfma_f32_16x16x32_bf16 v[88:91], v[64:67], a[64:67], v[88:91]
    buffer_load_dwordx4 v6, s[20:23], s58 offen lds
    v_mfma_f32_16x16x32_bf16 v[88:91], v[68:71], a[80:83], v[88:91]
    s_add_u32 m0, s61, 86016
    ds_read_b64_tr_b16 v[52:53], v4 offset:36864
    ds_read_b64_tr_b16 v[54:55], v4 offset:38912
    v_mfma_f32_16x16x32_bf16 v[92:95], v[64:67], a[68:71], v[92:95]
    s_add_u32 s58, s48, 2949632
    v_exp_f32 v119, v119
    v_mfma_f32_16x16x32_bf16 v[92:95], v[68:71], a[84:87], v[92:95]
    v_exp_f32 v120, v120
    v_mfma_f32_16x16x32_bf16 v[96:99], v[64:67], a[72:75], v[96:99]
    buffer_load_dwordx4 v6, s[20:23], s58 offen lds
    v_mfma_f32_16x16x32_bf16 v[96:99], v[68:71], a[88:91], v[96:99]
    s_add_u32 m0, s61, 90112
    ds_read_b64_tr_b16 v[56:57], v5 offset:32768
    ds_read_b64_tr_b16 v[58:59], v5 offset:34816
    v_mfma_f32_16x16x32_bf16 v[100:103], v[64:67], a[76:79], v[100:103]
    s_add_u32 s58, s48, 3318272
    v_exp_f32 v121, v121
    v_mfma_f32_16x16x32_bf16 v[100:103], v[68:71], a[92:95], v[100:103]
    s_waitcnt lgkmcnt(2)
    v_exp_f32 v122, v122
    v_mfma_f32_16x16x32_bf16 v[88:91], v[48:51], a[96:99], v[88:91]
    buffer_load_dwordx4 v6, s[20:23], s58 offen lds
    v_mfma_f32_16x16x32_bf16 v[88:91], v[52:55], a[112:115], v[88:91]
    s_add_u32 m0, s61, 20480
    ds_read_b64_tr_b16 v[60:61], v5 offset:36864
    ds_read_b64_tr_b16 v[62:63], v5 offset:38912
    v_mfma_f32_16x16x32_bf16 v[92:95], v[48:51], a[100:103], v[92:95]
    s_waitcnt vmcnt(13) lgkmcnt(4)
    s_barrier
    v_exp_f32 v123, v123
    v_mfma_f32_16x16x32_bf16 v[92:95], v[52:55], a[116:119], v[92:95]
    s_add_u32 s58, s48, 3613184
    v_exp_f32 v124, v124
    v_mfma_f32_16x16x32_bf16 v[96:99], v[48:51], a[104:107], v[96:99]
    buffer_load_dwordx4 v6, s[20:23], s58 offen lds
    v_mfma_f32_16x16x32_bf16 v[96:99], v[52:55], a[120:123], v[96:99]
    s_add_u32 m0, s61, 24576
    ds_read_b64_tr_b16 v[64:65], v5 offset:40960
    ds_read_b64_tr_b16 v[66:67], v5 offset:43008
    v_mfma_f32_16x16x32_bf16 v[100:103], v[48:51], a[108:111], v[100:103]
    s_add_u32 s58, s48, 3981824
    v_exp_f32 v125, v125
    v_mfma_f32_16x16x32_bf16 v[100:103], v[52:55], a[124:127], v[100:103]
    s_waitcnt lgkmcnt(2)
    v_exp_f32 v126, v126
    v_exp_f32 v127, v127
    v_pk_add_f32 v[112:113], v[112:113], 1.0 op_sel_hi:[1,0]
    v_pk_add_f32 v[114:115], v[114:115], 1.0 op_sel_hi:[1,0]
    v_pk_add_f32 v[116:117], v[116:117], 1.0 op_sel_hi:[1,0]
    v_pk_add_f32 v[118:119], v[118:119], 1.0 op_sel_hi:[1,0]
    v_pk_add_f32 v[120:121], v[120:121], 1.0 op_sel_hi:[1,0]
    v_pk_add_f32 v[122:123], v[122:123], 1.0 op_sel_hi:[1,0]
    v_pk_add_f32 v[124:125], v[124:125], 1.0 op_sel_hi:[1,0]
    v_pk_add_f32 v[126:127], v[126:127], 1.0 op_sel_hi:[1,0]
    v_mfma_f32_16x16x32_bf16 v[88:91], v[56:59], a[128:131], v[88:91]
    buffer_load_dwordx4 v6, s[20:23], s58 offen lds
    v_mfma_f32_16x16x32_bf16 v[88:91], v[60:63], a[144:147], v[88:91]
    s_add_u32 m0, s61, 28672
    ds_read_b64_tr_b16 v[68:69], v4 offset:40960
    ds_read_b64_tr_b16 v[70:71], v4 offset:43008
    v_mfma_f32_16x16x32_bf16 v[92:95], v[56:59], a[132:135], v[92:95]
    s_add_u32 s58, s48, 4276736
    v_rcp_f32 v112, v112
    v_mfma_f32_16x16x32_bf16 v[92:95], v[60:63], a[148:151], v[92:95]
    v_rcp_f32 v113, v113
    v_mfma_f32_16x16x32_bf16 v[96:99], v[56:59], a[136:139], v[96:99]
    buffer_load_dwordx4 v6, s[20:23], s58 offen lds
    v_mfma_f32_16x16x32_bf16 v[96:99], v[60:63], a[152:155], v[96:99]
    s_add_u32 m0, s61, 32768
    ds_read_b64_tr_b16 v[48:49], v4 offset:45056
    ds_read_b64_tr_b16 v[50:51], v4 offset:47104
    v_mfma_f32_16x16x32_bf16 v[100:103], v[56:59], a[140:143], v[100:103]
    s_add_u32 s58, s48, 4645376
    v_rcp_f32 v114, v114
    v_mfma_f32_16x16x32_bf16 v[100:103], v[60:63], a[156:159], v[100:103]
    s_waitcnt lgkmcnt(2)
    v_rcp_f32 v115, v115
    v_mfma_f32_16x16x32_bf16 v[88:91], v[64:67], a[160:163], v[88:91]
    buffer_load_dwordx4 v6, s[20:23], s58 offen lds
    v_mfma_f32_16x16x32_bf16 v[88:91], v[68:71], a[176:179], v[88:91]
    s_add_u32 m0, s61, 36864
    ds_read_b64_tr_b16 v[52:53], v4 offset:49152
    ds_read_b64_tr_b16 v[54:55], v4 offset:51200
    v_mfma_f32_16x16x32_bf16 v[92:95], v[64:67], a[164:167], v[92:95]
    s_add_u32 s58, s48, 4940288
    v_rcp_f32 v116, v116
    v_mfma_f32_16x16x32_bf16 v[92:95], v[68:71], a[180:183], v[92:95]
    v_rcp_f32 v117, v117
    v_mfma_f32_16x16x32_bf16 v[96:99], v[64:67], a[168:171], v[96:99]
    buffer_load_dwordx4 v6, s[20:23], s58 offen lds
    v_mfma_f32_16x16x32_bf16 v[96:99], v[68:71], a[184:187], v[96:99]
    s_add_u32 m0, s61, 94208
    ds_read_b64_tr_b16 v[56:57], v4 offset:53248
    ds_read_b64_tr_b16 v[58:59], v4 offset:55296
    v_mfma_f32_16x16x32_bf16 v[100:103], v[64:67], a[172:175], v[100:103]
    s_add_u32 s58, s48, 512
    v_rcp_f32 v118, v118
    v_mfma_f32_16x16x32_bf16 v[100:103], v[68:71], a[188:191], v[100:103]
    s_waitcnt lgkmcnt(2)
    v_rcp_f32 v119, v119
    v_mfma_f32_16x16x32_bf16 v[88:91], v[48:51], a[192:195], v[88:91]
    buffer_load_dwordx4 v7, s[20:23], s58 offen lds
    v_mfma_f32_16x16x32_bf16 v[88:91], v[52:55], a[208:211], v[88:91]
    s_add_u32 m0, s61, 40960
    ds_read_b64_tr_b16 v[60:61], v4 offset:57344
    ds_read_b64_tr_b16 v[62:63], v4 offset:59392
    v_mfma_f32_16x16x32_bf16 v[92:95], v[48:51], a[196:199], v[92:95]
    s_waitcnt vmcnt(13) lgkmcnt(4)
    s_barrier
    v_rcp_f32 v120, v120
    v_mfma_f32_16x16x32_bf16 v[92:95], v[52:55], a[212:215], v[92:95]
    s_add_u32 s58, s48, 2654720
    v_rcp_f32 v121, v121
    v_mfma_f32_16x16x32_bf16 v[96:99], v[48:51], a[200:203], v[96:99]
    buffer_load_dwordx4 v7, s[20:23], s58 offen lds
    v_mfma_f32_16x16x32_bf16 v[96:99], v[52:55], a[216:219], v[96:99]
    s_add_u32 m0, s61, 45056
    ds_read_b64_tr_b16 v[64:65], v4 offset:61440
    ds_read_b64_tr_b16 v[66:67], v4 offset:63488
    v_mfma_f32_16x16x32_bf16 v[100:103], v[48:51], a[204:207], v[100:103]
    s_add_u32 s58, s48, 640
    v_rcp_f32 v122, v122
    v_mfma_f32_16x16x32_bf16 v[100:103], v[52:55], a[220:223], v[100:103]
    s_waitcnt lgkmcnt(2)
    v_rcp_f32 v123, v123
    v_mfma_f32_16x16x32_bf16 v[88:91], v[56:59], a[224:227], v[88:91]
    buffer_load_dwordx4 v6, s[20:23], s58 offen lds
    v_mfma_f32_16x16x32_bf16 v[88:91], v[60:63], a[240:243], v[88:91]
    s_add_u32 m0, s61, 49152
    ds_read_b64_tr_b16 v[68:69], v4 offset:0
    ds_read_b64_tr_b16 v[70:71], v4 offset:2048
    v_mfma_f32_16x16x32_bf16 v[92:95], v[56:59], a[228:231], v[92:95]
    s_add_u32 s58, s48, 295552
    v_rcp_f32 v124, v124
    v_mfma_f32_16x16x32_bf16 v[92:95], v[60:63], a[244:247], v[92:95]
    v_rcp_f32 v125, v125
    v_mfma_f32_16x16x32_bf16 v[96:99], v[56:59], a[232:235], v[96:99]
    buffer_load_dwordx4 v6, s[20:23], s58 offen lds
    v_mfma_f32_16x16x32_bf16 v[96:99], v[60:63], a[248:251], v[96:99]
    s_add_u32 m0, s61, 98304
    ds_read_b64_tr_b16 v[48:49], v4 offset:4096
    ds_read_b64_tr_b16 v[50:51], v4 offset:6144
    v_mfma_f32_16x16x32_bf16 v[100:103], v[56:59], a[236:239], v[100:103]
    s_add_u32 s58, s48, 664192
    v_rcp_f32 v126, v126
    v_rcp_f32 v127, v127
    v_pk_mul_f32 v[112:113], v[72:73], v[112:113]
    v_pk_mul_f32 v[114:115], v[74:75], v[114:115]
    v_pk_mul_f32 v[116:117], v[76:77], v[116:117]
    v_pk_mul_f32 v[118:119], v[78:79], v[118:119]
    v_pk_mul_f32 v[120:121], v[80:81], v[120:121]
    v_pk_mul_f32 v[122:123], v[82:83], v[122:123]
    v_pk_mul_f32 v[124:125], v[84:85], v[124:125]
    v_pk_mul_f32 v[126:127], v[86:87], v[126:127]
    v_mfma_f32_16x16x32_bf16 v[100:103], v[60:63], a[252:255], v[100:103]
    s_waitcnt lgkmcnt(2)
    v_cvt_pk_bf16_f32 v180, v112, v113
    v_cvt_pk_bf16_f32 v181, v114, v115
    v_mfma_f32_16x16x32_bf16 v[88:91], v[64:67], v[16:19], v[88:91]
    buffer_load_dwordx4 v6, s[20:23], s58 offen lds
    v_mfma_f32_16x16x32_bf16 v[88:91], v[68:71], v[32:35], v[88:91]
    s_add_u32 m0, s61, 102400
    ds_read_b64_tr_b16 v[52:53], v5 offset:0
    ds_read_b64_tr_b16 v[54:55], v5 offset:2048
    v_mfma_f32_16x16x32_bf16 v[92:95], v[64:67], v[20:23], v[92:95]
    s_add_u32 s58, s48, 959104
    v_cvt_pk_bf16_f32 v184, v116, v117
    v_cvt_pk_bf16_f32 v185, v118, v119
    v_mfma_f32_16x16x32_bf16 v[92:95], v[68:71], v[36:39], v[92:95]
    v_cvt_pk_bf16_f32 v188, v120, v121
    v_cvt_pk_bf16_f32 v189, v122, v123
    v_mfma_f32_16x16x32_bf16 v[96:99], v[64:67], v[24:27], v[96:99]
    buffer_load_dwordx4 v6, s[20:23], s58 offen lds
    v_mfma_f32_16x16x32_bf16 v[96:99], v[68:71], v[40:43], v[96:99]
    s_add_u32 m0, s61, 106496
    ds_read_b64_tr_b16 v[56:57], v5 offset:4096
    ds_read_b64_tr_b16 v[58:59], v5 offset:6144
    v_mfma_f32_16x16x32_bf16 v[100:103], v[64:67], v[28:31], v[100:103]
    s_add_u32 s58, s48, 1327744
    v_cvt_pk_bf16_f32 v192, v124, v125
    v_cvt_pk_bf16_f32 v193, v126, v127
    v_mfma_f32_16x16x32_bf16 v[100:103], v[68:71], v[44:47], v[100:103]
    s_waitcnt lgkmcnt(2)
    v_mfma_f32_16x16x32_bf16 v[72:75], v[48:51], a[0:3], v[144:147]
    buffer_load_dwordx4 v6, s[20:23], s58 offen lds
    v_mfma_f32_16x16x32_bf16 v[72:75], v[52:55], a[16:19], v[72:75]
    s_add_u32 m0, s61, 0
    ds_read_b64_tr_b16 v[60:61], v5 offset:8192
    ds_read_b64_tr_b16 v[62:63], v5 offset:10240
    v_mfma_f32_16x16x32_bf16 v[76:79], v[48:51], a[4:7], v[144:147]
    s_waitcnt vmcnt(13) lgkmcnt(4)
    s_barrier
    v_pk_fma_f32 v[112:113], v[88:89], v[88:89], s[62:63]
    v_pk_fma_f32 v[114:115], v[90:91], v[90:91], s[62:63]
    v_pk_fma_f32 v[116:117], v[92:93], v[92:93], s[62:63]
    v_pk_fma_f32 v[118:119], v[94:95], v[94:95], s[62:63]
    v_pk_fma_f32 v[120:121], v[96:97], v[96:97], s[62:63]
    v_pk_fma_f32 v[122:123], v[98:99], v[98:99], s[62:63]
    v_pk_fma_f32 v[124:125], v[100:101], v[100:101], s[62:63]
    v_pk_fma_f32 v[126:127], v[102:103], v[102:103], s[62:63]
    v_pk_mul_f32 v[112:113], v[88:89], v[112:113]
    v_pk_mul_f32 v[114:115], v[90:91], v[114:115]
    v_pk_mul_f32 v[116:117], v[92:93], v[116:117]
    v_pk_mul_f32 v[118:119], v[94:95], v[118:119]
    v_pk_mul_f32 v[120:121], v[96:97], v[120:121]
    v_pk_mul_f32 v[122:123], v[98:99], v[122:123]
    v_pk_mul_f32 v[124:125], v[100:101], v[124:125]
    v_pk_mul_f32 v[126:127], v[102:103], v[126:127]
    v_mfma_f32_16x16x32_bf16 v[76:79], v[52:55], a[20:23], v[76:79]
    s_add_u32 s58, s48, 1622656
    v_exp_f32 v112, v112
    v_mfma_f32_16x16x32_bf16 v[80:83], v[48:51], a[8:11], v[144:147]
    buffer_load_dwordx4 v6, s[20:23], s58 offen lds
    v_mfma_f32_16x16x32_bf16 v[80:83], v[52:55], a[24:27], v[80:83]
    s_add_u32 m0, s61, 4096
    ds_read_b64_tr_b16 v[64:65], v5 offset:12288
    ds_read_b64_tr_b16 v[66:67], v5 offset:14336
    v_mfma_f32_16x16x32_bf16 v[84:87], v[48:51], a[12:15], v[144:147]
    s_add_u32 s58, s48, 1991296
    v_exp_f32 v113, v113
    v_mfma_f32_16x16x32_bf16 v[84:87], v[52:55], a[28:31], v[84:87]
    s_waitcnt lgkmcnt(2)
    v_exp_f32 v114, v114
    v_mfma_f32_16x16x32_bf16 v[72:75], v[56:59], a[32:35], v[72:75]
    buffer_load_dwordx4 v6, s[20:23], s58 offen lds
    v_mfma_f32_16x16x32_bf16 v[72:75], v[60:63], a[48:51], v[72:75]
    s_add_u32 m0, s61, 53248
    ds_read_b64_tr_b16 v[68:69], v4 offset:8192
    ds_read_b64_tr_b16 v[70:71], v4 offset:10240
    v_mfma_f32_16x16x32_bf16 v[76:79], v[56:59], a[36:39], v[76:79]
    s_add_u32 s58, s48, 2286208
    v_exp_f32 v115, v115
    v_mfma_f32_16x16x32_bf16 v[76:79], v[60:63], a[52:55], v[76:79]
    v_exp_f32 v116, v116
    v_mfma_f32_16x16x32_bf16 v[80:83], v[56:59], a[40:43], v[80:83]
    buffer_load_dwordx4 v6, s[20:23], s58 offen lds
    v_mfma_f32_16x16x32_bf16 v[80:83], v[60:63], a[56:59], v[80:83]
    s_add_u32 m0, s61, 57344
    ds_read_b64_tr_b16 v[48:49], v4 offset:12288
    ds_read_b64_tr_b16 v[50:51], v4 offset:14336
    v_mfma_f32_16x16x32_bf16 v[84:87], v[56:59], a[44:47], v[84:87]
    s_add_u32 s58, s48, 2654848
    v_exp_f32 v117, v117
    v_mfma_f32_16x16x32_bf16 v[84:87], v[60:63], a[60:63], v[84:87]
    s_waitcnt lgkmcnt(2)
    v_exp_f32 v118, v118
    v_mfma_f32_16x16x32_bf16 v[72:75], v[64:67], a[64:67], v[72:75]
    buffer_load_dwordx4 v6, s[20:23], s58 offen lds
    v_mfma_f32_16x16x32_bf16 v[72:75], v[68:71], a[80:83], v[72:75]
    s_add_u32 m0, s61, 61440
    ds_read_b64_tr_b16 v[52:53], v4 offset:16384
    ds_read_b64_tr_b16 v[54:55], v4 offset:18432
    v_mfma_f32_16x16x32_bf16 v[76:79], v[64:67], a[68:71], v[76:79]
    s_add_u32 s58, s48, 2949760
    v_exp_f32 v119, v119
    v_mfma_f32_16x16x32_bf16 v[76:79], v[68:71], a[84:87], v[76:79]
    v_exp_f32 v120, v120
    v_mfma_f32_16x16x32_bf16 v[80:83], v[64:67], a[72:75], v[80:83]
    buffer_load_dwordx4 v6, s[20:23], s58 offen lds
    v_mfma_f32_16x16x32_bf16 v[80:83], v[68:71], a[88:91], v[80:83]
    s_add_u32 m0, s61, 65536
    ds_read_b64_tr_b16 v[56:57], v5 offset:16384
    ds_read_b64_tr_b16 v[58:59], v5 offset:18432
    v_mfma_f32_16x16x32_bf16 v[84:87], v[64:67], a[76:79], v[84:87]
    s_add_u32 s58, s48, 3318400
    v_exp_f32 v121, v121
    v_mfma_f32_16x16x32_bf16 v[84:87], v[68:71], a[92:95], v[84:87]
    s_waitcnt lgkmcnt(2)
    v_exp_f32 v122, v122
    v_mfma_f32_16x16x32_bf16 v[72:75], v[48:51], a[96:99], v[72:75]
    buffer_load_dwordx4 v6, s[20:23], s58 offen lds
    v_mfma_f32_16x16x32_bf16 v[72:75], v[52:55], a[112:115], v[72:75]
    s_add_u32 m0, s61, 8192
    ds_read_b64_tr_b16 v[60:61], v5 offset:20480
    ds_read_b64_tr_b16 v[62:63], v5 offset:22528
    v_mfma_f32_16x16x32_bf16 v[76:79], v[48:51], a[100:103], v[76:79]
    s_waitcnt vmcnt(13) lgkmcnt(4)
    s_barrier
    v_exp_f32 v123, v123
    v_mfma_f32_16x16x32_bf16 v[76:79], v[52:55], a[116:119], v[76:79]
    s_add_u32 s58, s48, 3613312
    v_exp_f32 v124, v124
    v_mfma_f32_16x16x32_bf16 v[80:83], v[48:51], a[104:107], v[80:83]
    buffer_load_dwordx4 v6, s[20:23], s58 offen lds
    v_mfma_f32_16x16x32_bf16 v[80:83], v[52:55], a[120:123], v[80:83]
    s_add_u32 m0, s61, 12288
    ds_read_b64_tr_b16 v[64:65], v5 offset:24576
    ds_read_b64_tr_b16 v[66:67], v5 offset:26624
    v_mfma_f32_16x16x32_bf16 v[84:87], v[48:51], a[108:111], v[84:87]
    s_add_u32 s58, s48, 3981952
    v_exp_f32 v125, v125
    v_mfma_f32_16x16x32_bf16 v[84:87], v[52:55], a[124:127], v[84:87]
    s_waitcnt lgkmcnt(2)
    v_exp_f32 v126, v126
    v_exp_f32 v127, v127
    v_pk_add_f32 v[112:113], v[112:113], 1.0 op_sel_hi:[1,0]
    v_pk_add_f32 v[114:115], v[114:115], 1.0 op_sel_hi:[1,0]
    v_pk_add_f32 v[116:117], v[116:117], 1.0 op_sel_hi:[1,0]
    v_pk_add_f32 v[118:119], v[118:119], 1.0 op_sel_hi:[1,0]
    v_pk_add_f32 v[120:121], v[120:121], 1.0 op_sel_hi:[1,0]
    v_pk_add_f32 v[122:123], v[122:123], 1.0 op_sel_hi:[1,0]
    v_pk_add_f32 v[124:125], v[124:125], 1.0 op_sel_hi:[1,0]
    v_pk_add_f32 v[126:127], v[126:127], 1.0 op_sel_hi:[1,0]
    v_mfma_f32_16x16x32_bf16 v[72:75], v[56:59], a[128:131], v[72:75]
    buffer_load_dwordx4 v6, s[20:23], s58 offen lds
    v_mfma_f32_16x16x32_bf16 v[72:75], v[60:63], a[144:147], v[72:75]
    s_add_u32 m0, s61, 16384
    ds_read_b64_tr_b16 v[68:69], v4 offset:20480
    ds_read_b64_tr_b16 v[70:71], v4 offset:22528
    v_mfma_f32_16x16x32_bf16 v[76:79], v[56:59], a[132:135], v[76:79]
    s_add_u32 s58, s48, 4276864
    v_rcp_f32 v112, v112
    v_mfma_f32_16x16x32_bf16 v[76:79], v[60:63], a[148:151], v[76:79]
    v_rcp_f32 v113, v113
    v_mfma_f32_16x16x32_bf16 v[80:83], v[56:59], a[136:139], v[80:83]
    buffer_load_dwordx4 v6, s[20:23], s58 offen lds
    v_mfma_f32_16x16x32_bf16 v[80:83], v[60:63], a[152:155], v[80:83]
    s_add_u32 m0, s61, 69632
    ds_read_b64_tr_b16 v[48:49], v4 offset:24576
    ds_read_b64_tr_b16 v[50:51], v4 offset:26624
    v_mfma_f32_16x16x32_bf16 v[84:87], v[56:59], a[140:143], v[84:87]
    s_add_u32 s58, s48, 4645504
    v_rcp_f32 v114, v114
    v_mfma_f32_16x16x32_bf16 v[84:87], v[60:63], a[156:159], v[84:87]
    s_waitcnt lgkmcnt(2)
    v_rcp_f32 v115, v115
    v_mfma_f32_16x16x32_bf16 v[72:75], v[64:67], a[160:163], v[72:75]
    buffer_load_dwordx4 v6, s[20:23], s58 offen lds
    v_mfma_f32_16x16x32_bf16 v[72:75], v[68:71], a[176:179], v[72:75]
    s_add_u32 m0, s61, 73728
    ds_read_b64_tr_b16 v[52:53], v4 offset:28672
    ds_read_b64_tr_b16 v[54:55], v4 offset:30720
    v_mfma_f32_16x16x32_bf16 v[76:79], v[64:67], a[164:167], v[76:79]
    s_add_u32 s58, s48, 4940416
    v_rcp_f32 v116, v116
    v_mfma_f32_16x16x32_bf16 v[76:79], v[68:71], a[180:183], v[76:79]
    v_rcp_f32 v117, v117
    v_mfma_f32_16x16x32_bf16 v[80:83], v[64:67], a[168:171], v[80:83]
    buffer_load_dwordx4 v6, s[20:23], s58 offen lds
    v_mfma_f32_16x16x32_bf16 v[80:83], v[68:71], a[184:187], v[80:83]
    s_add_u32 m0, s61, 77824
    ds_read_b64_tr_b16 v[56:57], v4 offset:32768
    ds_read_b64_tr_b16 v[58:59], v4 offset:34816
    v_mfma_f32_16x16x32_bf16 v[84:87], v[64:67], a[172:175], v[84:87]
    s_add_u32 s58, s48, 640
    v_rcp_f32 v118, v118
    v_mfma_f32_16x16x32_bf16 v[84:87], v[68:71], a[188:191], v[84:87]
    s_waitcnt lgkmcnt(2)
    v_rcp_f32 v119, v119
    v_mfma_f32_16x16x32_bf16 v[72:75], v[48:51], a[192:195], v[72:75]
    buffer_load_dwordx4 v7, s[20:23], s58 offen lds
    v_mfma_f32_16x16x32_bf16 v[72:75], v[52:55], a[208:211], v[72:75]
    s_add_u32 m0, s61, 20480
    ds_read_b64_tr_b16 v[60:61], v4 offset:36864
    ds_read_b64_tr_b16 v[62:63], v4 offset:38912
    v_mfma_f32_16x16x32_bf16 v[76:79], v[48:51], a[196:199], v[76:79]
    s_waitcnt vmcnt(13) lgkmcnt(4)
    s_barrier
    v_rcp_f32 v120, v120
    v_mfma_f32_16x16x32_bf16 v[76:79], v[52:55], a[212:215], v[76:79]
    s_add_u32 s58, s48, 2654848
    v_rcp_f32 v121, v121
    v_mfma_f32_16x16x32_bf16 v[80:83], v[48:51], a[200:203], v[80:83]
    buffer_load_dwordx4 v7, s[20:23], s58 offen lds
    v_mfma_f32_16x16x32_bf16 v[80:83], v[52:55], a[216:219], v[80:83]
    s_add_u32 m0, s61, 24576
    ds_read_b64_tr_b16 v[64:65], v5 offset:28672
    ds_read_b64_tr_b16 v[66:67], v5 offset:30720
    v_mfma_f32_16x16x32_bf16 v[84:87], v[48:51], a[204:207], v[84:87]
    s_add_u32 s58, s48, 768
    v_rcp_f32 v122, v122
    v_mfma_f32_16x16x32_bf16 v[84:87], v[52:55], a[220:223], v[84:87]
    s_waitcnt lgkmcnt(2)
    v_rcp_f32 v123, v123
    v_mfma_f32_16x16x32_bf16 v[72:75], v[56:59], a[224:227], v[72:75]
    buffer_load_dwordx4 v6, s[20:23], s58 offen lds
    v_mfma_f32_16x16x32_bf16 v[72:75], v[60:63], a[240:243], v[72:75]
    s_add_u32 m0, s61, 28672
    ds_read_b64_tr_b16 v[68:69], v4 offset:40960
    ds_read_b64_tr_b16 v[70:71], v4 offset:43008
    v_mfma_f32_16x16x32_bf16 v[76:79], v[56:59], a[228:231], v[76:79]
    s_add_u32 s58, s48, 295680
    v_rcp_f32 v124, v124
    v_mfma_f32_16x16x32_bf16 v[76:79], v[60:63], a[244:247], v[76:79]
    v_rcp_f32 v125, v125
    v_mfma_f32_16x16x32_bf16 v[80:83], v[56:59], a[232:235], v[80:83]
    buffer_load_dwordx4 v6, s[20:23], s58 offen lds
    v_mfma_f32_16x16x32_bf16 v[80:83], v[60:63], a[248:251], v[80:83]
    s_add_u32 m0, s61, 81920
    ds_read_b64_tr_b16 v[48:49], v4 offset:45056
    ds_read_b64_tr_b16 v[50:51], v4 offset:47104
    v_mfma_f32_16x16x32_bf16 v[84:87], v[56:59], a[236:239], v[84:87]
    s_add_u32 s58, s48, 664320
    v_rcp_f32 v126, v126
    v_rcp_f32 v127, v127
    v_pk_mul_f32 v[112:113], v[88:89], v[112:113]
    v_pk_mul_f32 v[114:115], v[90:91], v[114:115]
    v_pk_mul_f32 v[116:117], v[92:93], v[116:117]
    v_pk_mul_f32 v[118:119], v[94:95], v[118:119]
    v_pk_mul_f32 v[120:121], v[96:97], v[120:121]
    v_pk_mul_f32 v[122:123], v[98:99], v[122:123]
    v_pk_mul_f32 v[124:125], v[100:101], v[124:125]
    v_pk_mul_f32 v[126:127], v[102:103], v[126:127]
    v_mfma_f32_16x16x32_bf16 v[84:87], v[60:63], a[252:255], v[84:87]
    s_waitcnt lgkmcnt(2)
    v_cvt_pk_bf16_f32 v182, v112, v113
    v_cvt_pk_bf16_f32 v183, v114, v115
    v_mfma_f32_16x16x32_bf16 v[72:75], v[64:67], v[16:19], v[72:75]
    buffer_load_dwordx4 v6, s[20:23], s58 offen lds
    v_mfma_f32_16x16x32_bf16 v[72:75], v[68:71], v[32:35], v[72:75]
    s_add_u32 m0, s61, 86016
    ds_read_b64_tr_b16 v[52:53], v4 offset:49152
    ds_read_b64_tr_b16 v[54:55], v4 offset:51200
    v_mfma_f32_16x16x32_bf16 v[76:79], v[64:67], v[20:23], v[76:79]
    s_add_u32 s58, s48, 959232
    v_cvt_pk_bf16_f32 v186, v116, v117
    v_cvt_pk_bf16_f32 v187, v118, v119
    v_mfma_f32_16x16x32_bf16 v[76:79], v[68:71], v[36:39], v[76:79]
    v_cvt_pk_bf16_f32 v190, v120, v121
    v_cvt_pk_bf16_f32 v191, v122, v123
    v_mfma_f32_16x16x32_bf16 v[80:83], v[64:67], v[24:27], v[80:83]
    buffer_load_dwordx4 v6, s[20:23], s58 offen lds
    v_mfma_f32_16x16x32_bf16 v[80:83], v[68:71], v[40:43], v[80:83]
    s_add_u32 m0, s61, 90112
    ds_read_b64_tr_b16 v[56:57], v5 offset:32768
    ds_read_b64_tr_b16 v[58:59], v5 offset:34816
    v_mfma_f32_16x16x32_bf16 v[84:87], v[64:67], v[28:31], v[84:87]
    s_add_u32 s58, s48, 1327872
    v_cvt_pk_bf16_f32 v194, v124, v125
    v_cvt_pk_bf16_f32 v195, v126, v127
    v_mfma_f32_16x16x32_bf16 v[84:87], v[68:71], v[44:47], v[84:87]
    s_waitcnt lgkmcnt(2)
    v_mfma_f32_16x16x32_bf16 v[88:91], v[48:51], a[0:3], v[148:151]
    buffer_load_dwordx4 v6, s[20:23], s58 offen lds
    v_mfma_f32_16x16x32_bf16 v[88:91], v[52:55], a[16:19], v[88:91]
    s_add_u32 m0, s61, 32768
    ds_read_b64_tr_b16 v[60:61], v5 offset:36864
    ds_read_b64_tr_b16 v[62:63], v5 offset:38912
    v_mfma_f32_16x16x32_bf16 v[92:95], v[48:51], a[4:7], v[148:151]
    s_waitcnt vmcnt(13) lgkmcnt(4)
    s_barrier
    v_pk_fma_f32 v[112:113], v[72:73], v[72:73], s[62:63]
    v_pk_fma_f32 v[114:115], v[74:75], v[74:75], s[62:63]
    v_pk_fma_f32 v[116:117], v[76:77], v[76:77], s[62:63]
    v_pk_fma_f32 v[118:119], v[78:79], v[78:79], s[62:63]
    v_pk_fma_f32 v[120:121], v[80:81], v[80:81], s[62:63]
    v_pk_fma_f32 v[122:123], v[82:83], v[82:83], s[62:63]
    v_pk_fma_f32 v[124:125], v[84:85], v[84:85], s[62:63]
    v_pk_fma_f32 v[126:127], v[86:87], v[86:87], s[62:63]
    v_pk_mul_f32 v[112:113], v[72:73], v[112:113]
    v_pk_mul_f32 v[114:115], v[74:75], v[114:115]
    v_pk_mul_f32 v[116:117], v[76:77], v[116:117]
    v_pk_mul_f32 v[118:119], v[78:79], v[118:119]
    v_pk_mul_f32 v[120:121], v[80:81], v[120:121]
    v_pk_mul_f32 v[122:123], v[82:83], v[122:123]
    v_pk_mul_f32 v[124:125], v[84:85], v[124:125]
    v_pk_mul_f32 v[126:127], v[86:87], v[126:127]
    v_mfma_f32_16x16x32_bf16 v[92:95], v[52:55], a[20:23], v[92:95]
    s_add_u32 s58, s48, 1622784
    v_exp_f32 v112, v112
    v_mfma_f32_16x16x32_bf16 v[96:99], v[48:51], a[8:11], v[148:151]
    buffer_load_dwordx4 v6, s[20:23], s58 offen lds
    v_mfma_f32_16x16x32_bf16 v[96:99], v[52:55], a[24:27], v[96:99]
    s_add_u32 m0, s61, 36864
    ds_read_b64_tr_b16 v[64:65], v5 offset:40960
    ds_read_b64_tr_b16 v[66:67], v5 offset:43008
    v_mfma_f32_16x16x32_bf16 v[100:103], v[48:51], a[12:15], v[148:151]
    s_add_u32 s58, s48, 1991424
    v_exp_f32 v113, v113
    v_mfma_f32_16x16x32_bf16 v[100:103], v[52:55], a[28:31], v[100:103]
    s_waitcnt lgkmcnt(2)
    v_exp_f32 v114, v114
    v_mfma_f32_16x16x32_bf16 v[88:91], v[56:59], a[32:35], v[88:91]
    buffer_load_dwordx4 v6, s[20:23], s58 offen lds
    v_mfma_f32_16x16x32_bf16 v[88:91], v[60:63], a[48:51], v[88:91]
    s_add_u32 m0, s61, 40960
    ds_read_b64_tr_b16 v[68:69], v4 offset:0
    ds_read_b64_tr_b16 v[70:71], v4 offset:2048
    v_mfma_f32_16x16x32_bf16 v[92:95], v[56:59], a[36:39], v[92:95]
    s_add_u32 s58, s48, 2286336
    v_exp_f32 v115, v115
    v_mfma_f32_16x16x32_bf16 v[92:95], v[60:63], a[52:55], v[92:95]
    v_exp_f32 v116, v116
    v_mfma_f32_16x16x32_bf16 v[96:99], v[56:59], a[40:43], v[96:99]
    buffer_load_dwordx4 v6, s[20:23], s58 offen lds
    v_mfma_f32_16x16x32_bf16 v[96:99], v[60:63], a[56:59], v[96:99]
    s_add_u32 m0, s61, 45056
    ds_read_b64_tr_b16 v[48:49], v4 offset:4096
    ds_read_b64_tr_b16 v[50:51], v4 offset:6144
    v_mfma_f32_16x16x32_bf16 v[100:103], v[56:59], a[44:47], v[100:103]
    s_add_u32 s58, s48, 2654976
    v_exp_f32 v117, v117
    v_mfma_f32_16x16x32_bf16 v[100:103], v[60:63], a[60:63], v[100:103]
    s_waitcnt lgkmcnt(2)
    v_exp_f32 v118, v118
    v_mfma_f32_16x16x32_bf16 v[88:91], v[64:67], a[64:67], v[88:91]
    buffer_load_dwordx4 v6, s[20:23], s58 offen lds
    v_mfma_f32_16x16x32_bf16 v[88:91], v[68:71], a[80:83], v[88:91]
    s_add_u32 m0, s61, 49152
    ds_read_b64_tr_b16 v[52:53], v4 offset:53248
    ds_read_b64_tr_b16 v[54:55], v4 offset:55296
    v_mfma_f32_16x16x32_bf16 v[92:95], v[64:67], a[68:71], v[92:95]
    s_add_u32 s58, s48, 2949888
    v_exp_f32 v119, v119
    v_mfma_f32_16x16x32_bf16 v[92:95], v[68:71], a[84:87], v[92:95]
    v_exp_f32 v120, v120
    v_mfma_f32_16x16x32_bf16 v[96:99], v[64:67], a[72:75], v[96:99]
    buffer_load_dwordx4 v6, s[20:23], s58 offen lds
    v_mfma_f32_16x16x32_bf16 v[96:99], v[68:71], a[88:91], v[96:99]
    s_add_u32 m0, s61, 94208
    ds_read_b64_tr_b16 v[56:57], v4 offset:57344
    ds_read_b64_tr_b16 v[58:59], v4 offset:59392
    v_mfma_f32_16x16x32_bf16 v[100:103], v[64:67], a[76:79], v[100:103]
    s_add_u32 s58, s48, 3318528
    v_exp_f32 v121, v121
    v_mfma_f32_16x16x32_bf16 v[100:103], v[68:71], a[92:95], v[100:103]
    s_waitcnt lgkmcnt(2)
    v_exp_f32 v122, v122
    v_mfma_f32_16x16x32_bf16 v[88:91], v[48:51], a[96:99], v[88:91]
    buffer_load_dwordx4 v6, s[20:23], s58 offen lds
    v_mfma_f32_16x16x32_bf16 v[88:91], v[52:55], a[112:115], v[88:91]
    s_add_u32 m0, s61, 0
    ds_read_b64_tr_b16 v[60:61], v4 offset:61440
    ds_read_b64_tr_b16 v[62:63], v4 offset:63488
    v_mfma_f32_16x16x32_bf16 v[92:95], v[48:51], a[100:103], v[92:95]
    s_waitcnt vmcnt(13) lgkmcnt(4)
    s_barrier
    v_exp_f32 v123, v123
    v_mfma_f32_16x16x32_bf16 v[92:95], v[52:55], a[116:119], v[92:95]
    s_add_u32 s58, s48, 3613440
    v_exp_f32 v124, v124
    v_mfma_f32_16x16x32_bf16 v[96:99], v[48:51], a[104:107], v[96:99]
    buffer_load_dwordx4 v6, s[20:23], s58 offen lds
    v_mfma_f32_16x16x32_bf16 v[96:99], v[52:55], a[120:123], v[96:99]
    s_add_u32 m0, s61, 4096
    ds_read_b64_tr_b16 v[64:65], v5 offset:0
    ds_read_b64_tr_b16 v[66:67], v5 offset:2048
    v_mfma_f32_16x16x32_bf16 v[100:103], v[48:51], a[108:111], v[100:103]
    s_add_u32 s58, s48, 3982080
    v_exp_f32 v125, v125
    v_mfma_f32_16x16x32_bf16 v[100:103], v[52:55], a[124:127], v[100:103]
    s_waitcnt lgkmcnt(2)
    v_exp_f32 v126, v126
    v_exp_f32 v127, v127
    v_pk_add_f32 v[112:113], v[112:113], 1.0 op_sel_hi:[1,0]
    v_pk_add_f32 v[114:115], v[114:115], 1.0 op_sel_hi:[1,0]
    v_pk_add_f32 v[116:117], v[116:117], 1.0 op_sel_hi:[1,0]
    v_pk_add_f32 v[118:119], v[118:119], 1.0 op_sel_hi:[1,0]
    v_pk_add_f32 v[120:121], v[120:121], 1.0 op_sel_hi:[1,0]
    v_pk_add_f32 v[122:123], v[122:123], 1.0 op_sel_hi:[1,0]
    v_pk_add_f32 v[124:125], v[124:125], 1.0 op_sel_hi:[1,0]
    v_pk_add_f32 v[126:127], v[126:127], 1.0 op_sel_hi:[1,0]
    v_mfma_f32_16x16x32_bf16 v[88:91], v[56:59], a[128:131], v[88:91]
    buffer_load_dwordx4 v6, s[20:23], s58 offen lds
    v_mfma_f32_16x16x32_bf16 v[88:91], v[60:63], a[144:147], v[88:91]
    s_add_u32 m0, s61, 53248
    ds_read_b64_tr_b16 v[68:69], v4 offset:8192
    ds_read_b64_tr_b16 v[70:71], v4 offset:10240
    v_mfma_f32_16x16x32_bf16 v[92:95], v[56:59], a[132:135], v[92:95]
    s_add_u32 s58, s48, 4276992
    v_rcp_f32 v112, v112
    v_mfma_f32_16x16x32_bf16 v[92:95], v[60:63], a[148:151], v[92:95]
    v_rcp_f32 v113, v113
    v_mfma_f32_16x16x32_bf16 v[96:99], v[56:59], a[136:139], v[96:99]
    buffer_load_dwordx4 v6, s[20:23], s58 offen lds
    v_mfma_f32_16x16x32_bf16 v[96:99], v[60:63], a[152:155], v[96:99]
    s_add_u32 m0, s61, 98304
    ds_read_b64_tr_b16 v[48:49], v4 offset:12288
    ds_read_b64_tr_b16 v[50:51], v4 offset:14336
    v_mfma_f32_16x16x32_bf16 v[100:103], v[56:59], a[140:143], v[100:103]
    s_add_u32 s58, s48, 4645632
    v_rcp_f32 v114, v114
    v_mfma_f32_16x16x32_bf16 v[100:103], v[60:63], a[156:159], v[100:103]
    s_waitcnt lgkmcnt(2)
    v_rcp_f32 v115, v115
    v_mfma_f32_16x16x32_bf16 v[88:91], v[64:67], a[160:163], v[88:91]
    buffer_load_dwordx4 v6, s[20:23], s58 offen lds
    v_mfma_f32_16x16x32_bf16 v[88:91], v[68:71], a[176:179], v[88:91]
    s_add_u32 m0, s61, 102400
    ds_read_b64_tr_b16 v[52:53], v4 offset:16384
    ds_read_b64_tr_b16 v[54:55], v4 offset:18432
    v_mfma_f32_16x16x32_bf16 v[92:95], v[64:67], a[164:167], v[92:95]
    s_add_u32 s58, s48, 4940544
    v_rcp_f32 v116, v116
    v_mfma_f32_16x16x32_bf16 v[92:95], v[68:71], a[180:183], v[92:95]
    v_rcp_f32 v117, v117
    v_mfma_f32_16x16x32_bf16 v[96:99], v[64:67], a[168:171], v[96:99]
    buffer_load_dwordx4 v6, s[20:23], s58 offen lds
    v_mfma_f32_16x16x32_bf16 v[96:99], v[68:71], a[184:187], v[96:99]
    s_add_u32 m0, s61, 106496
    ds_read_b64_tr_b16 v[56:57], v5 offset:4096
    ds_read_b64_tr_b16 v[58:59], v5 offset:6144
    v_mfma_f32_16x16x32_bf16 v[100:103], v[64:67], a[172:175], v[100:103]
    s_add_u32 s58, s48, 768
    v_rcp_f32 v118, v118
    v_mfma_f32_16x16x32_bf16 v[100:103], v[68:71], a[188:191], v[100:103]
    s_waitcnt lgkmcnt(2)
    v_rcp_f32 v119, v119
    v_mfma_f32_16x16x32_bf16 v[88:91], v[48:51], a[192:195], v[88:91]
    buffer_load_dwordx4 v7, s[20:23], s58 offen lds
    v_mfma_f32_16x16x32_bf16 v[88:91], v[52:55], a[208:211], v[88:91]
    s_add_u32 m0, s61, 8192
    ds_read_b64_tr_b16 v[60:61], v5 offset:8192
    ds_read_b64_tr_b16 v[62:63], v5 offset:10240
    v_mfma_f32_16x16x32_bf16 v[92:95], v[48:51], a[196:199], v[92:95]
    s_waitcnt vmcnt(13) lgkmcnt(4)
    s_barrier
    v_rcp_f32 v120, v120
    v_mfma_f32_16x16x32_bf16 v[92:95], v[52:55], a[212:215], v[92:95]
    s_add_u32 s58, s48, 2654976
    v_rcp_f32 v121, v121
    v_mfma_f32_16x16x32_bf16 v[96:99], v[48:51], a[200:203], v[96:99]
    buffer_load_dwordx4 v7, s[20:23], s58 offen lds
    v_mfma_f32_16x16x32_bf16 v[96:99], v[52:55], a[216:219], v[96:99]
    s_add_u32 m0, s61, 12288
    ds_read_b64_tr_b16 v[64:65], v5 offset:12288
    ds_read_b64_tr_b16 v[66:67], v5 offset:14336
    v_mfma_f32_16x16x32_bf16 v[100:103], v[48:51], a[204:207], v[100:103]
    s_add_u32 s58, s48, 896
    v_rcp_f32 v122, v122
    v_mfma_f32_16x16x32_bf16 v[100:103], v[52:55], a[220:223], v[100:103]
    s_waitcnt lgkmcnt(2)
    v_rcp_f32 v123, v123
    v_mfma_f32_16x16x32_bf16 v[88:91], v[56:59], a[224:227], v[88:91]
    buffer_load_dwordx4 v6, s[20:23], s58 offen lds
    v_mfma_f32_16x16x32_bf16 v[88:91], v[60:63], a[240:243], v[88:91]
    s_add_u32 m0, s61, 16384
    ds_read_b64_tr_b16 v[68:69], v4 offset:20480
    ds_read_b64_tr_b16 v[70:71], v4 offset:22528
    v_mfma_f32_16x16x32_bf16 v[92:95], v[56:59], a[228:231], v[92:95]
    s_add_u32 s58, s48, 295808
    v_rcp_f32 v124, v124
    v_mfma_f32_16x16x32_bf16 v[92:95], v[60:63], a[244:247], v[92:95]
    v_rcp_f32 v125, v125
    v_mfma_f32_16x16x32_bf16 v[96:99], v[56:59], a[232:235], v[96:99]
    buffer_load_dwordx4 v6, s[20:23], s58 offen lds
    v_mfma_f32_16x16x32_bf16 v[96:99], v[60:63], a[248:251], v[96:99]
    s_add_u32 m0, s61, 57344
    ds_read_b64_tr_b16 v[48:49], v4 offset:24576
    ds_read_b64_tr_b16 v[50:51], v4 offset:26624
    v_mfma_f32_16x16x32_bf16 v[100:103], v[56:59], a[236:239], v[100:103]
    s_add_u32 s58, s48, 664448
    v_rcp_f32 v126, v126
    v_rcp_f32 v127, v127
    v_pk_mul_f32 v[112:113], v[72:73], v[112:113]
    v_pk_mul_f32 v[114:115], v[74:75], v[114:115]
    v_pk_mul_f32 v[116:117], v[76:77], v[116:117]
    v_pk_mul_f32 v[118:119], v[78:79], v[118:119]
    v_pk_mul_f32 v[120:121], v[80:81], v[120:121]
    v_pk_mul_f32 v[122:123], v[82:83], v[122:123]
    v_pk_mul_f32 v[124:125], v[84:85], v[124:125]
    v_pk_mul_f32 v[126:127], v[86:87], v[126:127]
    v_mfma_f32_16x16x32_bf16 v[100:103], v[60:63], a[252:255], v[100:103]
    s_waitcnt lgkmcnt(2)
    v_cvt_pk_bf16_f32 v196, v112, v113
    v_cvt_pk_bf16_f32 v197, v114, v115
    v_mfma_f32_16x16x32_bf16 v[88:91], v[64:67], v[16:19], v[88:91]
    buffer_load_dwordx4 v6, s[20:23], s58 offen lds
    v_mfma_f32_16x16x32_bf16 v[88:91], v[68:71], v[32:35], v[88:91]
    s_add_u32 m0, s61, 61440
    ds_read_b64_tr_b16 v[52:53], v4 offset:28672
    ds_read_b64_tr_b16 v[54:55], v4 offset:30720
    v_mfma_f32_16x16x32_bf16 v[92:95], v[64:67], v[20:23], v[92:95]
    s_add_u32 s58, s48, 959360
    v_cvt_pk_bf16_f32 v200, v116, v117
    v_cvt_pk_bf16_f32 v201, v118, v119
    v_mfma_f32_16x16x32_bf16 v[92:95], v[68:71], v[36:39], v[92:95]
    v_cvt_pk_bf16_f32 v204, v120, v121
    v_cvt_pk_bf16_f32 v205, v122, v123
    v_mfma_f32_16x16x32_bf16 v[96:99], v[64:67], v[24:27], v[96:99]
    buffer_load_dwordx4 v6, s[20:23], s58 offen lds
    v_mfma_f32_16x16x32_bf16 v[96:99], v[68:71], v[40:43], v[96:99]
    s_add_u32 m0, s61, 65536
    ds_read_b64_tr_b16 v[56:57], v5 offset:16384
    ds_read_b64_tr_b16 v[58:59], v5 offset:18432
    v_mfma_f32_16x16x32_bf16 v[100:103], v[64:67], v[28:31], v[100:103]
    s_add_u32 s58, s48, 1328000
    v_cvt_pk_bf16_f32 v208, v124, v125
    v_cvt_pk_bf16_f32 v209, v126, v127
    v_mfma_f32_16x16x32_bf16 v[100:103], v[68:71], v[44:47], v[100:103]
    s_waitcnt lgkmcnt(2)
    v_mfma_f32_16x16x32_bf16 v[72:75], v[48:51], a[0:3], v[152:155]
    buffer_load_dwordx4 v6, s[20:23], s58 offen lds
    v_mfma_f32_16x16x32_bf16 v[72:75], v[52:55], a[16:19], v[72:75]
    s_add_u32 m0, s61, 20480
    ds_read_b64_tr_b16 v[60:61], v5 offset:20480
    ds_read_b64_tr_b16 v[62:63], v5 offset:22528
    v_mfma_f32_16x16x32_bf16 v[76:79], v[48:51], a[4:7], v[152:155]
    s_waitcnt vmcnt(13) lgkmcnt(4)
    s_barrier
    v_pk_fma_f32 v[112:113], v[88:89], v[88:89], s[62:63]
    v_pk_fma_f32 v[114:115], v[90:91], v[90:91], s[62:63]
    v_pk_fma_f32 v[116:117], v[92:93], v[92:93], s[62:63]
    v_pk_fma_f32 v[118:119], v[94:95], v[94:95], s[62:63]
    v_pk_fma_f32 v[120:121], v[96:97], v[96:97], s[62:63]
    v_pk_fma_f32 v[122:123], v[98:99], v[98:99], s[62:63]
    v_pk_fma_f32 v[124:125], v[100:101], v[100:101], s[62:63]
    v_pk_fma_f32 v[126:127], v[102:103], v[102:103], s[62:63]
    v_pk_mul_f32 v[112:113], v[88:89], v[112:113]
    v_pk_mul_f32 v[114:115], v[90:91], v[114:115]
    v_pk_mul_f32 v[116:117], v[92:93], v[116:117]
    v_pk_mul_f32 v[118:119], v[94:95], v[118:119]
    v_pk_mul_f32 v[120:121], v[96:97], v[120:121]
    v_pk_mul_f32 v[122:123], v[98:99], v[122:123]
    v_pk_mul_f32 v[124:125], v[100:101], v[124:125]
    v_pk_mul_f32 v[126:127], v[102:103], v[126:127]
    v_mfma_f32_16x16x32_bf16 v[76:79], v[52:55], a[20:23], v[76:79]
    s_add_u32 s58, s48, 1622912
    v_exp_f32 v112, v112
    v_mfma_f32_16x16x32_bf16 v[80:83], v[48:51], a[8:11], v[152:155]
    buffer_load_dwordx4 v6, s[20:23], s58 offen lds
    v_mfma_f32_16x16x32_bf16 v[80:83], v[52:55], a[24:27], v[80:83]
    s_add_u32 m0, s61, 24576
    ds_read_b64_tr_b16 v[64:65], v5 offset:24576
    ds_read_b64_tr_b16 v[66:67], v5 offset:26624
    v_mfma_f32_16x16x32_bf16 v[84:87], v[48:51], a[12:15], v[152:155]
    s_add_u32 s58, s48, 1991552
    v_exp_f32 v113, v113
    v_mfma_f32_16x16x32_bf16 v[84:87], v[52:55], a[28:31], v[84:87]
    s_waitcnt lgkmcnt(2)
    v_exp_f32 v114, v114
    v_mfma_f32_16x16x32_bf16 v[72:75], v[56:59], a[32:35], v[72:75]
    buffer_load_dwordx4 v6, s[20:23], s58 offen lds
    v_mfma_f32_16x16x32_bf16 v[72:75], v[60:63], a[48:51], v[72:75]
    s_add_u32 m0, s61, 28672
    ds_read_b64_tr_b16 v[68:69], v4 offset:32768
    ds_read_b64_tr_b16 v[70:71], v4 offset:34816
    v_mfma_f32_16x16x32_bf16 v[76:79], v[56:59], a[36:39], v[76:79]
    s_add_u32 s58, s48, 2286464
    v_exp_f32 v115, v115
    v_mfma_f32_16x16x32_bf16 v[76:79], v[60:63], a[52:55], v[76:79]
    v_exp_f32 v116, v116
    v_mfma_f32_16x16x32_bf16 v[80:83], v[56:59], a[40:43], v[80:83]
    buffer_load_dwordx4 v6, s[20:23], s58 offen lds
    v_mfma_f32_16x16x32_bf16 v[80:83], v[60:63], a[56:59], v[80:83]
    s_add_u32 m0, s61, 69632
    ds_read_b64_tr_b16 v[48:49], v4 offset:36864
    ds_read_b64_tr_b16 v[50:51], v4 offset:38912
    v_mfma_f32_16x16x32_bf16 v[84:87], v[56:59], a[44:47], v[84:87]
    s_add_u32 s58, s48, 2655104
    v_exp_f32 v117, v117
    v_mfma_f32_16x16x32_bf16 v[84:87], v[60:63], a[60:63], v[84:87]
    s_waitcnt lgkmcnt(2)
    v_exp_f32 v118, v118
    v_mfma_f32_16x16x32_bf16 v[72:75], v[64:67], a[64:67], v[72:75]
    buffer_load_dwordx4 v6, s[20:23], s58 offen lds
    v_mfma_f32_16x16x32_bf16 v[72:75], v[68:71], a[80:83], v[72:75]
    s_add_u32 m0, s61, 73728
    ds_read_b64_tr_b16 v[52:53], v4 offset:40960
    ds_read_b64_tr_b16 v[54:55], v4 offset:43008
    v_mfma_f32_16x16x32_bf16 v[76:79], v[64:67], a[68:71], v[76:79]
    s_add_u32 s58, s48, 2950016
    v_exp_f32 v119, v119
    v_mfma_f32_16x16x32_bf16 v[76:79], v[68:71], a[84:87], v[76:79]
    v_exp_f32 v120, v120
    v_mfma_f32_16x16x32_bf16 v[80:83], v[64:67], a[72:75], v[80:83]
    buffer_load_dwordx4 v6, s[20:23], s58 offen lds
    v_mfma_f32_16x16x32_bf16 v[80:83], v[68:71], a[88:91], v[80:83]
    s_add_u32 m0, s61, 77824
    ds_read_b64_tr_b16 v[56:57], v4 offset:45056
    ds_read_b64_tr_b16 v[58:59], v4 offset:47104
    v_mfma_f32_16x16x32_bf16 v[84:87], v[64:67], a[76:79], v[84:87]
    s_add_u32 s58, s48, 3318656
    v_exp_f32 v121, v121
    v_mfma_f32_16x16x32_bf16 v[84:87], v[68:71], a[92:95], v[84:87]
    s_waitcnt lgkmcnt(2)
    v_exp_f32 v122, v122
    v_mfma_f32_16x16x32_bf16 v[72:75], v[48:51], a[96:99], v[72:75]
    buffer_load_dwordx4 v6, s[20:23], s58 offen lds
    v_mfma_f32_16x16x32_bf16 v[72:75], v[52:55], a[112:115], v[72:75]
    s_add_u32 m0, s61, 32768
    ds_read_b64_tr_b16 v[60:61], v4 offset:49152
    ds_read_b64_tr_b16 v[62:63], v4 offset:51200
    v_mfma_f32_16x16x32_bf16 v[76:79], v[48:51], a[100:103], v[76:79]
    s_waitcnt vmcnt(13) lgkmcnt(4)
    s_barrier
    v_exp_f32 v123, v123
    v_mfma_f32_16x16x32_bf16 v[76:79], v[52:55], a[116:119], v[76:79]
    s_add_u32 s58, s48, 3613568
    v_exp_f32 v124, v124
    v_mfma_f32_16x16x32_bf16 v[80:83], v[48:51], a[104:107], v[80:83]
    buffer_load_dwordx4 v6, s[20:23], s58 offen lds
    v_mfma_f32_16x16x32_bf16 v[80:83], v[52:55], a[120:123], v[80:83]
    s_add_u32 m0, s61, 36864
    ds_read_b64_tr_b16 v[64:65], v5 offset:28672
    ds_read_b64_tr_b16 v[66:67], v5 offset:30720
    v_mfma_f32_16x16x32_bf16 v[84:87], v[48:51], a[108:111], v[84:87]
    s_add_u32 s58, s48, 3982208
    v_exp_f32 v125, v125
    v_mfma_f32_16x16x32_bf16 v[84:87], v[52:55], a[124:127], v[84:87]
    s_waitcnt lgkmcnt(2)
    v_exp_f32 v126, v126
    v_exp_f32 v127, v127
    v_pk_add_f32 v[112:113], v[112:113], 1.0 op_sel_hi:[1,0]
    v_pk_add_f32 v[114:115], v[114:115], 1.0 op_sel_hi:[1,0]
    v_pk_add_f32 v[116:117], v[116:117], 1.0 op_sel_hi:[1,0]
    v_pk_add_f32 v[118:119], v[118:119], 1.0 op_sel_hi:[1,0]
    v_pk_add_f32 v[120:121], v[120:121], 1.0 op_sel_hi:[1,0]
    v_pk_add_f32 v[122:123], v[122:123], 1.0 op_sel_hi:[1,0]
    v_pk_add_f32 v[124:125], v[124:125], 1.0 op_sel_hi:[1,0]
    v_pk_add_f32 v[126:127], v[126:127], 1.0 op_sel_hi:[1,0]
    v_mfma_f32_16x16x32_bf16 v[72:75], v[56:59], a[128:131], v[72:75]
    buffer_load_dwordx4 v6, s[20:23], s58 offen lds
    v_mfma_f32_16x16x32_bf16 v[72:75], v[60:63], a[144:147], v[72:75]
    s_add_u32 m0, s61, 40960
    ds_read_b64_tr_b16 v[68:69], v4 offset:0
    ds_read_b64_tr_b16 v[70:71], v4 offset:2048
    v_mfma_f32_16x16x32_bf16 v[76:79], v[56:59], a[132:135], v[76:79]
    s_add_u32 s58, s48, 4277120
    v_rcp_f32 v112, v112
    v_mfma_f32_16x16x32_bf16 v[76:79], v[60:63], a[148:151], v[76:79]
    v_rcp_f32 v113, v113
    v_mfma_f32_16x16x32_bf16 v[80:83], v[56:59], a[136:139], v[80:83]
    buffer_load_dwordx4 v6, s[20:23], s58 offen lds
    v_mfma_f32_16x16x32_bf16 v[80:83], v[60:63], a[152:155], v[80:83]
    s_add_u32 m0, s61, 81920
    ds_read_b64_tr_b16 v[48:49], v4 offset:4096
    ds_read_b64_tr_b16 v[50:51], v4 offset:6144
    v_mfma_f32_16x16x32_bf16 v[84:87], v[56:59], a[140:143], v[84:87]
    s_add_u32 s58, s48, 4645760
    v_rcp_f32 v114, v114
    v_mfma_f32_16x16x32_bf16 v[84:87], v[60:63], a[156:159], v[84:87]
    s_waitcnt lgkmcnt(2)
    v_rcp_f32 v115, v115
    v_mfma_f32_16x16x32_bf16 v[72:75], v[64:67], a[160:163], v[72:75]
    buffer_load_dwordx4 v6, s[20:23], s58 offen lds
    v_mfma_f32_16x16x32_bf16 v[72:75], v[68:71], a[176:179], v[72:75]
    s_add_u32 m0, s61, 86016
    ds_read_b64_tr_b16 v[52:53], v4 offset:53248
    ds_read_b64_tr_b16 v[54:55], v4 offset:55296
    v_mfma_f32_16x16x32_bf16 v[76:79], v[64:67], a[164:167], v[76:79]
    s_add_u32 s58, s48, 4940672
    v_rcp_f32 v116, v116
    v_mfma_f32_16x16x32_bf16 v[76:79], v[68:71], a[180:183], v[76:79]
    v_rcp_f32 v117, v117
    v_mfma_f32_16x16x32_bf16 v[80:83], v[64:67], a[168:171], v[80:83]
    buffer_load_dwordx4 v6, s[20:23], s58 offen lds
    v_mfma_f32_16x16x32_bf16 v[80:83], v[68:71], a[184:187], v[80:83]
    s_add_u32 m0, s61, 90112
    ds_read_b64_tr_b16 v[56:57], v5 offset:32768
    ds_read_b64_tr_b16 v[58:59], v5 offset:34816
    v_mfma_f32_16x16x32_bf16 v[84:87], v[64:67], a[172:175], v[84:87]
    s_add_u32 s58, s48, 896
    v_rcp_f32 v118, v118
    v_mfma_f32_16x16x32_bf16 v[84:87], v[68:71], a[188:191], v[84:87]
    s_waitcnt lgkmcnt(2)
    v_rcp_f32 v119, v119
    v_mfma_f32_16x16x32_bf16 v[72:75], v[48:51], a[192:195], v[72:75]
    buffer_load_dwordx4 v7, s[20:23], s58 offen lds
    v_mfma_f32_16x16x32_bf16 v[72:75], v[52:55], a[208:211], v[72:75]
    s_add_u32 m0, s61, 0
    ds_read_b64_tr_b16 v[60:61], v5 offset:36864
    ds_read_b64_tr_b16 v[62:63], v5 offset:38912
    v_mfma_f32_16x16x32_bf16 v[76:79], v[48:51], a[196:199], v[76:79]
    s_waitcnt vmcnt(13) lgkmcnt(4)
    s_barrier
    v_rcp_f32 v120, v120
    v_mfma_f32_16x16x32_bf16 v[76:79], v[52:55], a[212:215], v[76:79]
    s_add_u32 s58, s48, 2655104
    v_rcp_f32 v121, v121
    v_mfma_f32_16x16x32_bf16 v[80:83], v[48:51], a[200:203], v[80:83]
    buffer_load_dwordx4 v7, s[20:23], s58 offen lds
    v_mfma_f32_16x16x32_bf16 v[80:83], v[52:55], a[216:219], v[80:83]
    s_add_u32 m0, s61, 4096
    ds_read_b64_tr_b16 v[64:65], v5 offset:40960
    ds_read_b64_tr_b16 v[66:67], v5 offset:43008
    v_mfma_f32_16x16x32_bf16 v[84:87], v[48:51], a[204:207], v[84:87]
    s_add_u32 s58, s48, 1024
    v_rcp_f32 v122, v122
    v_mfma_f32_16x16x32_bf16 v[84:87], v[52:55], a[220:223], v[84:87]
    s_waitcnt lgkmcnt(2)
    v_rcp_f32 v123, v123
    v_mfma_f32_16x16x32_bf16 v[72:75], v[56:59], a[224:227], v[72:75]
    buffer_load_dwordx4 v6, s[20:23], s58 offen lds
    v_mfma_f32_16x16x32_bf16 v[72:75], v[60:63], a[240:243], v[72:75]
    s_add_u32 m0, s61, 45056
    ds_read_b64_tr_b16 v[68:69], v4 offset:8192
    ds_read_b64_tr_b16 v[70:71], v4 offset:10240
    v_mfma_f32_16x16x32_bf16 v[76:79], v[56:59], a[228:231], v[76:79]
    s_add_u32 s58, s48, 295936
    v_rcp_f32 v124, v124
    v_mfma_f32_16x16x32_bf16 v[76:79], v[60:63], a[244:247], v[76:79]
    v_rcp_f32 v125, v125
    v_mfma_f32_16x16x32_bf16 v[80:83], v[56:59], a[232:235], v[80:83]
    buffer_load_dwordx4 v6, s[20:23], s58 offen lds
    v_mfma_f32_16x16x32_bf16 v[80:83], v[60:63], a[248:251], v[80:83]
    s_add_u32 m0, s61, 49152
    ds_read_b64_tr_b16 v[48:49], v4 offset:12288
    ds_read_b64_tr_b16 v[50:51], v4 offset:14336
    v_mfma_f32_16x16x32_bf16 v[84:87], v[56:59], a[236:239], v[84:87]
    s_add_u32 s58, s48, 664576
    v_rcp_f32 v126, v126
    v_rcp_f32 v127, v127
    v_pk_mul_f32 v[112:113], v[88:89], v[112:113]
    v_pk_mul_f32 v[114:115], v[90:91], v[114:115]
    v_pk_mul_f32 v[116:117], v[92:93], v[116:117]
    v_pk_mul_f32 v[118:119], v[94:95], v[118:119]
    v_pk_mul_f32 v[120:121], v[96:97], v[120:121]
    v_pk_mul_f32 v[122:123], v[98:99], v[122:123]
    v_pk_mul_f32 v[124:125], v[100:101], v[124:125]
    v_pk_mul_f32 v[126:127], v[102:103], v[126:127]
    v_mfma_f32_16x16x32_bf16 v[84:87], v[60:63], a[252:255], v[84:87]
    s_waitcnt lgkmcnt(2)
    v_cvt_pk_bf16_f32 v198, v112, v113
    v_cvt_pk_bf16_f32 v199, v114, v115
    v_mfma_f32_16x16x32_bf16 v[72:75], v[64:67], v[16:19], v[72:75]
    buffer_load_dwordx4 v6, s[20:23], s58 offen lds
    v_mfma_f32_16x16x32_bf16 v[72:75], v[68:71], v[32:35], v[72:75]
    s_add_u32 m0, s61, 53248
    ds_read_b64_tr_b16 v[52:53], v4 offset:16384
    ds_read_b64_tr_b16 v[54:55], v4 offset:18432
    v_mfma_f32_16x16x32_bf16 v[76:79], v[64:67], v[20:23], v[76:79]
    s_add_u32 s58, s48, 959488
    v_cvt_pk_bf16_f32 v202, v116, v117
    v_cvt_pk_bf16_f32 v203, v118, v119
    v_mfma_f32_16x16x32_bf16 v[76:79], v[68:71], v[36:39], v[76:79]
    v_cvt_pk_bf16_f32 v206, v120, v121
    v_cvt_pk_bf16_f32 v207, v122, v123
    v_mfma_f32_16x16x32_bf16 v[80:83], v[64:67], v[24:27], v[80:83]
    buffer_load_dwordx4 v6, s[20:23], s58 offen lds
    v_mfma_f32_16x16x32_bf16 v[80:83], v[68:71], v[40:43], v[80:83]
    s_add_u32 m0, s61, 94208
    ds_read_b64_tr_b16 v[56:57], v4 offset:57344
    ds_read_b64_tr_b16 v[58:59], v4 offset:59392
    v_mfma_f32_16x16x32_bf16 v[84:87], v[64:67], v[28:31], v[84:87]
    s_add_u32 s58, s48, 1328128
    v_cvt_pk_bf16_f32 v210, v124, v125
    v_cvt_pk_bf16_f32 v211, v126, v127
    v_mfma_f32_16x16x32_bf16 v[84:87], v[68:71], v[44:47], v[84:87]
    s_waitcnt lgkmcnt(2)
    v_mfma_f32_16x16x32_bf16 v[88:91], v[48:51], a[0:3], v[156:159]
    buffer_load_dwordx4 v6, s[20:23], s58 offen lds
    v_mfma_f32_16x16x32_bf16 v[88:91], v[52:55], a[16:19], v[88:91]
    s_add_u32 m0, s61, 8192
    ds_read_b64_tr_b16 v[60:61], v4 offset:61440
    ds_read_b64_tr_b16 v[62:63], v4 offset:63488
    v_mfma_f32_16x16x32_bf16 v[92:95], v[48:51], a[4:7], v[156:159]
    s_waitcnt vmcnt(13) lgkmcnt(4)
    s_barrier
    v_pk_fma_f32 v[112:113], v[72:73], v[72:73], s[62:63]
    v_pk_fma_f32 v[114:115], v[74:75], v[74:75], s[62:63]
    v_pk_fma_f32 v[116:117], v[76:77], v[76:77], s[62:63]
    v_pk_fma_f32 v[118:119], v[78:79], v[78:79], s[62:63]
    v_pk_fma_f32 v[120:121], v[80:81], v[80:81], s[62:63]
    v_pk_fma_f32 v[122:123], v[82:83], v[82:83], s[62:63]
    v_pk_fma_f32 v[124:125], v[84:85], v[84:85], s[62:63]
    v_pk_fma_f32 v[126:127], v[86:87], v[86:87], s[62:63]
    v_pk_mul_f32 v[112:113], v[72:73], v[112:113]
    v_pk_mul_f32 v[114:115], v[74:75], v[114:115]
    v_pk_mul_f32 v[116:117], v[76:77], v[116:117]
    v_pk_mul_f32 v[118:119], v[78:79], v[118:119]
    v_pk_mul_f32 v[120:121], v[80:81], v[120:121]
    v_pk_mul_f32 v[122:123], v[82:83], v[122:123]
    v_pk_mul_f32 v[124:125], v[84:85], v[124:125]
    v_pk_mul_f32 v[126:127], v[86:87], v[126:127]
    v_mfma_f32_16x16x32_bf16 v[92:95], v[52:55], a[20:23], v[92:95]
    s_add_u32 s58, s48, 1623040
    v_exp_f32 v112, v112
    v_mfma_f32_16x16x32_bf16 v[96:99], v[48:51], a[8:11], v[156:159]
    buffer_load_dwordx4 v6, s[20:23], s58 offen lds
    v_mfma_f32_16x16x32_bf16 v[96:99], v[52:55], a[24:27], v[96:99]
    s_add_u32 m0, s61, 12288
    ds_read_b64_tr_b16 v[64:65], v5 offset:0
    ds_read_b64_tr_b16 v[66:67], v5 offset:2048
    v_mfma_f32_16x16x32_bf16 v[100:103], v[48:51], a[12:15], v[156:159]
    s_add_u32 s58, s48, 1991680
    v_exp_f32 v113, v113
    v_mfma_f32_16x16x32_bf16 v[100:103], v[52:55], a[28:31], v[100:103]
    s_waitcnt lgkmcnt(2)
    v_exp_f32 v114, v114
    v_mfma_f32_16x16x32_bf16 v[88:91], v[56:59], a[32:35], v[88:91]
    buffer_load_dwordx4 v6, s[20:23], s58 offen lds
    v_mfma_f32_16x16x32_bf16 v[88:91], v[60:63], a[48:51], v[88:91]
    s_add_u32 m0, s61, 16384
    ds_read_b64_tr_b16 v[68:69], v4 offset:20480
    ds_read_b64_tr_b16 v[70:71], v4 offset:22528
    v_mfma_f32_16x16x32_bf16 v[92:95], v[56:59], a[36:39], v[92:95]
    s_add_u32 s58, s48, 2286592
    v_exp_f32 v115, v115
    v_mfma_f32_16x16x32_bf16 v[92:95], v[60:63], a[52:55], v[92:95]
    v_exp_f32 v116, v116
    v_mfma_f32_16x16x32_bf16 v[96:99], v[56:59], a[40:43], v[96:99]
    buffer_load_dwordx4 v6, s[20:23], s58 offen lds
    v_mfma_f32_16x16x32_bf16 v[96:99], v[60:63], a[56:59], v[96:99]
    s_add_u32 m0, s61, 98304
    ds_read_b64_tr_b16 v[48:49], v4 offset:24576
    ds_read_b64_tr_b16 v[50:51], v4 offset:26624
    v_mfma_f32_16x16x32_bf16 v[100:103], v[56:59], a[44:47], v[100:103]
    s_add_u32 s58, s48, 2655232
    v_exp_f32 v117, v117
    v_mfma_f32_16x16x32_bf16 v[100:103], v[60:63], a[60:63], v[100:103]
    s_waitcnt lgkmcnt(2)
    v_exp_f32 v118, v118
    v_mfma_f32_16x16x32_bf16 v[88:91], v[64:67], a[64:67], v[88:91]
    buffer_load_dwordx4 v6, s[20:23], s58 offen lds
    v_mfma_f32_16x16x32_bf16 v[88:91], v[68:71], a[80:83], v[88:91]
    s_add_u32 m0, s61, 102400
    ds_read_b64_tr_b16 v[52:53], v4 offset:28672
    ds_read_b64_tr_b16 v[54:55], v4 offset:30720
    v_mfma_f32_16x16x32_bf16 v[92:95], v[64:67], a[68:71], v[92:95]
    s_add_u32 s58, s48, 2950144
    v_exp_f32 v119, v119
    v_mfma_f32_16x16x32_bf16 v[92:95], v[68:71], a[84:87], v[92:95]
    v_exp_f32 v120, v120
    v_mfma_f32_16x16x32_bf16 v[96:99], v[64:67], a[72:75], v[96:99]
    buffer_load_dwordx4 v6, s[20:23], s58 offen lds
    v_mfma_f32_16x16x32_bf16 v[96:99], v[68:71], a[88:91], v[96:99]
    s_add_u32 m0, s61, 106496
    ds_read_b64_tr_b16 v[56:57], v5 offset:4096
    ds_read_b64_tr_b16 v[58:59], v5 offset:6144
    v_mfma_f32_16x16x32_bf16 v[100:103], v[64:67], a[76:79], v[100:103]
    s_add_u32 s58, s48, 3318784
    v_exp_f32 v121, v121
    v_mfma_f32_16x16x32_bf16 v[100:103], v[68:71], a[92:95], v[100:103]
    s_waitcnt lgkmcnt(2)
    v_exp_f32 v122, v122
    v_mfma_f32_16x16x32_bf16 v[88:91], v[48:51], a[96:99], v[88:91]
    buffer_load_dwordx4 v6, s[20:23], s58 offen lds
    v_mfma_f32_16x16x32_bf16 v[88:91], v[52:55], a[112:115], v[88:91]
    s_add_u32 m0, s61, 20480
    ds_read_b64_tr_b16 v[60:61], v5 offset:8192
    ds_read_b64_tr_b16 v[62:63], v5 offset:10240
    v_mfma_f32_16x16x32_bf16 v[92:95], v[48:51], a[100:103], v[92:95]
    s_waitcnt vmcnt(13) lgkmcnt(4)
    s_barrier
    v_exp_f32 v123, v123
    v_mfma_f32_16x16x32_bf16 v[92:95], v[52:55], a[116:119], v[92:95]
    s_add_u32 s58, s48, 3613696
    v_exp_f32 v124, v124
    v_mfma_f32_16x16x32_bf16 v[96:99], v[48:51], a[104:107], v[96:99]
    buffer_load_dwordx4 v6, s[20:23], s58 offen lds
    v_mfma_f32_16x16x32_bf16 v[96:99], v[52:55], a[120:123], v[96:99]
    s_add_u32 m0, s61, 24576
    ds_read_b64_tr_b16 v[64:65], v5 offset:12288
    ds_read_b64_tr_b16 v[66:67], v5 offset:14336
    v_mfma_f32_16x16x32_bf16 v[100:103], v[48:51], a[108:111], v[100:103]
    s_add_u32 s58, s48, 3982336
    v_exp_f32 v125, v125
    v_mfma_f32_16x16x32_bf16 v[100:103], v[52:55], a[124:127], v[100:103]
    s_waitcnt lgkmcnt(2)
    v_exp_f32 v126, v126
    v_exp_f32 v127, v127
    v_pk_add_f32 v[112:113], v[112:113], 1.0 op_sel_hi:[1,0]
    v_pk_add_f32 v[114:115], v[114:115], 1.0 op_sel_hi:[1,0]
    v_pk_add_f32 v[116:117], v[116:117], 1.0 op_sel_hi:[1,0]
    v_pk_add_f32 v[118:119], v[118:119], 1.0 op_sel_hi:[1,0]
    v_pk_add_f32 v[120:121], v[120:121], 1.0 op_sel_hi:[1,0]
    v_pk_add_f32 v[122:123], v[122:123], 1.0 op_sel_hi:[1,0]
    v_pk_add_f32 v[124:125], v[124:125], 1.0 op_sel_hi:[1,0]
    v_pk_add_f32 v[126:127], v[126:127], 1.0 op_sel_hi:[1,0]
    v_mfma_f32_16x16x32_bf16 v[88:91], v[56:59], a[128:131], v[88:91]
    buffer_load_dwordx4 v6, s[20:23], s58 offen lds
    v_mfma_f32_16x16x32_bf16 v[88:91], v[60:63], a[144:147], v[88:91]
    s_add_u32 m0, s61, 28672
    ds_read_b64_tr_b16 v[68:69], v4 offset:32768
    ds_read_b64_tr_b16 v[70:71], v4 offset:34816
    v_mfma_f32_16x16x32_bf16 v[92:95], v[56:59], a[132:135], v[92:95]
    s_add_u32 s58, s48, 4277248
    v_rcp_f32 v112, v112
    v_mfma_f32_16x16x32_bf16 v[92:95], v[60:63], a[148:151], v[92:95]
    v_rcp_f32 v113, v113
    v_mfma_f32_16x16x32_bf16 v[96:99], v[56:59], a[136:139], v[96:99]
    buffer_load_dwordx4 v6, s[20:23], s58 offen lds
    v_mfma_f32_16x16x32_bf16 v[96:99], v[60:63], a[152:155], v[96:99]
    s_add_u32 m0, s61, 110592
    ds_read_b64_tr_b16 v[48:49], v4 offset:36864
    ds_read_b64_tr_b16 v[50:51], v4 offset:38912
    v_mfma_f32_16x16x32_bf16 v[100:103], v[56:59], a[140:143], v[100:103]
    s_add_u32 s58, s48, 4645888
    v_rcp_f32 v114, v114
    v_mfma_f32_16x16x32_bf16 v[100:103], v[60:63], a[156:159], v[100:103]
    s_waitcnt lgkmcnt(2)
    v_rcp_f32 v115, v115
    v_mfma_f32_16x16x32_bf16 v[88:91], v[64:67], a[160:163], v[88:91]
    buffer_load_dwordx4 v6, s[20:23], s58 offen lds
    v_mfma_f32_16x16x32_bf16 v[88:91], v[68:71], a[176:179], v[88:91]
    s_add_u32 m0, s61, 114688
    ds_read_b64_tr_b16 v[52:53], v4 offset:40960
    ds_read_b64_tr_b16 v[54:55], v4 offset:43008
    v_mfma_f32_16x16x32_bf16 v[92:95], v[64:67], a[164:167], v[92:95]
    s_add_u32 s58, s48, 4940800
    v_rcp_f32 v116, v116
    v_mfma_f32_16x16x32_bf16 v[92:95], v[68:71], a[180:183], v[92:95]
    v_rcp_f32 v117, v117
    v_mfma_f32_16x16x32_bf16 v[96:99], v[64:67], a[168:171], v[96:99]
    buffer_load_dwordx4 v6, s[20:23], s58 offen lds
    v_mfma_f32_16x16x32_bf16 v[96:99], v[68:71], a[184:187], v[96:99]
    s_add_u32 m0, s61, 118784
    ds_read_b64_tr_b16 v[56:57], v5 offset:16384
    ds_read_b64_tr_b16 v[58:59], v5 offset:18432
    v_mfma_f32_16x16x32_bf16 v[100:103], v[64:67], a[172:175], v[100:103]
    s_add_u32 s58, s48, 1024
    v_rcp_f32 v118, v118
    v_mfma_f32_16x16x32_bf16 v[100:103], v[68:71], a[188:191], v[100:103]
    s_waitcnt lgkmcnt(2)
    v_rcp_f32 v119, v119
    v_mfma_f32_16x16x32_bf16 v[88:91], v[48:51], a[192:195], v[88:91]
    buffer_load_dwordx4 v7, s[20:23], s58 offen lds
    v_mfma_f32_16x16x32_bf16 v[88:91], v[52:55], a[208:211], v[88:91]
    s_add_u32 m0, s61, 73728
    ds_read_b64_tr_b16 v[60:61], v5 offset:20480
    ds_read_b64_tr_b16 v[62:63], v5 offset:22528
    v_mfma_f32_16x16x32_bf16 v[92:95], v[48:51], a[196:199], v[92:95]
    s_waitcnt vmcnt(13) lgkmcnt(4)
    s_barrier
    v_rcp_f32 v120, v120
    v_mfma_f32_16x16x32_bf16 v[92:95], v[52:55], a[212:215], v[92:95]
    s_add_u32 s58, s48, 2655232
    v_rcp_f32 v121, v121
    v_mfma_f32_16x16x32_bf16 v[96:99], v[48:51], a[200:203], v[96:99]
    buffer_load_dwordx4 v7, s[20:23], s58 offen lds
    v_mfma_f32_16x16x32_bf16 v[96:99], v[52:55], a[216:219], v[96:99]
    s_add_u32 m0, s61, 77824
    ds_read_b64_tr_b16 v[64:65], v5 offset:24576
    ds_read_b64_tr_b16 v[66:67], v5 offset:26624
    v_mfma_f32_16x16x32_bf16 v[100:103], v[48:51], a[204:207], v[100:103]
    s_add_u32 s58, s57, 1024
    v_rcp_f32 v122, v122
    v_mfma_f32_16x16x32_bf16 v[100:103], v[52:55], a[220:223], v[100:103]
    s_waitcnt lgkmcnt(2)
    v_rcp_f32 v123, v123
    v_mfma_f32_16x16x32_bf16 v[88:91], v[56:59], a[224:227], v[88:91]
    buffer_load_dwordx4 v242, s[24:27], s58 offen lds
    v_mfma_f32_16x16x32_bf16 v[88:91], v[60:63], a[240:243], v[88:91]
    s_add_u32 m0, s61, 122880
    ds_read_b64_tr_b16 v[68:69], v4 offset:0
    ds_read_b64_tr_b16 v[70:71], v4 offset:2048
    v_mfma_f32_16x16x32_bf16 v[92:95], v[56:59], a[228:231], v[92:95]
    s_add_u32 s58, s57, 19456
    v_rcp_f32 v124, v124
    v_mfma_f32_16x16x32_bf16 v[92:95], v[60:63], a[244:247], v[92:95]
    v_rcp_f32 v125, v125
    v_mfma_f32_16x16x32_bf16 v[96:99], v[56:59], a[232:235], v[96:99]
    buffer_load_dwordx4 v242, s[24:27], s58 offen lds
    v_mfma_f32_16x16x32_bf16 v[96:99], v[60:63], a[248:251], v[96:99]
    s_add_u32 m0, s61, 126976
    ds_read_b64_tr_b16 v[48:49], v4 offset:4096
    ds_read_b64_tr_b16 v[50:51], v4 offset:6144
    v_mfma_f32_16x16x32_bf16 v[100:103], v[56:59], a[236:239], v[100:103]
    s_add_u32 s58, s57, 37888
    v_rcp_f32 v126, v126
    v_rcp_f32 v127, v127
    v_pk_mul_f32 v[112:113], v[72:73], v[112:113]
    v_pk_mul_f32 v[114:115], v[74:75], v[114:115]
    v_pk_mul_f32 v[116:117], v[76:77], v[116:117]
    v_pk_mul_f32 v[118:119], v[78:79], v[118:119]
    v_pk_mul_f32 v[120:121], v[80:81], v[120:121]
    v_pk_mul_f32 v[122:123], v[82:83], v[122:123]
    v_pk_mul_f32 v[124:125], v[84:85], v[124:125]
    v_pk_mul_f32 v[126:127], v[86:87], v[126:127]
    v_mfma_f32_16x16x32_bf16 v[100:103], v[60:63], a[252:255], v[100:103]
    s_waitcnt lgkmcnt(2)
    v_cvt_pk_bf16_f32 v212, v112, v113
    v_cvt_pk_bf16_f32 v213, v114, v115
    v_mfma_f32_16x16x32_bf16 v[88:91], v[64:67], v[16:19], v[88:91]
    buffer_load_dwordx4 v242, s[24:27], s58 offen lds
    v_mfma_f32_16x16x32_bf16 v[88:91], v[68:71], v[32:35], v[88:91]
    s_add_u32 m0, s61, 131072
    ds_read_b64_tr_b16 v[52:53], v4 offset:45056
    ds_read_b64_tr_b16 v[54:55], v4 offset:47104
    v_mfma_f32_16x16x32_bf16 v[92:95], v[64:67], v[20:23], v[92:95]
    s_add_u32 s58, s57, 56320
    v_cvt_pk_bf16_f32 v216, v116, v117
    v_cvt_pk_bf16_f32 v217, v118, v119
    v_mfma_f32_16x16x32_bf16 v[92:95], v[68:71], v[36:39], v[92:95]
    v_cvt_pk_bf16_f32 v220, v120, v121
    v_cvt_pk_bf16_f32 v221, v122, v123
    v_mfma_f32_16x16x32_bf16 v[96:99], v[64:67], v[24:27], v[96:99]
    buffer_load_dwordx4 v242, s[24:27], s58 offen lds
    v_mfma_f32_16x16x32_bf16 v[96:99], v[68:71], v[40:43], v[96:99]
    s_add_u32 m0, s61, 135168
    ds_read_b64_tr_b16 v[56:57], v4 offset:49152
    ds_read_b64_tr_b16 v[58:59], v4 offset:51200
    v_mfma_f32_16x16x32_bf16 v[100:103], v[64:67], v[28:31], v[100:103]
    s_add_u32 s58, s57, 148480
    v_cvt_pk_bf16_f32 v224, v124, v125
    v_cvt_pk_bf16_f32 v225, v126, v127
    v_mfma_f32_16x16x32_bf16 v[100:103], v[68:71], v[44:47], v[100:103]
    s_waitcnt lgkmcnt(2)
    v_mfma_f32_16x16x32_bf16 v[72:75], v[48:51], a[0:3], v[160:163]
    buffer_load_dwordx4 v242, s[24:27], s58 offen lds
    v_mfma_f32_16x16x32_bf16 v[72:75], v[52:55], a[16:19], v[72:75]
    s_add_u32 m0, s61, 81920
    ds_read_b64_tr_b16 v[60:61], v4 offset:53248
    ds_read_b64_tr_b16 v[62:63], v4 offset:55296
    v_mfma_f32_16x16x32_bf16 v[76:79], v[48:51], a[4:7], v[160:163]
    s_waitcnt vmcnt(13) lgkmcnt(4)
    s_barrier
    v_pk_fma_f32 v[112:113], v[88:89], v[88:89], s[62:63]
    v_pk_fma_f32 v[114:115], v[90:91], v[90:91], s[62:63]
    v_pk_fma_f32 v[116:117], v[92:93], v[92:93], s[62:63]
    v_pk_fma_f32 v[118:119], v[94:95], v[94:95], s[62:63]
    v_pk_fma_f32 v[120:121], v[96:97], v[96:97], s[62:63]
    v_pk_fma_f32 v[122:123], v[98:99], v[98:99], s[62:63]
    v_pk_fma_f32 v[124:125], v[100:101], v[100:101], s[62:63]
    v_pk_fma_f32 v[126:127], v[102:103], v[102:103], s[62:63]
    v_pk_mul_f32 v[112:113], v[88:89], v[112:113]
    v_pk_mul_f32 v[114:115], v[90:91], v[114:115]
    v_pk_mul_f32 v[116:117], v[92:93], v[116:117]
    v_pk_mul_f32 v[118:119], v[94:95], v[118:119]
    v_pk_mul_f32 v[120:121], v[96:97], v[120:121]
    v_pk_mul_f32 v[122:123], v[98:99], v[122:123]
    v_pk_mul_f32 v[124:125], v[100:101], v[124:125]
    v_pk_mul_f32 v[126:127], v[102:103], v[126:127]
    v_mfma_f32_16x16x32_bf16 v[76:79], v[52:55], a[20:23], v[76:79]
    s_add_u32 s58, s57, 166912
    v_exp_f32 v112, v112
    v_mfma_f32_16x16x32_bf16 v[80:83], v[48:51], a[8:11], v[160:163]
    buffer_load_dwordx4 v242, s[24:27], s58 offen lds
    v_mfma_f32_16x16x32_bf16 v[80:83], v[52:55], a[24:27], v[80:83]
    s_add_u32 m0, s61, 86016
    ds_read_b64_tr_b16 v[64:65], v5 offset:28672
    ds_read_b64_tr_b16 v[66:67], v5 offset:30720
    v_mfma_f32_16x16x32_bf16 v[84:87], v[48:51], a[12:15], v[160:163]
    s_add_u32 s58, s57, 185344
    v_exp_f32 v113, v113
    v_mfma_f32_16x16x32_bf16 v[84:87], v[52:55], a[28:31], v[84:87]
    s_waitcnt lgkmcnt(2)
    v_exp_f32 v114, v114
    v_mfma_f32_16x16x32_bf16 v[72:75], v[56:59], a[32:35], v[72:75]
    buffer_load_dwordx4 v242, s[24:27], s58 offen lds
    v_mfma_f32_16x16x32_bf16 v[72:75], v[60:63], a[48:51], v[72:75]
    s_add_u32 m0, s61, 90112
    ds_read_b64_tr_b16 v[68:69], v4 offset:8192
    ds_read_b64_tr_b16 v[70:71], v4 offset:10240
    v_mfma_f32_16x16x32_bf16 v[76:79], v[56:59], a[36:39], v[76:79]
    s_add_u32 s58, s57, 203776
    v_exp_f32 v115, v115
    v_mfma_f32_16x16x32_bf16 v[76:79], v[60:63], a[52:55], v[76:79]
    v_exp_f32 v116, v116
    v_mfma_f32_16x16x32_bf16 v[80:83], v[56:59], a[40:43], v[80:83]
    buffer_load_dwordx4 v242, s[24:27], s58 offen lds
    v_mfma_f32_16x16x32_bf16 v[80:83], v[60:63], a[56:59], v[80:83]
    s_add_u32 m0, s61, 139264
    ds_read_b64_tr_b16 v[48:49], v4 offset:12288
    ds_read_b64_tr_b16 v[50:51], v4 offset:14336
    v_mfma_f32_16x16x32_bf16 v[84:87], v[56:59], a[44:47], v[84:87]
    s_add_u32 s58, s57, 295936
    v_exp_f32 v117, v117
    v_mfma_f32_16x16x32_bf16 v[84:87], v[60:63], a[60:63], v[84:87]
    s_waitcnt lgkmcnt(2)
    v_exp_f32 v118, v118
    v_mfma_f32_16x16x32_bf16 v[72:75], v[64:67], a[64:67], v[72:75]
    buffer_load_dwordx4 v242, s[24:27], s58 offen lds
    v_mfma_f32_16x16x32_bf16 v[72:75], v[68:71], a[80:83], v[72:75]
    s_add_u32 m0, s61, 143360
    ds_read_b64_tr_b16 v[52:53], v4 offset:16384
    ds_read_b64_tr_b16 v[54:55], v4 offset:18432
    v_mfma_f32_16x16x32_bf16 v[76:79], v[64:67], a[68:71], v[76:79]
    s_add_u32 s58, s57, 314368
    v_exp_f32 v119, v119
    v_mfma_f32_16x16x32_bf16 v[76:79], v[68:71], a[84:87], v[76:79]
    v_exp_f32 v120, v120
    v_mfma_f32_16x16x32_bf16 v[80:83], v[64:67], a[72:75], v[80:83]
    buffer_load_dwordx4 v242, s[24:27], s58 offen lds
    v_mfma_f32_16x16x32_bf16 v[80:83], v[68:71], a[88:91], v[80:83]
    s_add_u32 m0, s61, 147456
    ds_read_b64_tr_b16 v[56:57], v5 offset:32768
    ds_read_b64_tr_b16 v[58:59], v5 offset:34816
    v_mfma_f32_16x16x32_bf16 v[84:87], v[64:67], a[76:79], v[84:87]
    s_add_u32 s58, s57, 332800
    v_exp_f32 v121, v121
    v_mfma_f32_16x16x32_bf16 v[84:87], v[68:71], a[92:95], v[84:87]
    s_waitcnt lgkmcnt(2)
    v_exp_f32 v122, v122
    v_mfma_f32_16x16x32_bf16 v[72:75], v[48:51], a[96:99], v[72:75]
    buffer_load_dwordx4 v242, s[24:27], s58 offen lds
    v_mfma_f32_16x16x32_bf16 v[72:75], v[52:55], a[112:115], v[72:75]
    s_add_u32 m0, s61, 94208
    ds_read_b64_tr_b16 v[60:61], v5 offset:36864
    ds_read_b64_tr_b16 v[62:63], v5 offset:38912
    v_mfma_f32_16x16x32_bf16 v[76:79], v[48:51], a[100:103], v[76:79]
    s_waitcnt vmcnt(13) lgkmcnt(4)
    s_barrier
    v_exp_f32 v123, v123
    v_mfma_f32_16x16x32_bf16 v[76:79], v[52:55], a[116:119], v[76:79]
    s_add_u32 s58, s57, 351232
    v_exp_f32 v124, v124
    v_mfma_f32_16x16x32_bf16 v[80:83], v[48:51], a[104:107], v[80:83]
    buffer_load_dwordx4 v242, s[24:27], s58 offen lds
    v_mfma_f32_16x16x32_bf16 v[80:83], v[52:55], a[120:123], v[80:83]
    s_add_u32 m0, s61, 151552
    ds_read_b64_tr_b16 v[64:65], v5 offset:40960
    ds_read_b64_tr_b16 v[66:67], v5 offset:43008
    v_mfma_f32_16x16x32_bf16 v[84:87], v[48:51], a[108:111], v[84:87]
    s_add_u32 s58, s57, 443392
    v_exp_f32 v125, v125
    v_mfma_f32_16x16x32_bf16 v[84:87], v[52:55], a[124:127], v[84:87]
    s_waitcnt lgkmcnt(2)
    v_exp_f32 v126, v126
    v_exp_f32 v127, v127
    v_pk_add_f32 v[112:113], v[112:113], 1.0 op_sel_hi:[1,0]
    v_pk_add_f32 v[114:115], v[114:115], 1.0 op_sel_hi:[1,0]
    v_pk_add_f32 v[116:117], v[116:117], 1.0 op_sel_hi:[1,0]
    v_pk_add_f32 v[118:119], v[118:119], 1.0 op_sel_hi:[1,0]
    v_pk_add_f32 v[120:121], v[120:121], 1.0 op_sel_hi:[1,0]
    v_pk_add_f32 v[122:123], v[122:123], 1.0 op_sel_hi:[1,0]
    v_pk_add_f32 v[124:125], v[124:125], 1.0 op_sel_hi:[1,0]
    v_pk_add_f32 v[126:127], v[126:127], 1.0 op_sel_hi:[1,0]
    v_mfma_f32_16x16x32_bf16 v[72:75], v[56:59], a[128:131], v[72:75]
    buffer_load_dwordx4 v242, s[24:27], s58 offen lds
    v_mfma_f32_16x16x32_bf16 v[72:75], v[60:63], a[144:147], v[72:75]
    s_add_u32 m0, s61, 155648
    ds_read_b64_tr_b16 v[68:69], v4 offset:20480
    ds_read_b64_tr_b16 v[70:71], v4 offset:22528
    v_mfma_f32_16x16x32_bf16 v[76:79], v[56:59], a[132:135], v[76:79]
    s_add_u32 s58, s57, 461824
    v_rcp_f32 v112, v112
    v_mfma_f32_16x16x32_bf16 v[76:79], v[60:63], a[148:151], v[76:79]
    v_rcp_f32 v113, v113
    v_mfma_f32_16x16x32_bf16 v[80:83], v[56:59], a[136:139], v[80:83]
    buffer_load_dwordx4 v242, s[24:27], s58 offen lds
    v_mfma_f32_16x16x32_bf16 v[80:83], v[60:63], a[152:155], v[80:83]
    s_add_u32 m0, s61, 159744
    ds_read_b64_tr_b16 v[48:49], v4 offset:24576
    ds_read_b64_tr_b16 v[50:51], v4 offset:26624
    v_mfma_f32_16x16x32_bf16 v[84:87], v[56:59], a[140:143], v[84:87]
    s_add_u32 s58, s57, 480256
    v_rcp_f32 v114, v114
    v_mfma_f32_16x16x32_bf16 v[84:87], v[60:63], a[156:159], v[84:87]
    s_waitcnt lgkmcnt(2)
    v_rcp_f32 v115, v115
    v_mfma_f32_16x16x32_bf16 v[72:75], v[64:67], a[160:163], v[72:75]
    buffer_load_dwordx4 v242, s[24:27], s58 offen lds
    v_mfma_f32_16x16x32_bf16 v[72:75], v[68:71], a[176:179], v[72:75]
    ds_read_b64_tr_b16 v[52:53], v4 offset:28672
    ds_read_b64_tr_b16 v[54:55], v4 offset:30720
    v_mfma_f32_16x16x32_bf16 v[76:79], v[64:67], a[164:167], v[76:79]
    v_rcp_f32 v116, v116
    v_mfma_f32_16x16x32_bf16 v[76:79], v[68:71], a[180:183], v[76:79]
    v_rcp_f32 v117, v117
    v_mfma_f32_16x16x32_bf16 v[80:83], v[64:67], a[168:171], v[80:83]
    v_mfma_f32_16x16x32_bf16 v[80:83], v[68:71], a[184:187], v[80:83]
    ds_read_b64_tr_b16 v[56:57], v5 offset:45056
    ds_read_b64_tr_b16 v[58:59], v5 offset:47104
    v_mfma_f32_16x16x32_bf16 v[84:87], v[64:67], a[172:175], v[84:87]
    v_rcp_f32 v118, v118
    v_mfma_f32_16x16x32_bf16 v[84:87], v[68:71], a[188:191], v[84:87]
    s_waitcnt lgkmcnt(2)
    v_rcp_f32 v119, v119
    v_mfma_f32_16x16x32_bf16 v[72:75], v[48:51], a[192:195], v[72:75]
    buffer_load_dwordx2 v[152:153], v248, s[28:31], 0 offen sc1
    buffer_load_dwordx2 v[154:155], v249, s[28:31], 0 offen sc1
    v_mfma_f32_16x16x32_bf16 v[72:75], v[52:55], a[208:211], v[72:75]
    ds_read_b64_tr_b16 v[60:61], v5 offset:49152
    ds_read_b64_tr_b16 v[62:63], v5 offset:51200
    v_mfma_f32_16x16x32_bf16 v[76:79], v[48:51], a[196:199], v[76:79]
    s_waitcnt vmcnt(13) lgkmcnt(4)
    s_barrier
    v_rcp_f32 v120, v120
    v_mfma_f32_16x16x32_bf16 v[76:79], v[52:55], a[212:215], v[76:79]
    v_rcp_f32 v121, v121
    v_mfma_f32_16x16x32_bf16 v[80:83], v[48:51], a[200:203], v[80:83]
    buffer_load_dwordx2 v[156:157], v250, s[28:31], 0 offen sc1
    buffer_load_dwordx2 v[158:159], v251, s[28:31], 0 offen sc1
    v_mfma_f32_16x16x32_bf16 v[80:83], v[52:55], a[216:219], v[80:83]
    ds_read_b64_tr_b16 v[64:65], v5 offset:53248
    ds_read_b64_tr_b16 v[66:67], v5 offset:55296
    v_mfma_f32_16x16x32_bf16 v[84:87], v[48:51], a[204:207], v[84:87]
    v_rcp_f32 v122, v122
    v_mfma_f32_16x16x32_bf16 v[84:87], v[52:55], a[220:223], v[84:87]
    s_waitcnt lgkmcnt(2)
    v_rcp_f32 v123, v123
    v_mfma_f32_16x16x32_bf16 v[72:75], v[56:59], a[224:227], v[72:75]
    buffer_load_dwordx2 v[160:161], v252, s[28:31], 0 offen sc1
    buffer_load_dwordx2 v[236:237], v13, s[40:43], 0 offen
    v_mfma_f32_16x16x32_bf16 v[72:75], v[60:63], a[240:243], v[72:75]
    ds_read_b64_tr_b16 v[68:69], v5 offset:8192
    ds_read_b64_tr_b16 v[70:71], v5 offset:10240
    v_mfma_f32_16x16x32_bf16 v[76:79], v[56:59], a[228:231], v[76:79]
    v_rcp_f32 v124, v124
    v_mfma_f32_16x16x32_bf16 v[76:79], v[60:63], a[244:247], v[76:79]
    v_rcp_f32 v125, v125
    v_mfma_f32_16x16x32_bf16 v[80:83], v[56:59], a[232:235], v[80:83]
    buffer_load_dwordx2 v[238:239], v14, s[40:43], 0 offen
    s_lshl_b32 s6, s5, 5
    s_add_u32 s6, s6, s4
    s_mul_i32 s6, s6, 20736
    buffer_load_dword v255, v255, s[24:27], s6 offen
    v_mfma_f32_16x16x32_bf16 v[80:83], v[60:63], a[248:251], v[80:83]
    ds_read_b64_tr_b16 v[48:49], v5 offset:12288
    ds_read_b64_tr_b16 v[50:51], v5 offset:14336
    v_mfma_f32_16x16x32_bf16 v[84:87], v[56:59], a[236:239], v[84:87]
    v_rcp_f32 v126, v126
    v_rcp_f32 v127, v127
    v_pk_mul_f32 v[112:113], v[88:89], v[112:113]
    v_pk_mul_f32 v[114:115], v[90:91], v[114:115]
    v_pk_mul_f32 v[116:117], v[92:93], v[116:117]
    v_pk_mul_f32 v[118:119], v[94:95], v[118:119]
    v_pk_mul_f32 v[120:121], v[96:97], v[120:121]
    v_pk_mul_f32 v[122:123], v[98:99], v[122:123]
    v_pk_mul_f32 v[124:125], v[100:101], v[124:125]
    v_pk_mul_f32 v[126:127], v[102:103], v[126:127]
    v_mfma_f32_16x16x32_bf16 v[84:87], v[60:63], a[252:255], v[84:87]
    s_waitcnt lgkmcnt(2)
    v_cvt_pk_bf16_f32 v214, v112, v113
    v_cvt_pk_bf16_f32 v215, v114, v115
    v_mfma_f32_16x16x32_bf16 v[72:75], v[64:67], v[16:19], v[72:75]
    v_mfma_f32_16x16x32_bf16 v[72:75], v[68:71], v[32:35], v[72:75]
    ds_read_b64_tr_b16 v[52:53], v5 offset:57344
    ds_read_b64_tr_b16 v[54:55], v5 offset:59392
    v_mfma_f32_16x16x32_bf16 v[76:79], v[64:67], v[20:23], v[76:79]
    v_cvt_pk_bf16_f32 v218, v116, v117
    v_cvt_pk_bf16_f32 v219, v118, v119
    v_mfma_f32_16x16x32_bf16 v[76:79], v[68:71], v[36:39], v[76:79]
    v_cvt_pk_bf16_f32 v222, v120, v121
    v_cvt_pk_bf16_f32 v223, v122, v123
    v_mfma_f32_16x16x32_bf16 v[80:83], v[64:67], v[24:27], v[80:83]
    v_mfma_f32_16x16x32_bf16 v[80:83], v[68:71], v[40:43], v[80:83]
    ds_read_b64_tr_b16 v[56:57], v5 offset:61440
    ds_read_b64_tr_b16 v[58:59], v5 offset:63488
    v_mfma_f32_16x16x32_bf16 v[84:87], v[64:67], v[28:31], v[84:87]
    v_cvt_pk_bf16_f32 v226, v124, v125
    v_cvt_pk_bf16_f32 v227, v126, v127
    v_mfma_f32_16x16x32_bf16 v[84:87], v[68:71], v[44:47], v[84:87]
    s_waitcnt lgkmcnt(4)
    ds_write_b128 v9, v[164:167] offset:0
    v_pk_fma_f32 v[112:113], v[72:73], v[72:73], s[62:63]
    v_pk_fma_f32 v[114:115], v[74:75], v[74:75], s[62:63]
    v_pk_fma_f32 v[116:117], v[76:77], v[76:77], s[62:63]
    v_pk_fma_f32 v[118:119], v[78:79], v[78:79], s[62:63]
    v_pk_fma_f32 v[120:121], v[80:81], v[80:81], s[62:63]
    v_pk_fma_f32 v[122:123], v[82:83], v[82:83], s[62:63]
    ds_write_b128 v9, v[168:171] offset:1024
    v_pk_fma_f32 v[124:125], v[84:85], v[84:85], s[62:63]
    v_pk_fma_f32 v[126:127], v[86:87], v[86:87], s[62:63]
    v_pk_mul_f32 v[112:113], v[72:73], v[112:113]
    v_pk_mul_f32 v[114:115], v[74:75], v[114:115]
    v_pk_mul_f32 v[116:117], v[76:77], v[116:117]
    v_pk_mul_f32 v[118:119], v[78:79], v[118:119]
    ds_write_b128 v9, v[172:175] offset:2048
    v_pk_mul_f32 v[120:121], v[80:81], v[120:121]
    v_pk_mul_f32 v[122:123], v[82:83], v[122:123]
    v_pk_mul_f32 v[124:125], v[84:85], v[124:125]
    v_pk_mul_f32 v[126:127], v[86:87], v[126:127]
    v_exp_f32 v112, v112
    ds_write_b128 v9, v[176:179] offset:3072
    v_exp_f32 v113, v113
    v_exp_f32 v114, v114
    v_exp_f32 v115, v115
    ds_write_b128 v9, v[180:183] offset:16384
    v_exp_f32 v116, v116
    v_exp_f32 v117, v117
    v_exp_f32 v118, v118
    ds_write_b128 v9, v[184:187] offset:17408
    v_exp_f32 v119, v119
    v_exp_f32 v120, v120
    v_exp_f32 v121, v121
    ds_write_b128 v9, v[188:191] offset:18432
    v_exp_f32 v122, v122
    v_exp_f32 v123, v123
    v_exp_f32 v124, v124
    ds_write_b128 v9, v[192:195] offset:19456
    v_exp_f32 v125, v125
    v_exp_f32 v126, v126
    v_exp_f32 v127, v127
    ds_write_b128 v9, v[196:199] offset:32768
    v_pk_add_f32 v[112:113], v[112:113], 1.0 op_sel_hi:[1,0]
    v_pk_add_f32 v[114:115], v[114:115], 1.0 op_sel_hi:[1,0]
    v_pk_add_f32 v[116:117], v[116:117], 1.0 op_sel_hi:[1,0]
    v_pk_add_f32 v[118:119], v[118:119], 1.0 op_sel_hi:[1,0]
    v_pk_add_f32 v[120:121], v[120:121], 1.0 op_sel_hi:[1,0]
    v_pk_add_f32 v[122:123], v[122:123], 1.0 op_sel_hi:[1,0]
    ds_write_b128 v9, v[200:203] offset:33792
    v_pk_add_f32 v[124:125], v[124:125], 1.0 op_sel_hi:[1,0]
    v_pk_add_f32 v[126:127], v[126:127], 1.0 op_sel_hi:[1,0]
    v_rcp_f32 v112, v112
    v_rcp_f32 v113, v113
    ds_write_b128 v9, v[204:207] offset:34816
    v_rcp_f32 v114, v114
    v_rcp_f32 v115, v115
    v_rcp_f32 v116, v116
    ds_write_b128 v9, v[208:211] offset:35840
    v_rcp_f32 v117, v117
    v_rcp_f32 v118, v118
    v_rcp_f32 v119, v119
    s_waitcnt lgkmcnt(8)
    s_barrier
    ds_read_b128 a[0:3], v15 offset:0
    ds_read_b128 a[4:7], v15 offset:1024
    ds_read_b128 a[8:11], v15 offset:2048
    ds_read_b128 a[12:15], v15 offset:3072
    ds_write_b128 v9, v[212:215] offset:49152
    v_rcp_f32 v120, v120
    v_rcp_f32 v121, v121
    v_rcp_f32 v122, v122
    ds_write_b128 v9, v[216:219] offset:50176
    v_rcp_f32 v123, v123
    v_rcp_f32 v124, v124
    v_rcp_f32 v125, v125
    ds_write_b128 v9, v[220:223] offset:51200
    v_rcp_f32 v126, v126
    v_rcp_f32 v127, v127
    v_pk_mul_f32 v[112:113], v[72:73], v[112:113]
    v_pk_mul_f32 v[114:115], v[74:75], v[114:115]
    ds_write_b128 v9, v[224:227] offset:52224
    v_pk_mul_f32 v[116:117], v[76:77], v[116:117]
    v_pk_mul_f32 v[118:119], v[78:79], v[118:119]
    v_pk_mul_f32 v[120:121], v[80:81], v[120:121]
    v_pk_mul_f32 v[122:123], v[82:83], v[122:123]
    v_pk_mul_f32 v[124:125], v[84:85], v[124:125]
    v_pk_mul_f32 v[126:127], v[86:87], v[126:127]
    v_cvt_pk_bf16_f32 v228, v112, v113
    v_cvt_pk_bf16_f32 v229, v114, v115
    ds_write_b64 v10, v[228:229] offset:0
    ds_read_b128 a[16:19], v15 offset:4096
    v_cvt_pk_bf16_f32 v230, v116, v117
    v_cvt_pk_bf16_f32 v231, v118, v119
    ds_write_b64 v10, v[230:231] offset:1024
    ds_read_b128 a[20:23], v15 offset:5120
    v_cvt_pk_bf16_f32 v232, v120, v121
    v_cvt_pk_bf16_f32 v233, v122, v123
    ds_write_b64 v10, v[232:233] offset:2048
    ds_read_b128 a[24:27], v15 offset:6144
    v_cvt_pk_bf16_f32 v234, v124, v125
    v_cvt_pk_bf16_f32 v235, v126, v127
    ds_write_b64 v10, v[234:235] offset:3072
    ds_read_b128 a[28:31], v15 offset:7168
    s_add_u32 m0, s61, 73728
    s_add_u32 s58, s57, 498688
    buffer_load_dwordx4 v242, s[24:27], s58 offen lds
    s_add_u32 m0, s61, 77824
    s_add_u32 s58, s57, 590848
    buffer_load_dwordx4 v8, s[24:27], s58 offen lds
    s_add_u32 m0, s61, 98304
    s_add_u32 s58, s57, 627712
    buffer_load_dwordx4 v8, s[24:27], s58 offen lds
    s_add_u32 m0, s61, 102400
    s_add_u32 s58, s8, 0
    buffer_load_dwordx4 v242, s[24:27], s58 offen lds
    s_add_u32 m0, s61, 106496
    s_add_u32 s58, s8, 18432
    buffer_load_dwordx4 v242, s[24:27], s58 offen lds
    s_add_u32 m0, s61, 110592
    s_add_u32 s58, s8, 36864
    buffer_load_dwordx4 v242, s[24:27], s58 offen lds
    s_add_u32 m0, s61, 114688
    s_add_u32 s58, s8, 55296
    buffer_load_dwordx4 v242, s[24:27], s58 offen lds
    s_add_u32 m0, s61, 118784
    s_add_u32 s58, s8, 147456
    s_waitcnt lgkmcnt(8)
    s_barrier
    v_mfma_f32_16x16x32_bf16 v[88:91], v[48:51], a[0:3], 0
    buffer_load_dwordx4 v242, s[24:27], s58 offen lds
    v_mfma_f32_16x16x32_bf16 v[92:95], v[48:51], a[4:7], 0
    s_add_u32 m0, s61, 0
    ds_read_b64_tr_b16 v[60:61], v240 offset:0
    ds_read_b64_tr_b16 v[62:63], v240 offset:2048
    v_mfma_f32_16x16x32_bf16 v[96:99], v[48:51], a[8:11], 0
    s_waitcnt vmcnt(24) lgkmcnt(15)
    s_barrier
    ds_read_b128 a[32:35], v15 offset:8192
    ds_read_b128 a[36:39], v15 offset:9216
    v_mfma_f32_16x16x32_bf16 v[100:103], v[48:51], a[12:15], 0
    s_waitcnt lgkmcnt(4)
    s_add_u32 s58, s8, 165888
    ds_read_b128 a[40:43], v15 offset:10240
    ds_read_b128 a[44:47], v15 offset:11264
    v_mfma_f32_16x16x32_bf16 v[88:91], v[52:55], a[16:19], v[88:91]
    buffer_load_dwordx4 v242, s[24:27], s58 offen lds
    v_mfma_f32_16x16x32_bf16 v[92:95], v[52:55], a[20:23], v[92:95]
    s_add_u32 m0, s61, 122880
    ds_read_b64_tr_b16 v[64:65], v240 offset:4096
    ds_read_b64_tr_b16 v[66:67], v240 offset:6144
    v_mfma_f32_16x16x32_bf16 v[96:99], v[52:55], a[24:27], v[96:99]
    s_add_u32 s58, s8, 184320
    ds_read_b128 a[48:51], v15 offset:12288
    ds_read_b128 a[52:55], v15 offset:13312
    v_mfma_f32_16x16x32_bf16 v[100:103], v[52:55], a[28:31], v[100:103]
    s_waitcnt lgkmcnt(4)
    ds_read_b128 a[56:59], v15 offset:14336
    ds_read_b128 a[60:63], v15 offset:15360
    v_mfma_f32_16x16x32_bf16 v[88:91], v[56:59], a[32:35], v[88:91]
    buffer_load_dwordx4 v242, s[24:27], s58 offen lds
    v_mfma_f32_16x16x32_bf16 v[92:95], v[56:59], a[36:39], v[92:95]
    ds_read_b64_tr_b16 v[68:69], v5 offset:16384
    ds_read_b64_tr_b16 v[70:71], v5 offset:18432
    v_mfma_f32_16x16x32_bf16 v[96:99], v[56:59], a[40:43], v[96:99]
    ds_read_b128 a[64:67], v15 offset:16384
    ds_read_b128 a[68:71], v15 offset:17408
    v_mfma_f32_16x16x32_bf16 v[100:103], v[56:59], a[44:47], v[100:103]
    s_waitcnt lgkmcnt(4)
    ds_read_b128 a[72:75], v15 offset:18432
    ds_read_b128 a[76:79], v15 offset:19456
    v_mfma_f32_16x16x32_bf16 v[88:91], v[60:63], a[48:51], v[88:91]
    v_mfma_f32_16x16x32_bf16 v[92:95], v[60:63], a[52:55], v[92:95]
    s_add_u32 m0, s61, 4096
    ds_read_b64_tr_b16 v[48:49], v5 offset:20480
    ds_read_b64_tr_b16 v[50:51], v5 offset:22528
    v_mfma_f32_16x16x32_bf16 v[96:99], v[60:63], a[56:59], v[96:99]
    s_waitcnt vmcnt(23) lgkmcnt(12)
    s_barrier
    ds_read_b128 a[80:83], v15 offset:20480
    ds_read_b128 a[84:87], v15 offset:21504
    v_mfma_f32_16x16x32_bf16 v[100:103], v[60:63], a[60:63], v[100:103]
    s_waitcnt lgkmcnt(4)
    s_add_u32 s58, s8, 202752
    ds_read_b128 a[88:91], v15 offset:22528
    ds_read_b128 a[92:95], v15 offset:23552
    v_mfma_f32_16x16x32_bf16 v[88:91], v[64:67], a[64:67], v[88:91]
    buffer_load_dwordx4 v242, s[24:27], s58 offen lds
    s_add_u32 m0, s61, 126976
    s_add_u32 s58, s8, 294912
    buffer_load_dwordx4 v242, s[24:27], s58 offen lds
    v_mfma_f32_16x16x32_bf16 v[92:95], v[64:67], a[68:71], v[92:95]
    s_add_u32 m0, s61, 8192
    ds_read_b64_tr_b16 v[52:53], v5 offset:24576
    ds_read_b64_tr_b16 v[54:55], v5 offset:26624
    v_mfma_f32_16x16x32_bf16 v[96:99], v[64:67], a[72:75], v[96:99]
    s_add_u32 s58, s8, 313344
    ds_read_b128 a[96:99], v15 offset:24576
    ds_read_b128 a[100:103], v15 offset:25600
    v_mfma_f32_16x16x32_bf16 v[100:103], v[64:67], a[76:79], v[100:103]
    s_waitcnt lgkmcnt(4)
    ds_read_b128 a[104:107], v15 offset:26624
    ds_read_b128 a[108:111], v15 offset:27648
    v_mfma_f32_16x16x32_bf16 v[88:91], v[68:71], a[80:83], v[88:91]
    buffer_load_dwordx4 v242, s[24:27], s58 offen lds
    v_mfma_f32_16x16x32_bf16 v[92:95], v[68:71], a[84:87], v[92:95]
    s_add_u32 m0, s61, 131072
    ds_read_b64_tr_b16 v[56:57], v240 offset:8192
    ds_read_b64_tr_b16 v[58:59], v240 offset:10240
    v_mfma_f32_16x16x32_bf16 v[96:99], v[68:71], a[88:91], v[96:99]
    s_add_u32 s58, s8, 331776
    ds_read_b128 a[112:115], v15 offset:28672
    ds_read_b128 a[116:119], v15 offset:29696
    v_mfma_f32_16x16x32_bf16 v[100:103], v[68:71], a[92:95], v[100:103]
    s_waitcnt lgkmcnt(4)
    ds_read_b128 a[120:123], v15 offset:30720
    ds_read_b128 a[124:127], v15 offset:31744
    v_mfma_f32_16x16x32_bf16 v[88:91], v[48:51], a[96:99], v[88:91]
    buffer_load_dwordx4 v242, s[24:27], s58 offen lds
    v_mfma_f32_16x16x32_bf16 v[92:95], v[48:51], a[100:103], v[92:95]
    s_add_u32 m0, s61, 12288
    ds_read_b64_tr_b16 v[60:61], v240 offset:12288
    ds_read_b64_tr_b16 v[62:63], v240 offset:14336
    v_mfma_f32_16x16x32_bf16 v[96:99], v[48:51], a[104:107], v[96:99]
    s_waitcnt vmcnt(13) lgkmcnt(12)
    s_barrier
    ds_read_b128 a[128:131], v15 offset:32768
    ds_read_b128 a[132:135], v15 offset:33792
    v_mfma_f32_16x16x32_bf16 v[100:103], v[48:51], a[108:111], v[100:103]
    s_waitcnt lgkmcnt(4)
    s_add_u32 s58, s8, 350208
    ds_read_b128 a[136:139], v15 offset:34816
    ds_read_b128 a[140:143], v15 offset:35840
    v_mfma_f32_16x16x32_bf16 v[88:91], v[52:55], a[112:115], v[88:91]
    buffer_load_dwordx4 v242, s[24:27], s58 offen lds
    v_mfma_f32_16x16x32_bf16 v[92:95], v[52:55], a[116:119], v[92:95]
    s_add_u32 m0, s61, 135168
    ds_read_b64_tr_b16 v[64:65], v240 offset:16384
    ds_read_b64_tr_b16 v[66:67], v240 offset:18432
    v_mfma_f32_16x16x32_bf16 v[96:99], v[52:55], a[120:123], v[96:99]
    s_add_u32 s58, s8, 442368
    ds_read_b128 a[144:147], v15 offset:36864
    ds_read_b128 a[148:151], v15 offset:37888
    v_mfma_f32_16x16x32_bf16 v[100:103], v[52:55], a[124:127], v[100:103]
    s_waitcnt lgkmcnt(4)
    ds_read_b128 a[152:155], v15 offset:38912
    ds_read_b128 a[156:159], v15 offset:39936
    v_mfma_f32_16x16x32_bf16 v[88:91], v[56:59], a[128:131], v[88:91]
    buffer_load_dwordx4 v242, s[24:27], s58 offen lds
    v_mfma_f32_16x16x32_bf16 v[92:95], v[56:59], a[132:135], v[92:95]
    s_add_u32 m0, s61, 16384
    ds_read_b64_tr_b16 v[68:69], v5 offset:28672
    ds_read_b64_tr_b16 v[70:71], v5 offset:30720
    v_mfma_f32_16x16x32_bf16 v[96:99], v[56:59], a[136:139], v[96:99]
    s_add_u32 s58, s8, 460800
    ds_read_b128 a[160:163], v15 offset:40960
    ds_read_b128 a[164:167], v15 offset:41984
    v_mfma_f32_16x16x32_bf16 v[100:103], v[56:59], a[140:143], v[100:103]
    s_waitcnt lgkmcnt(4)
    ds_read_b128 a[168:171], v15 offset:43008
    ds_read_b128 a[172:175], v15 offset:44032
    v_mfma_f32_16x16x32_bf16 v[88:91], v[60:63], a[144:147], v[88:91]
    buffer_load_dwordx4 v242, s[24:27], s58 offen lds
    v_mfma_f32_16x16x32_bf16 v[92:95], v[60:63], a[148:151], v[92:95]
    s_add_u32 m0, s61, 81920
    ds_read_b64_tr_b16 v[48:49], v240 offset:20480
    ds_read_b64_tr_b16 v[50:51], v240 offset:22528
    v_mfma_f32_16x16x32_bf16 v[96:99], v[60:63], a[152:155], v[96:99]
    s_add_u32 s58, s8, 479232
    ds_read_b128 a[176:179], v15 offset:45056
    ds_read_b128 a[180:183], v15 offset:46080
    v_mfma_f32_16x16x32_bf16 v[100:103], v[60:63], a[156:159], v[100:103]
    s_waitcnt lgkmcnt(4)
    ds_read_b128 a[184:187], v15 offset:47104
    ds_read_b128 a[188:191], v15 offset:48128
    v_mfma_f32_16x16x32_bf16 v[88:91], v[64:67], a[160:163], v[88:91]
    buffer_load_dwordx4 v242, s[24:27], s58 offen lds
    v_mfma_f32_16x16x32_bf16 v[92:95], v[64:67], a[164:167], v[92:95]
    s_add_u32 m0, s61, 20480
    ds_read_b64_tr_b16 v[52:53], v240 offset:24576
    ds_read_b64_tr_b16 v[54:55], v240 offset:26624
    v_mfma_f32_16x16x32_bf16 v[96:99], v[64:67], a[168:171], v[96:99]
    s_add_u32 s58, s8, 497664
    ds_read_b128 a[192:195], v15 offset:49152
    ds_read_b128 a[196:199], v15 offset:50176
    v_mfma_f32_16x16x32_bf16 v[100:103], v[64:67], a[172:175], v[100:103]
    s_waitcnt lgkmcnt(4)
    ds_read_b128 a[200:203], v15 offset:51200
    ds_read_b128 a[204:207], v15 offset:52224
    v_mfma_f32_16x16x32_bf16 v[88:91], v[68:71], a[176:179], v[88:91]
    buffer_load_dwordx4 v242, s[24:27], s58 offen lds
    v_mfma_f32_16x16x32_bf16 v[92:95], v[68:71], a[180:183], v[92:95]
    s_add_u32 m0, s61, 86016
    ds_read_b64_tr_b16 v[56:57], v240 offset:28672
    ds_read_b64_tr_b16 v[58:59], v240 offset:30720
    v_mfma_f32_16x16x32_bf16 v[96:99], v[68:71], a[184:187], v[96:99]
    s_add_u32 s58, s8, 589824
    ds_read_b128 a[208:211], v15 offset:53248
    ds_read_b128 a[212:215], v15 offset:54272
    v_mfma_f32_16x16x32_bf16 v[100:103], v[68:71], a[188:191], v[100:103]
    s_waitcnt lgkmcnt(4)
    ds_read_b128 a[216:219], v15 offset:55296
    ds_read_b128 a[220:223], v15 offset:56320
    v_mfma_f32_16x16x32_bf16 v[88:91], v[48:51], a[192:195], v[88:91]
    buffer_load_dwordx4 v8, s[24:27], s58 offen lds
    v_mfma_f32_16x16x32_bf16 v[92:95], v[48:51], a[196:199], v[92:95]
    s_add_u32 m0, s61, 24576
    ds_read_b64_tr_b16 v[60:61], v5 offset:8192
    ds_read_b64_tr_b16 v[62:63], v5 offset:10240
    v_mfma_f32_16x16x32_bf16 v[96:99], v[48:51], a[200:203], v[96:99]
    s_waitcnt vmcnt(13) lgkmcnt(12)
    s_barrier
    ds_read_b128 a[224:227], v15 offset:57344
    ds_read_b128 a[228:231], v15 offset:58368
    v_mfma_f32_16x16x32_bf16 v[100:103], v[48:51], a[204:207], v[100:103]
    s_waitcnt lgkmcnt(4)
    s_add_u32 s58, s8, 626688
    ds_read_b128 a[232:235], v15 offset:59392
    ds_read_b128 a[236:239], v15 offset:60416
    v_mfma_f32_16x16x32_bf16 v[88:91], v[52:55], a[208:211], v[88:91]
    buffer_load_dwordx4 v8, s[24:27], s58 offen lds
    v_mfma_f32_16x16x32_bf16 v[92:95], v[52:55], a[212:215], v[92:95]
    s_add_u32 m0, s61, 90112
    ds_read_b64_tr_b16 v[64:65], v5 offset:12288
    ds_read_b64_tr_b16 v[66:67], v5 offset:14336
    v_mfma_f32_16x16x32_bf16 v[96:99], v[52:55], a[216:219], v[96:99]
    s_add_u32 s58, s9, 0
    ds_read_b128 a[240:243], v15 offset:61440
    ds_read_b128 a[244:247], v15 offset:62464
    v_mfma_f32_16x16x32_bf16 v[100:103], v[52:55], a[220:223], v[100:103]
    s_waitcnt lgkmcnt(4)
    ds_read_b128 a[248:251], v15 offset:63488
    ds_read_b128 a[252:255], v15 offset:64512
    v_mfma_f32_16x16x32_bf16 v[88:91], v[56:59], a[224:227], v[88:91]
    buffer_load_dwordx4 v242, s[24:27], s58 offen lds
    v_mfma_f32_16x16x32_bf16 v[92:95], v[56:59], a[228:231], v[92:95]
    s_add_u32 m0, s61, 28672
    ds_read_b64_tr_b16 v[68:69], v5 offset:32768
    ds_read_b64_tr_b16 v[70:71], v5 offset:34816
    v_mfma_f32_16x16x32_bf16 v[96:99], v[56:59], a[232:235], v[96:99]
    s_add_u32 s58, s9, 18432
    ds_read_b128 v[16:19], v11 offset:0
    ds_read_b128 v[20:23], v11 offset:1024
    v_mfma_f32_16x16x32_bf16 v[100:103], v[56:59], a[236:239], v[100:103]
    s_waitcnt lgkmcnt(4)
    ds_read_b128 v[24:27], v11 offset:2048
    ds_read_b128 v[28:31], v11 offset:3072
    v_mfma_f32_16x16x32_bf16 v[88:91], v[60:63], a[240:243], v[88:91]
    buffer_load_dwordx4 v242, s[24:27], s58 offen lds
    v_mfma_f32_16x16x32_bf16 v[92:95], v[60:63], a[244:247], v[92:95]
    s_add_u32 m0, s61, 139264
    ds_read_b64_tr_b16 v[48:49], v5 offset:36864
    ds_read_b64_tr_b16 v[50:51], v5 offset:38912
    v_mfma_f32_16x16x32_bf16 v[96:99], v[60:63], a[248:251], v[96:99]
    s_add_u32 s58, s9, 36864
    ds_read_b128 v[32:35], v11 offset:4096
    ds_read_b128 v[36:39], v11 offset:5120
    v_mfma_f32_16x16x32_bf16 v[100:103], v[60:63], a[252:255], v[100:103]
    s_waitcnt lgkmcnt(4)
    ds_read_b128 v[40:43], v11 offset:6144
    ds_read_b128 v[44:47], v11 offset:7168
    v_mfma_f32_16x16x32_bf16 v[88:91], v[64:67], v[16:19], v[88:91]
    buffer_load_dwordx4 v242, s[24:27], s58 offen lds
    v_mfma_f32_16x16x32_bf16 v[92:95], v[64:67], v[20:23], v[92:95]
    s_add_u32 m0, s61, 32768
    ds_read_b64_tr_b16 v[52:53], v5 offset:40960
    ds_read_b64_tr_b16 v[54:55], v5 offset:43008
    v_mfma_f32_16x16x32_bf16 v[96:99], v[64:67], v[24:27], v[96:99]
    s_add_u32 s58, s9, 55296
    v_mov_b32 v145, 1
    v_mov_b32 v144, 1
    v_mfma_f32_16x16x32_bf16 v[100:103], v[64:67], v[28:31], v[100:103]
    s_waitcnt lgkmcnt(2)
    v_mfma_f32_16x16x32_bf16 v[88:91], v[68:71], v[32:35], v[88:91]
    buffer_load_dwordx4 v242, s[24:27], s58 offen lds
    v_mfma_f32_16x16x32_bf16 v[92:95], v[68:71], v[36:39], v[92:95]
    s_add_u32 m0, s61, 143360
    ds_read_b64_tr_b16 v[56:57], v5 offset:45056
    ds_read_b64_tr_b16 v[58:59], v5 offset:47104
    v_mfma_f32_16x16x32_bf16 v[96:99], v[68:71], v[40:43], v[96:99]
    s_add_u32 s58, s9, 147456
    s_add_u32 s56, s55, 65536
    v_mfma_f32_16x16x32_bf16 v[100:103], v[68:71], v[44:47], v[100:103]
    s_waitcnt lgkmcnt(2)
    v_mfma_f32_16x16x32_bf16 v[72:75], v[48:51], a[0:3], 0
    buffer_load_dwordx4 v242, s[24:27], s58 offen lds
    v_mfma_f32_16x16x32_bf16 v[72:75], v[52:55], a[16:19], v[72:75]
    s_add_u32 m0, s61, 36864
    ds_read_b64_tr_b16 v[60:61], v5 offset:49152
    ds_read_b64_tr_b16 v[62:63], v5 offset:51200
    v_mfma_f32_16x16x32_bf16 v[76:79], v[48:51], a[4:7], 0
    s_waitcnt vmcnt(13) lgkmcnt(4)
    s_barrier
    v_cvt_pk_bf16_f32 v104, v88, v89
    v_cvt_pk_bf16_f32 v105, v90, v91
    v_mfma_f32_16x16x32_bf16 v[76:79], v[52:55], a[20:23], v[76:79]
    s_add_u32 s58, s9, 165888
    v_cvt_pk_bf16_f32 v106, v92, v93
    v_cvt_pk_bf16_f32 v107, v94, v95
    v_mfma_f32_16x16x32_bf16 v[80:83], v[48:51], a[8:11], 0
    buffer_load_dwordx4 v242, s[24:27], s58 offen lds
    v_mfma_f32_16x16x32_bf16 v[80:83], v[52:55], a[24:27], v[80:83]
    s_add_u32 m0, s61, 147456
    ds_read_b64_tr_b16 v[64:65], v5 offset:53248
    ds_read_b64_tr_b16 v[66:67], v5 offset:55296
    v_mfma_f32_16x16x32_bf16 v[84:87], v[48:51], a[12:15], 0
    s_add_u32 s58, s9, 184320
    buffer_store_dwordx4 v[104:107], v243, s[28:31], s56 offen offset:0 sc1
    v_mfma_f32_16x16x32_bf16 v[84:87], v[52:55], a[28:31], v[84:87]
    s_waitcnt lgkmcnt(2)
    v_mfma_f32_16x16x32_bf16 v[72:75], v[56:59], a[32:35], v[72:75]
    buffer_load_dwordx4 v242, s[24:27], s58 offen lds
    v_mfma_f32_16x16x32_bf16 v[72:75], v[60:63], a[48:51], v[72:75]
    s_add_u32 m0, s61, 40960
    ds_read_b64_tr_b16 v[68:69], v4 offset:0
    ds_read_b64_tr_b16 v[70:71], v4 offset:2048
    v_mfma_f32_16x16x32_bf16 v[76:79], v[56:59], a[36:39], v[76:79]
    s_add_u32 s58, s9, 202752
    v_cvt_pk_bf16_f32 v108, v96, v97
    v_cvt_pk_bf16_f32 v109, v98, v99
    v_mfma_f32_16x16x32_bf16 v[76:79], v[60:63], a[52:55], v[76:79]
    v_cvt_pk_bf16_f32 v110, v100, v101
    v_cvt_pk_bf16_f32 v111, v102, v103
    v_mfma_f32_16x16x32_bf16 v[80:83], v[56:59], a[40:43], v[80:83]
    buffer_load_dwordx4 v242, s[24:27], s58 offen lds
    v_mfma_f32_16x16x32_bf16 v[80:83], v[60:63], a[56:59], v[80:83]
    s_add_u32 m0, s61, 94208
    ds_read_b64_tr_b16 v[48:49], v5 offset:57344
    ds_read_b64_tr_b16 v[50:51], v5 offset:59392
    v_mfma_f32_16x16x32_bf16 v[84:87], v[56:59], a[44:47], v[84:87]
    s_add_u32 s58, s9, 294912
    buffer_store_dwordx4 v[108:111], v243, s[28:31], s56 offen offset:1024 sc1
    v_mfma_f32_16x16x32_bf16 v[84:87], v[60:63], a[60:63], v[84:87]
    s_waitcnt lgkmcnt(2)
    v_mfma_f32_16x16x32_bf16 v[72:75], v[64:67], a[64:67], v[72:75]
    buffer_load_dwordx4 v242, s[24:27], s58 offen lds
    v_mfma_f32_16x16x32_bf16 v[72:75], v[68:71], a[80:83], v[72:75]
    s_add_u32 m0, s61, 45056
    ds_read_b64_tr_b16 v[52:53], v4 offset:4096
    ds_read_b64_tr_b16 v[54:55], v4 offset:6144
    v_mfma_f32_16x16x32_bf16 v[76:79], v[64:67], a[68:71], v[76:79]
    s_add_u32 s58, s9, 313344
    s_waitcnt vmcnt(33)
    v_lshlrev_b32 v212, 16, v236
    v_and_b32 v213, s49, v236
    v_mfma_f32_16x16x32_bf16 v[76:79], v[68:71], a[84:87], v[76:79]
    v_lshlrev_b32 v214, 16, v237
    v_and_b32 v215, s49, v237
    v_mfma_f32_16x16x32_bf16 v[80:83], v[64:67], a[72:75], v[80:83]
    buffer_load_dwordx4 v242, s[24:27], s58 offen lds
    v_mfma_f32_16x16x32_bf16 v[80:83], v[68:71], a[88:91], v[80:83]
    s_add_u32 m0, s61, 151552
    ds_read_b64_tr_b16 v[56:57], v5 offset:61440
    ds_read_b64_tr_b16 v[58:59], v5 offset:63488
    v_mfma_f32_16x16x32_bf16 v[84:87], v[64:67], a[76:79], v[84:87]
    s_add_u32 s58, s9, 331776
    v_lshlrev_b32 v216, 16, v238
    v_and_b32 v217, s49, v238
    v_mfma_f32_16x16x32_bf16 v[84:87], v[68:71], a[92:95], v[84:87]
    s_waitcnt lgkmcnt(2)
    v_lshlrev_b32 v218, 16, v239
    v_and_b32 v219, s49, v239
    v_mfma_f32_16x16x32_bf16 v[72:75], v[48:51], a[96:99], v[72:75]
    buffer_load_dwordx4 v242, s[24:27], s58 offen lds
    v_mfma_f32_16x16x32_bf16 v[72:75], v[52:55], a[112:115], v[72:75]
    s_add_u32 m0, s61, 49152
    ds_read_b64_tr_b16 v[60:61], v4 offset:8192
    ds_read_b64_tr_b16 v[62:63], v4 offset:10240
    v_mfma_f32_16x16x32_bf16 v[76:79], v[48:51], a[100:103], v[76:79]
    s_waitcnt vmcnt(15) lgkmcnt(4)
    s_barrier
    v_lshlrev_b32 v112, 16, v152
    v_and_b32 v113, s49, v152
    v_mfma_f32_16x16x32_bf16 v[76:79], v[52:55], a[116:119], v[76:79]
    s_add_u32 s58, s9, 350208
    v_add_f32 v112, v112, v212
    v_add_f32 v113, v113, v213
    v_mfma_f32_16x16x32_bf16 v[80:83], v[48:51], a[104:107], v[80:83]
    buffer_load_dwordx4 v242, s[24:27], s58 offen lds
    v_mfma_f32_16x16x32_bf16 v[80:83], v[52:55], a[120:123], v[80:83]
    s_add_u32 m0, s61, 155648
    ds_read_b64_tr_b16 v[64:65], v240 offset:0
    ds_read_b64_tr_b16 v[66:67], v240 offset:2048
    v_mfma_f32_16x16x32_bf16 v[84:87], v[48:51], a[108:111], v[84:87]
    s_add_u32 s58, s9, 442368
    s_lshl_b32 s68, s5, 8
    s_add_u32 s68, s68, s69
    v_mfma_f32_16x16x32_bf16 v[84:87], v[52:55], a[124:127], v[84:87]
    s_waitcnt lgkmcnt(2)
    v_lshlrev_b32 v114, 16, v153
    v_and_b32 v115, s49, v153
    v_mfma_f32_16x16x32_bf16 v[72:75], v[56:59], a[128:131], v[72:75]
    buffer_load_dwordx4 v242, s[24:27], s58 offen lds
    v_mfma_f32_16x16x32_bf16 v[72:75], v[60:63], a[144:147], v[72:75]
    s_add_u32 m0, s61, 53248
    ds_read_b64_tr_b16 v[68:69], v4 offset:12288
    ds_read_b64_tr_b16 v[70:71], v4 offset:14336
    v_mfma_f32_16x16x32_bf16 v[76:79], v[56:59], a[132:135], v[76:79]
    s_add_u32 s58, s9, 460800
    s_mov_b32 s62, 0xf0f0f0f0
    s_mov_b32 s63, s62
    v_mfma_f32_16x16x32_bf16 v[76:79], v[60:63], a[148:151], v[76:79]
    s_add_u32 s68, s68, 65536
    s_add_u32 s66, s68, 294912
    v_mfma_f32_16x16x32_bf16 v[80:83], v[56:59], a[136:139], v[80:83]
    buffer_load_dwordx4 v242, s[24:27], s58 offen lds
    v_mfma_f32_16x16x32_bf16 v[80:83], v[60:63], a[152:155], v[80:83]
    s_add_u32 m0, s61, 159744
    ds_read_b64_tr_b16 v[48:49], v240 offset:4096
    ds_read_b64_tr_b16 v[50:51], v240 offset:6144
    v_mfma_f32_16x16x32_bf16 v[84:87], v[56:59], a[140:143], v[84:87]
    s_add_u32 s58, s9, 479232
    v_add_f32 v114, v114, v214
    v_add_f32 v115, v115, v215
    v_mfma_f32_16x16x32_bf16 v[84:87], v[60:63], a[156:159], v[84:87]
    s_waitcnt lgkmcnt(2)
    v_lshlrev_b32 v116, 16, v154
    v_and_b32 v117, s49, v154
    v_mfma_f32_16x16x32_bf16 v[72:75], v[64:67], a[160:163], v[72:75]
    buffer_load_dwordx4 v242, s[24:27], s58 offen lds
    v_mfma_f32_16x16x32_bf16 v[72:75], v[68:71], a[176:179], v[72:75]
    s_add_u32 m0, s61, 57344
    ds_read_b64_tr_b16 v[52:53], v4 offset:16384
    ds_read_b64_tr_b16 v[54:55], v4 offset:18432
    v_mfma_f32_16x16x32_bf16 v[76:79], v[64:67], a[164:167], v[76:79]
    s_add_u32 s58, s9, 497664
    v_add_f32 v116, v116, v212
    v_add_f32 v117, v117, v213
    v_mfma_f32_16x16x32_bf16 v[76:79], v[68:71], a[180:183], v[76:79]
    v_lshlrev_b32 v118, 16, v155
    v_and_b32 v119, s49, v155
    v_mfma_f32_16x16x32_bf16 v[80:83], v[64:67], a[168:171], v[80:83]
    buffer_load_dwordx4 v242, s[24:27], s58 offen lds
    v_mfma_f32_16x16x32_bf16 v[80:83], v[68:71], a[184:187], v[80:83]
    s_add_u32 m0, s61, 61440
    ds_read_b64_tr_b16 v[56:57], v5 offset:16384
    ds_read_b64_tr_b16 v[58:59], v5 offset:18432
    v_mfma_f32_16x16x32_bf16 v[84:87], v[64:67], a[172:175], v[84:87]
    s_add_u32 s58, s9, 589824
    v_add_f32 v118, v118, v214
    v_add_f32 v119, v119, v215
    v_mfma_f32_16x16x32_bf16 v[84:87], v[68:71], a[188:191], v[84:87]
    s_waitcnt lgkmcnt(2)
    s_waitcnt vmcnt(8)
    s_mov_b64 exec, 1
    buffer_store_dword v145, off, s[28:31], s51 offset:0 sc1
    s_mov_b64 exec, -1
    v_mfma_f32_16x16x32_bf16 v[72:75], v[48:51], a[192:195], v[72:75]
    buffer_load_dwordx4 v8, s[24:27], s58 offen lds
    v_mfma_f32_16x16x32_bf16 v[72:75], v[52:55], a[208:211], v[72:75]
    s_add_u32 m0, s61, 73728
    ds_read_b64_tr_b16 v[60:61], v4 offset:20480
    ds_read_b64_tr_b16 v[62:63], v4 offset:22528
    v_mfma_f32_16x16x32_bf16 v[76:79], v[48:51], a[196:199], v[76:79]
    s_waitcnt vmcnt(16) lgkmcnt(4)
    s_barrier
    v_lshlrev_b32 v120, 16, v156
    v_and_b32 v121, s49, v156
    v_mfma_f32_16x16x32_bf16 v[76:79], v[52:55], a[212:215], v[76:79]
    s_add_u32 s58, s9, 626688
    v_add_f32 v120, v120, v212
    v_add_f32 v121, v121, v213
    v_mfma_f32_16x16x32_bf16 v[80:83], v[48:51], a[200:203], v[80:83]
    buffer_load_dwordx4 v8, s[24:27], s58 offen lds
    v_mfma_f32_16x16x32_bf16 v[80:83], v[52:55], a[216:219], v[80:83]
    s_add_u32 m0, s61, 65536
    ds_read_b64_tr_b16 v[64:65], v5 offset:20480
    ds_read_b64_tr_b16 v[66:67], v5 offset:22528
    v_mfma_f32_16x16x32_bf16 v[84:87], v[48:51], a[204:207], v[84:87]
    s_add_u32 s58, s10, 0
    v_lshlrev_b32 v122, 16, v157
    v_and_b32 v123, s49, v157
    v_mfma_f32_16x16x32_bf16 v[84:87], v[52:55], a[220:223], v[84:87]
    s_waitcnt lgkmcnt(2)
    v_add_f32 v122, v122, v214
    v_add_f32 v123, v123, v215
    v_mfma_f32_16x16x32_bf16 v[72:75], v[56:59], a[224:227], v[72:75]
    buffer_load_dwordx4 v242, s[24:27], s58 offen lds
    v_mfma_f32_16x16x32_bf16 v[72:75], v[60:63], a[240:243], v[72:75]
    s_add_u32 m0, s61, 77824
    ds_read_b64_tr_b16 v[68:69], v4 offset:24576
    ds_read_b64_tr_b16 v[70:71], v4 offset:26624
    v_mfma_f32_16x16x32_bf16 v[76:79], v[56:59], a[228:231], v[76:79]
    s_add_u32 s58, s10, 18432
    v_lshlrev_b32 v124, 16, v158
    v_and_b32 v125, s49, v158
    v_mfma_f32_16x16x32_bf16 v[76:79], v[60:63], a[244:247], v[76:79]
    v_add_f32 v124, v124, v212
    v_add_f32 v125, v125, v213
    v_mfma_f32_16x16x32_bf16 v[80:83], v[56:59], a[232:235], v[80:83]
    buffer_load_dwordx4 v242, s[24:27], s58 offen lds
    v_mfma_f32_16x16x32_bf16 v[80:83], v[60:63], a[248:251], v[80:83]
    s_add_u32 m0, s61, 69632
    ds_read_b64_tr_b16 v[48:49], v5 offset:24576
    ds_read_b64_tr_b16 v[50:51], v5 offset:26624
    v_mfma_f32_16x16x32_bf16 v[84:87], v[56:59], a[236:239], v[84:87]
    s_add_u32 s58, s10, 36864
    v_lshlrev_b32 v126, 16, v159
    v_and_b32 v127, s49, v159
    v_mfma_f32_16x16x32_bf16 v[84:87], v[60:63], a[252:255], v[84:87]
    s_waitcnt lgkmcnt(2)
    v_add_f32 v126, v126, v214
    v_add_f32 v127, v127, v215
    v_mfma_f32_16x16x32_bf16 v[72:75], v[64:67], v[16:19], v[72:75]
    buffer_load_dwordx4 v242, s[24:27], s58 offen lds
    v_mfma_f32_16x16x32_bf16 v[72:75], v[68:71], v[32:35], v[72:75]
    s_add_u32 m0, s61, 98304
    ds_read_b64_tr_b16 v[52:53], v4 offset:28672
    ds_read_b64_tr_b16 v[54:55], v4 offset:30720
    v_mfma_f32_16x16x32_bf16 v[76:79], v[64:67], v[20:23], v[76:79]
    s_add_u32 s58, s10, 55296
    v_lshlrev_b32 v152, 16, v160
    v_and_b32 v153, s49, v160
    v_mfma_f32_16x16x32_bf16 v[76:79], v[68:71], v[36:39], v[76:79]
    v_add_f32 v152, v152, v216
    v_add_f32 v153, v153, v217
    v_mfma_f32_16x16x32_bf16 v[80:83], v[64:67], v[24:27], v[80:83]
    buffer_load_dwordx4 v242, s[24:27], s58 offen lds
    v_mfma_f32_16x16x32_bf16 v[80:83], v[68:71], v[40:43], v[80:83]
    s_add_u32 m0, s61, 102400
    ds_read_b64_tr_b16 v[56:57], v240 offset:8192
    ds_read_b64_tr_b16 v[58:59], v240 offset:10240
    v_mfma_f32_16x16x32_bf16 v[84:87], v[64:67], v[28:31], v[84:87]
    s_add_u32 s58, s10, 147456
    s_sub_u32 s56, s8, s57
    s_lshl_b32 s56, s56, 6
    s_add_u32 s56, s56, s55
    v_mfma_f32_16x16x32_bf16 v[84:87], v[68:71], v[44:47], v[84:87]
    s_waitcnt lgkmcnt(2)
    v_lshlrev_b32 v154, 16, v161
    v_and_b32 v155, s49, v161
    v_mfma_f32_16x16x32_bf16 v[88:91], v[48:51], a[0:3], 0
    buffer_load_dwordx4 v242, s[24:27], s58 offen lds
    v_mfma_f32_16x16x32_bf16 v[88:91], v[52:55], a[16:19], v[88:91]
    s_add_u32 m0, s61, 106496
    ds_read_b64_tr_b16 v[60:61], v4 offset:32768
    ds_read_b64_tr_b16 v[62:63], v4 offset:34816
    v_mfma_f32_16x16x32_bf16 v[92:95], v[48:51], a[4:7], 0
    s_waitcnt vmcnt(14) lgkmcnt(4)
    s_barrier
    v_cvt_pk_bf16_f32 v104, v72, v73
    v_cvt_pk_bf16_f32 v105, v74, v75
    v_mfma_f32_16x16x32_bf16 v[92:95], v[52:55], a[20:23], v[92:95]
    s_add_u32 s58, s10, 165888
    v_cvt_pk_bf16_f32 v106, v76, v77
    v_cvt_pk_bf16_f32 v107, v78, v79
    v_mfma_f32_16x16x32_bf16 v[96:99], v[48:51], a[8:11], 0
    buffer_load_dwordx4 v242, s[24:27], s58 offen lds
    v_mfma_f32_16x16x32_bf16 v[96:99], v[52:55], a[24:27], v[96:99]
    s_add_u32 m0, s61, 110592
    ds_read_b64_tr_b16 v[64:65], v240 offset:12288
    ds_read_b64_tr_b16 v[66:67], v240 offset:14336
    v_mfma_f32_16x16x32_bf16 v[100:103], v[48:51], a[12:15], 0
    s_add_u32 s58, s10, 184320
    buffer_store_dwordx4 v[104:107], v15, s[28:31], s56 offen offset:0 sc1
    v_mfma_f32_16x16x32_bf16 v[100:103], v[52:55], a[28:31], v[100:103]
    s_waitcnt lgkmcnt(2)
    v_add_f32 v154, v154, v218
    v_add_f32 v155, v155, v219
    v_mfma_f32_16x16x32_bf16 v[88:91], v[56:59], a[32:35], v[88:91]
    buffer_load_dwordx4 v242, s[24:27], s58 offen lds
    v_mfma_f32_16x16x32_bf16 v[88:91], v[60:63], a[48:51], v[88:91]
    s_add_u32 m0, s61, 114688
    ds_read_b64_tr_b16 v[68:69], v4 offset:36864
    ds_read_b64_tr_b16 v[70:71], v4 offset:38912
    v_mfma_f32_16x16x32_bf16 v[92:95], v[56:59], a[36:39], v[92:95]
    s_add_u32 s58, s10, 202752
    v_cvt_pk_bf16_f32 v108, v80, v81
    v_cvt_pk_bf16_f32 v109, v82, v83
    v_mfma_f32_16x16x32_bf16 v[92:95], v[60:63], a[52:55], v[92:95]
    v_cvt_pk_bf16_f32 v110, v84, v85
    v_cvt_pk_bf16_f32 v111, v86, v87
    v_mfma_f32_16x16x32_bf16 v[96:99], v[56:59], a[40:43], v[96:99]
    buffer_load_dwordx4 v242, s[24:27], s58 offen lds
    v_mfma_f32_16x16x32_bf16 v[96:99], v[60:63], a[56:59], v[96:99]
    s_add_u32 m0, s61, 118784
    ds_read_b64_tr_b16 v[48:49], v240 offset:16384
    ds_read_b64_tr_b16 v[50:51], v240 offset:18432
    v_mfma_f32_16x16x32_bf16 v[100:103], v[56:59], a[44:47], v[100:103]
    s_add_u32 s58, s10, 294912
    buffer_store_dwordx4 v[108:111], v15, s[28:31], s56 offen offset:1024 sc1
    v_mfma_f32_16x16x32_bf16 v[100:103], v[60:63], a[60:63], v[100:103]
    s_waitcnt lgkmcnt(2)
    v_mfma_f32_16x16x32_bf16 v[88:91], v[64:67], a[64:67], v[88:91]
    buffer_load_dwordx4 v242, s[24:27], s58 offen lds
    v_mfma_f32_16x16x32_bf16 v[88:91], v[68:71], a[80:83], v[88:91]
    s_add_u32 m0, s61, 0
    ds_read_b64_tr_b16 v[52:53], v4 offset:40960
    ds_read_b64_tr_b16 v[54:55], v4 offset:43008
    v_mfma_f32_16x16x32_bf16 v[92:95], v[64:67], a[68:71], v[92:95]
    s_add_u32 s58, s10, 313344
    v_mfma_f32_16x16x32_bf16 v[92:95], v[68:71], a[84:87], v[92:95]
    v_mfma_f32_16x16x32_bf16 v[96:99], v[64:67], a[72:75], v[96:99]
    buffer_load_dwordx4 v242, s[24:27], s58 offen lds
    v_mfma_f32_16x16x32_bf16 v[96:99], v[68:71], a[88:91], v[96:99]
    s_add_u32 m0, s61, 122880
    ds_read_b64_tr_b16 v[56:57], v5 offset:28672
    ds_read_b64_tr_b16 v[58:59], v5 offset:30720
    v_mfma_f32_16x16x32_bf16 v[100:103], v[64:67], a[76:79], v[100:103]
    s_add_u32 s58, s10, 331776
    v_mfma_f32_16x16x32_bf16 v[100:103], v[68:71], a[92:95], v[100:103]
    s_waitcnt lgkmcnt(2)
    v_mfma_f32_16x16x32_bf16 v[88:91], v[48:51], a[96:99], v[88:91]
    buffer_load_dwordx4 v242, s[24:27], s58 offen lds
    v_mfma_f32_16x16x32_bf16 v[88:91], v[52:55], a[112:115], v[88:91]
    s_add_u32 m0, s61, 4096
    ds_read_b64_tr_b16 v[60:61], v4 offset:45056
    ds_read_b64_tr_b16 v[62:63], v4 offset:47104
    v_mfma_f32_16x16x32_bf16 v[92:95], v[48:51], a[100:103], v[92:95]
    s_waitcnt vmcnt(16) lgkmcnt(4)
    s_barrier
    v_mfma_f32_16x16x32_bf16 v[92:95], v[52:55], a[116:119], v[92:95]
    s_add_u32 s58, s10, 350208
    v_mfma_f32_16x16x32_bf16 v[96:99], v[48:51], a[104:107], v[96:99]
    buffer_load_dwordx4 v242, s[24:27], s58 offen lds
    v_mfma_f32_16x16x32_bf16 v[96:99], v[52:55], a[120:123], v[96:99]
    s_add_u32 m0, s61, 126976
    ds_read_b64_tr_b16 v[64:65], v240 offset:20480
    ds_read_b64_tr_b16 v[66:67], v240 offset:22528
    v_mfma_f32_16x16x32_bf16 v[100:103], v[48:51], a[108:111], v[100:103]
    s_add_u32 s58, s10, 442368
    v_mfma_f32_16x16x32_bf16 v[100:103], v[52:55], a[124:127], v[100:103]
    s_waitcnt lgkmcnt(2)
    s_mov_b64 exec, 255
    buffer_load_dword v144, v245, s[28:31], s70 offen offset:0 sc1
    s_mov_b64 exec, -1
    v_mfma_f32_16x16x32_bf16 v[88:91], v[56:59], a[128:131], v[88:91]
    buffer_load_dwordx4 v242, s[24:27], s58 offen lds
    v_mfma_f32_16x16x32_bf16 v[88:91], v[60:63], a[144:147], v[88:91]
    s_add_u32 m0, s61, 8192
    ds_read_b64_tr_b16 v[68:69], v4 offset:49152
    ds_read_b64_tr_b16 v[70:71], v4 offset:51200
    v_mfma_f32_16x16x32_bf16 v[92:95], v[56:59], a[132:135], v[92:95]
    s_add_u32 s58, s10, 460800
    v_mfma_f32_16x16x32_bf16 v[92:95], v[60:63], a[148:151], v[92:95]
    v_mfma_f32_16x16x32_bf16 v[96:99], v[56:59], a[136:139], v[96:99]
    buffer_load_dwordx4 v242, s[24:27], s58 offen lds
    v_mfma_f32_16x16x32_bf16 v[96:99], v[60:63], a[152:155], v[96:99]
    s_add_u32 m0, s61, 131072
    ds_read_b64_tr_b16 v[48:49], v240 offset:24576
    ds_read_b64_tr_b16 v[50:51], v240 offset:26624
    v_mfma_f32_16x16x32_bf16 v[100:103], v[56:59], a[140:143], v[100:103]
    s_add_u32 s58, s10, 479232
    v_mfma_f32_16x16x32_bf16 v[100:103], v[60:63], a[156:159], v[100:103]
    s_waitcnt lgkmcnt(2)
    v_mfma_f32_16x16x32_bf16 v[88:91], v[64:67], a[160:163], v[88:91]
    buffer_load_dwordx4 v242, s[24:27], s58 offen lds
    v_mfma_f32_16x16x32_bf16 v[88:91], v[68:71], a[176:179], v[88:91]
    s_add_u32 m0, s61, 12288
    ds_read_b64_tr_b16 v[52:53], v4 offset:53248
    ds_read_b64_tr_b16 v[54:55], v4 offset:55296
    v_mfma_f32_16x16x32_bf16 v[92:95], v[64:67], a[164:167], v[92:95]
    s_add_u32 s58, s10, 497664
    v_mfma_f32_16x16x32_bf16 v[92:95], v[68:71], a[180:183], v[92:95]
    v_mfma_f32_16x16x32_bf16 v[96:99], v[64:67], a[168:171], v[96:99]
    buffer_load_dwordx4 v242, s[24:27], s58 offen lds
    v_mfma_f32_16x16x32_bf16 v[96:99], v[68:71], a[184:187], v[96:99]
    s_add_u32 m0, s61, 135168
    ds_read_b64_tr_b16 v[56:57], v240 offset:28672
    ds_read_b64_tr_b16 v[58:59], v240 offset:30720
    v_mfma_f32_16x16x32_bf16 v[100:103], v[64:67], a[172:175], v[100:103]
    s_add_u32 s58, s10, 589824
    v_mfma_f32_16x16x32_bf16 v[100:103], v[68:71], a[188:191], v[100:103]
    s_waitcnt lgkmcnt(2)
    s_waitcnt vmcnt(9)
    s_mov_b64 exec, 1
    buffer_store_dword v145, off, s[28:31], s51 offset:128 sc1
    s_mov_b64 exec, -1
    v_mfma_f32_16x16x32_bf16 v[88:91], v[48:51], a[192:195], v[88:91]
    buffer_load_dwordx4 v8, s[24:27], s58 offen lds
    v_mfma_f32_16x16x32_bf16 v[88:91], v[52:55], a[208:211], v[88:91]
    s_add_u32 m0, s61, 16384
    ds_read_b64_tr_b16 v[60:61], v4 offset:57344
    ds_read_b64_tr_b16 v[62:63], v4 offset:59392
    v_mfma_f32_16x16x32_bf16 v[92:95], v[48:51], a[196:199], v[92:95]
    s_waitcnt vmcnt(17) lgkmcnt(4)
    s_barrier
    v_mfma_f32_16x16x32_bf16 v[92:95], v[52:55], a[212:215], v[92:95]
    s_add_u32 s58, s10, 626688
    v_mfma_f32_16x16x32_bf16 v[96:99], v[48:51], a[200:203], v[96:99]
    buffer_load_dwordx4 v8, s[24:27], s58 offen lds
    v_mfma_f32_16x16x32_bf16 v[96:99], v[52:55], a[216:219], v[96:99]
    s_add_u32 m0, s61, 81920
    ds_read_b64_tr_b16 v[64:65], v4 offset:61440
    ds_read_b64_tr_b16 v[66:67], v4 offset:63488
    v_mfma_f32_16x16x32_bf16 v[100:103], v[48:51], a[204:207], v[100:103]
    s_add_u32 s58, s11, 0
    v_mfma_f32_16x16x32_bf16 v[100:103], v[52:55], a[220:223], v[100:103]
    s_waitcnt lgkmcnt(2)
    v_mfma_f32_16x16x32_bf16 v[88:91], v[56:59], a[224:227], v[88:91]
    buffer_load_dwordx4 v242, s[24:27], s58 offen lds
    v_mfma_f32_16x16x32_bf16 v[88:91], v[60:63], a[240:243], v[88:91]
    s_add_u32 m0, s61, 20480
    ds_read_b64_tr_b16 v[68:69], v5 offset:8192
    ds_read_b64_tr_b16 v[70:71], v5 offset:10240
    v_mfma_f32_16x16x32_bf16 v[92:95], v[56:59], a[228:231], v[92:95]
    s_add_u32 s58, s11, 18432
    s_waitcnt vmcnt(8)
    v_cmp_eq_u32 vcc, 0, v144
    v_mfma_f32_16x16x32_bf16 v[92:95], v[60:63], a[244:247], v[92:95]
    s_cbranch_vccnz L_gslow_11
    L_gback_12:
    v_mfma_f32_16x16x32_bf16 v[96:99], v[56:59], a[232:235], v[96:99]
    buffer_load_dwordx4 v242, s[24:27], s58 offen lds
    v_mfma_f32_16x16x32_bf16 v[96:99], v[60:63], a[248:251], v[96:99]
    s_add_u32 m0, s61, 86016
    ds_read_b64_tr_b16 v[48:49], v5 offset:0
    ds_read_b64_tr_b16 v[50:51], v5 offset:2048
    v_mfma_f32_16x16x32_bf16 v[100:103], v[56:59], a[236:239], v[100:103]
    s_add_u32 s58, s11, 36864
    buffer_load_dwordx4 v[220:223], v244, s[28:31], s68 offen sc1
    v_mfma_f32_16x16x32_bf16 v[100:103], v[60:63], a[252:255], v[100:103]
    s_waitcnt lgkmcnt(2)
    v_mfma_f32_16x16x32_bf16 v[88:91], v[64:67], v[16:19], v[88:91]
    buffer_load_dwordx4 v242, s[24:27], s58 offen lds
    v_mfma_f32_16x16x32_bf16 v[88:91], v[68:71], v[32:35], v[88:91]
    s_add_u32 m0, s61, 24576
    ds_read_b64_tr_b16 v[52:53], v5 offset:12288
    ds_read_b64_tr_b16 v[54:55], v5 offset:14336
    v_mfma_f32_16x16x32_bf16 v[92:95], v[64:67], v[20:23], v[92:95]
    s_add_u32 s58, s11, 55296
    v_mfma_f32_16x16x32_bf16 v[92:95], v[68:71], v[36:39], v[92:95]
    v_mfma_f32_16x16x32_bf16 v[96:99], v[64:67], v[24:27], v[96:99]
    buffer_load_dwordx4 v242, s[24:27], s58 offen lds
    v_mfma_f32_16x16x32_bf16 v[96:99], v[68:71], v[40:43], v[96:99]
    s_add_u32 m0, s61, 90112
    ds_read_b64_tr_b16 v[56:57], v5 offset:4096
    ds_read_b64_tr_b16 v[58:59], v5 offset:6144
    v_mfma_f32_16x16x32_bf16 v[100:103], v[64:67], v[28:31], v[100:103]
    s_add_u32 s58, s11, 147456
    s_sub_u32 s56, s9, s57
    s_lshl_b32 s56, s56, 6
    s_add_u32 s56, s56, s55
    v_mfma_f32_16x16x32_bf16 v[100:103], v[68:71], v[44:47], v[100:103]
    s_waitcnt lgkmcnt(2)
    v_mfma_f32_16x16x32_bf16 v[72:75], v[48:51], a[0:3], 0
    buffer_load_dwordx4 v242, s[24:27], s58 offen lds
    v_mfma_f32_16x16x32_bf16 v[72:75], v[52:55], a[16:19], v[72:75]
    s_add_u32 m0, s61, 28672
    ds_read_b64_tr_b16 v[60:61], v5 offset:32768
    ds_read_b64_tr_b16 v[62:63], v5 offset:34816
    v_mfma_f32_16x16x32_bf16 v[76:79], v[48:51], a[4:7], 0
    s_waitcnt vmcnt(16) lgkmcnt(4)
    s_barrier
    v_cvt_pk_bf16_f32 v104, v88, v89
    v_cvt_pk_bf16_f32 v105, v90, v91
    v_mfma_f32_16x16x32_bf16 v[76:79], v[52:55], a[20:23], v[76:79]
    s_add_u32 s58, s11, 165888
    v_cvt_pk_bf16_f32 v106, v92, v93
    v_cvt_pk_bf16_f32 v107, v94, v95
    v_mfma_f32_16x16x32_bf16 v[80:83], v[48:51], a[8:11], 0
    buffer_load_dwordx4 v242, s[24:27], s58 offen lds
    v_mfma_f32_16x16x32_bf16 v[80:83], v[52:55], a[24:27], v[80:83]
    s_add_u32 m0, s61, 139264
    ds_read_b64_tr_b16 v[64:65], v5 offset:36864
    ds_read_b64_tr_b16 v[66:67], v5 offset:38912
    v_mfma_f32_16x16x32_bf16 v[84:87], v[48:51], a[12:15], 0
    s_add_u32 s58, s11, 184320
    buffer_store_dwordx4 v[104:107], v15, s[28:31], s56 offen offset:0 sc1
    v_mfma_f32_16x16x32_bf16 v[84:87], v[52:55], a[28:31], v[84:87]
    s_waitcnt lgkmcnt(2)
    v_mfma_f32_16x16x32_bf16 v[72:75], v[56:59], a[32:35], v[72:75]
    buffer_load_dwordx4 v242, s[24:27], s58 offen lds
    v_mfma_f32_16x16x32_bf16 v[72:75], v[60:63], a[48:51], v[72:75]
    s_add_u32 m0, s61, 32768
    ds_read_b64_tr_b16 v[68:69], v5 offset:40960
    ds_read_b64_tr_b16 v[70:71], v5 offset:43008
    v_mfma_f32_16x16x32_bf16 v[76:79], v[56:59], a[36:39], v[76:79]
    s_add_u32 s58, s11, 202752
    buffer_load_dwordx4 v[224:227], v244, s[28:31], s66 offen sc1
    v_cvt_pk_bf16_f32 v108, v96, v97
    v_cvt_pk_bf16_f32 v109, v98, v99
    v_mfma_f32_16x16x32_bf16 v[76:79], v[60:63], a[52:55], v[76:79]
    v_cvt_pk_bf16_f32 v110, v100, v101
    v_cvt_pk_bf16_f32 v111, v102, v103
    v_mfma_f32_16x16x32_bf16 v[80:83], v[56:59], a[40:43], v[80:83]
    buffer_load_dwordx4 v242, s[24:27], s58 offen lds
    v_mfma_f32_16x16x32_bf16 v[80:83], v[60:63], a[56:59], v[80:83]
    s_add_u32 m0, s61, 143360
    ds_read_b64_tr_b16 v[48:49], v5 offset:45056
    ds_read_b64_tr_b16 v[50:51], v5 offset:47104
    v_mfma_f32_16x16x32_bf16 v[84:87], v[56:59], a[44:47], v[84:87]
    s_add_u32 s58, s11, 294912
    buffer_store_dwordx4 v[108:111], v15, s[28:31], s56 offen offset:1024 sc1
    v_mfma_f32_16x16x32_bf16 v[84:87], v[60:63], a[60:63], v[84:87]
    s_waitcnt lgkmcnt(2)
    v_mfma_f32_16x16x32_bf16 v[72:75], v[64:67], a[64:67], v[72:75]
    buffer_load_dwordx4 v242, s[24:27], s58 offen lds
    v_mfma_f32_16x16x32_bf16 v[72:75], v[68:71], a[80:83], v[72:75]
    s_add_u32 m0, s61, 36864
    ds_read_b64_tr_b16 v[52:53], v5 offset:49152
    ds_read_b64_tr_b16 v[54:55], v5 offset:51200
    v_mfma_f32_16x16x32_bf16 v[76:79], v[64:67], a[68:71], v[76:79]
    s_add_u32 s58, s11, 313344
    v_mfma_f32_16x16x32_bf16 v[76:79], v[68:71], a[84:87], v[76:79]
    v_mfma_f32_16x16x32_bf16 v[80:83], v[64:67], a[72:75], v[80:83]
    buffer_load_dwordx4 v242, s[24:27], s58 offen lds
    v_mfma_f32_16x16x32_bf16 v[80:83], v[68:71], a[88:91], v[80:83]
    s_add_u32 m0, s61, 147456
    ds_read_b64_tr_b16 v[56:57], v5 offset:53248
    ds_read_b64_tr_b16 v[58:59], v5 offset:55296
    v_mfma_f32_16x16x32_bf16 v[84:87], v[64:67], a[76:79], v[84:87]
    s_add_u32 s58, s11, 331776
    v_mfma_f32_16x16x32_bf16 v[84:87], v[68:71], a[92:95], v[84:87]
    s_waitcnt lgkmcnt(2)
    v_mfma_f32_16x16x32_bf16 v[72:75], v[48:51], a[96:99], v[72:75]
    buffer_load_dwordx4 v242, s[24:27], s58 offen lds
    v_mfma_f32_16x16x32_bf16 v[72:75], v[52:55], a[112:115], v[72:75]
    s_add_u32 m0, s61, 40960
    ds_read_b64_tr_b16 v[60:61], v4 offset:0
    ds_read_b64_tr_b16 v[62:63], v4 offset:2048
    v_mfma_f32_16x16x32_bf16 v[76:79], v[48:51], a[100:103], v[76:79]
    s_waitcnt vmcnt(18) lgkmcnt(4)
    s_barrier
    v_mfma_f32_16x16x32_bf16 v[76:79], v[52:55], a[116:119], v[76:79]
    s_add_u32 s58, s11, 350208
    v_mfma_f32_16x16x32_bf16 v[80:83], v[48:51], a[104:107], v[80:83]
    buffer_load_dwordx4 v242, s[24:27], s58 offen lds
    v_mfma_f32_16x16x32_bf16 v[80:83], v[52:55], a[120:123], v[80:83]
    s_add_u32 m0, s61, 94208
    ds_read_b64_tr_b16 v[64:65], v5 offset:57344
    ds_read_b64_tr_b16 v[66:67], v5 offset:59392
    v_mfma_f32_16x16x32_bf16 v[84:87], v[48:51], a[108:111], v[84:87]
    s_add_u32 s58, s11, 442368
    v_mfma_f32_16x16x32_bf16 v[84:87], v[52:55], a[124:127], v[84:87]
    s_waitcnt lgkmcnt(2)
    s_mov_b64 exec, 2
    buffer_load_dword v144, v245, s[28:31], s70 offen offset:128 sc1
    s_mov_b64 exec, -1
    v_mfma_f32_16x16x32_bf16 v[72:75], v[56:59], a[128:131], v[72:75]
    buffer_load_dwordx4 v242, s[24:27], s58 offen lds
    v_mfma_f32_16x16x32_bf16 v[72:75], v[60:63], a[144:147], v[72:75]
    s_add_u32 m0, s61, 45056
    ds_read_b64_tr_b16 v[68:69], v4 offset:4096
    ds_read_b64_tr_b16 v[70:71], v4 offset:6144
    v_mfma_f32_16x16x32_bf16 v[76:79], v[56:59], a[132:135], v[76:79]
    s_add_u32 s58, s11, 460800
    v_mfma_f32_16x16x32_bf16 v[76:79], v[60:63], a[148:151], v[76:79]
    v_mfma_f32_16x16x32_bf16 v[80:83], v[56:59], a[136:139], v[80:83]
    buffer_load_dwordx4 v242, s[24:27], s58 offen lds
    v_mfma_f32_16x16x32_bf16 v[80:83], v[60:63], a[152:155], v[80:83]
    s_add_u32 m0, s61, 151552
    ds_read_b64_tr_b16 v[48:49], v5 offset:61440
    ds_read_b64_tr_b16 v[50:51], v5 offset:63488
    v_mfma_f32_16x16x32_bf16 v[84:87], v[56:59], a[140:143], v[84:87]
    s_add_u32 s58, s11, 479232
    v_mfma_f32_16x16x32_bf16 v[84:87], v[60:63], a[156:159], v[84:87]
    s_waitcnt lgkmcnt(2)
    v_mfma_f32_16x16x32_bf16 v[72:75], v[64:67], a[160:163], v[72:75]
    buffer_load_dwordx4 v242, s[24:27], s58 offen lds
    v_mfma_f32_16x16x32_bf16 v[72:75], v[68:71], a[176:179], v[72:75]
    s_add_u32 m0, s61, 49152
    ds_read_b64_tr_b16 v[52:53], v4 offset:8192
    ds_read_b64_tr_b16 v[54:55], v4 offset:10240
    v_mfma_f32_16x16x32_bf16 v[76:79], v[64:67], a[164:167], v[76:79]
    s_add_u32 s58, s11, 497664
    v_mfma_f32_16x16x32_bf16 v[76:79], v[68:71], a[180:183], v[76:79]
    v_mfma_f32_16x16x32_bf16 v[80:83], v[64:67], a[168:171], v[80:83]
    buffer_load_dwordx4 v242, s[24:27], s58 offen lds
    v_mfma_f32_16x16x32_bf16 v[80:83], v[68:71], a[184:187], v[80:83]
    s_add_u32 m0, s61, 155648
    ds_read_b64_tr_b16 v[56:57], v240 offset:0
    ds_read_b64_tr_b16 v[58:59], v240 offset:2048
    v_mfma_f32_16x16x32_bf16 v[84:87], v[64:67], a[172:175], v[84:87]
    s_add_u32 s58, s11, 589824
    s_waitcnt vmcnt(11)
    v_lshlrev_b32 v228, 16, v220
    v_and_b32 v229, s49, v220
    v_mfma_f32_16x16x32_bf16 v[84:87], v[68:71], a[188:191], v[84:87]
    s_waitcnt lgkmcnt(2)
    s_waitcnt vmcnt(9)
    s_mov_b64 exec, 1
    buffer_store_dword v145, off, s[28:31], s51 offset:256 sc1
    s_mov_b64 exec, -1
    v_mfma_f32_16x16x32_bf16 v[72:75], v[48:51], a[192:195], v[72:75]
    buffer_load_dwordx4 v8, s[24:27], s58 offen lds
    v_mfma_f32_16x16x32_bf16 v[72:75], v[52:55], a[208:211], v[72:75]
    s_add_u32 m0, s61, 53248
    ds_read_b64_tr_b16 v[60:61], v4 offset:12288
    ds_read_b64_tr_b16 v[62:63], v4 offset:14336
    v_mfma_f32_16x16x32_bf16 v[76:79], v[48:51], a[196:199], v[76:79]
    s_waitcnt vmcnt(18) lgkmcnt(4)
    s_barrier
    v_lshlrev_b32 v230, 16, v221
    v_and_b32 v231, s49, v221
    v_mfma_f32_16x16x32_bf16 v[76:79], v[52:55], a[212:215], v[76:79]
    s_add_u32 s58, s11, 626688
    v_lshlrev_b32 v232, 16, v222
    v_and_b32 v233, s49, v222
    v_mfma_f32_16x16x32_bf16 v[80:83], v[48:51], a[200:203], v[80:83]
    buffer_load_dwordx4 v8, s[24:27], s58 offen lds
    v_mfma_f32_16x16x32_bf16 v[80:83], v[52:55], a[216:219], v[80:83]
    s_add_u32 m0, s61, 159744
    ds_read_b64_tr_b16 v[64:65], v240 offset:4096
    ds_read_b64_tr_b16 v[66:67], v240 offset:6144
    v_mfma_f32_16x16x32_bf16 v[84:87], v[48:51], a[204:207], v[84:87]
    s_add_u32 s58, s12, 0
    v_lshlrev_b32 v234, 16, v223
    v_and_b32 v235, s49, v223
    v_mfma_f32_16x16x32_bf16 v[84:87], v[52:55], a[220:223], v[84:87]
    s_waitcnt lgkmcnt(2)
    v_lshlrev_b32 v146, 16, v224
    v_and_b32 v147, s49, v224
    v_mfma_f32_16x16x32_bf16 v[72:75], v[56:59], a[224:227], v[72:75]
    buffer_load_dwordx4 v242, s[24:27], s58 offen lds
    v_mfma_f32_16x16x32_bf16 v[72:75], v[60:63], a[240:243], v[72:75]
    s_add_u32 m0, s61, 57344
    ds_read_b64_tr_b16 v[68:69], v4 offset:16384
    ds_read_b64_tr_b16 v[70:71], v4 offset:18432
    s_sub_u32 s67, s5, 1
    s_and_b32 s67, s67, 7
    v_mfma_f32_16x16x32_bf16 v[76:79], v[56:59], a[228:231], v[76:79]
    s_add_u32 s58, s12, 18432
    s_waitcnt vmcnt(8)
    v_cmp_eq_u32 vcc, 0, v144
    v_mfma_f32_16x16x32_bf16 v[76:79], v[60:63], a[244:247], v[76:79]
    s_cbranch_vccnz L_gslow_13
    L_gback_14:
    v_mfma_f32_16x16x32_bf16 v[80:83], v[56:59], a[232:235], v[80:83]
    buffer_load_dwordx4 v242, s[24:27], s58 offen lds
    v_mfma_f32_16x16x32_bf16 v[80:83], v[60:63], a[248:251], v[80:83]
    s_add_u32 m0, s61, 61440
    ds_read_b64_tr_b16 v[48:49], v5 offset:16384
    ds_read_b64_tr_b16 v[50:51], v5 offset:18432
    s_mul_i32 s67, s67, 73728
    s_add_u32 s67, s67, s59
    v_mfma_f32_16x16x32_bf16 v[84:87], v[56:59], a[236:239], v[84:87]
    s_add_u32 s58, s12, 36864
    buffer_load_dwordx4 v[164:167], v15, s[28:31], s67 offen offset:0 sc1
    v_mfma_f32_16x16x32_bf16 v[84:87], v[60:63], a[252:255], v[84:87]
    s_waitcnt lgkmcnt(2)
    v_add_f32 v228, v228, v146
    v_add_f32 v229, v229, v147
    v_mfma_f32_16x16x32_bf16 v[72:75], v[64:67], v[16:19], v[72:75]
    buffer_load_dwordx4 v242, s[24:27], s58 offen lds
    v_mfma_f32_16x16x32_bf16 v[72:75], v[68:71], v[32:35], v[72:75]
    s_add_u32 m0, s61, 73728
    ds_read_b64_tr_b16 v[52:53], v4 offset:20480
    ds_read_b64_tr_b16 v[54:55], v4 offset:22528
    v_mfma_f32_16x16x32_bf16 v[76:79], v[64:67], v[20:23], v[76:79]
    s_add_u32 s58, s12, 55296
    v_lshlrev_b32 v146, 16, v225
    v_and_b32 v147, s49, v225
    v_mfma_f32_16x16x32_bf16 v[76:79], v[68:71], v[36:39], v[76:79]
    v_add_f32 v230, v230, v146
    v_add_f32 v231, v231, v147
    v_mfma_f32_16x16x32_bf16 v[80:83], v[64:67], v[24:27], v[80:83]
    buffer_load_dwordx4 v242, s[24:27], s58 offen lds
    v_mfma_f32_16x16x32_bf16 v[80:83], v[68:71], v[40:43], v[80:83]
    s_add_u32 m0, s61, 65536
    ds_read_b64_tr_b16 v[56:57], v5 offset:20480
    ds_read_b64_tr_b16 v[58:59], v5 offset:22528
    v_mfma_f32_16x16x32_bf16 v[84:87], v[64:67], v[28:31], v[84:87]
    s_add_u32 s58, s12, 147456
    s_sub_u32 s56, s10, s57
    s_lshl_b32 s56, s56, 6
    s_add_u32 s56, s56, s55
    v_mfma_f32_16x16x32_bf16 v[84:87], v[68:71], v[44:47], v[84:87]
    s_waitcnt lgkmcnt(2)
    v_lshlrev_b32 v146, 16, v226
    v_and_b32 v147, s49, v226
    v_mfma_f32_16x16x32_bf16 v[88:91], v[48:51], a[0:3], 0
    buffer_load_dwordx4 v242, s[24:27], s58 offen lds
    v_mfma_f32_16x16x32_bf16 v[88:91], v[52:55], a[16:19], v[88:91]
    s_add_u32 m0, s61, 77824
    ds_read_b64_tr_b16 v[60:61], v4 offset:24576
    ds_read_b64_tr_b16 v[62:63], v4 offset:26624
    v_mfma_f32_16x16x32_bf16 v[92:95], v[48:51], a[4:7], 0
    s_waitcnt vmcnt(16) lgkmcnt(4)
    s_barrier
    v_cvt_pk_bf16_f32 v104, v72, v73
    v_cvt_pk_bf16_f32 v105, v74, v75
    v_mfma_f32_16x16x32_bf16 v[92:95], v[52:55], a[20:23], v[92:95]
    s_add_u32 s58, s12, 165888
    v_cvt_pk_bf16_f32 v106, v76, v77
    v_cvt_pk_bf16_f32 v107, v78, v79
    v_mfma_f32_16x16x32_bf16 v[96:99], v[48:51], a[8:11], 0
    buffer_load_dwordx4 v242, s[24:27], s58 offen lds
    v_mfma_f32_16x16x32_bf16 v[96:99], v[52:55], a[24:27], v[96:99]
    s_add_u32 m0, s61, 69632
    ds_read_b64_tr_b16 v[64:65], v5 offset:24576
    ds_read_b64_tr_b16 v[66:67], v5 offset:26624
    v_mfma_f32_16x16x32_bf16 v[100:103], v[48:51], a[12:15], 0
    s_add_u32 s58, s12, 184320
    buffer_store_dwordx4 v[104:107], v15, s[28:31], s56 offen offset:0 sc1
    v_mfma_f32_16x16x32_bf16 v[100:103], v[52:55], a[28:31], v[100:103]
    s_waitcnt lgkmcnt(2)
    v_add_f32 v232, v232, v146
    v_add_f32 v233, v233, v147
    v_mfma_f32_16x16x32_bf16 v[88:91], v[56:59], a[32:35], v[88:91]
    buffer_load_dwordx4 v242, s[24:27], s58 offen lds
    v_mfma_f32_16x16x32_bf16 v[88:91], v[60:63], a[48:51], v[88:91]
    s_add_u32 m0, s61, 98304
    ds_read_b64_tr_b16 v[68:69], v4 offset:28672
    ds_read_b64_tr_b16 v[70:71], v4 offset:30720
    v_mfma_f32_16x16x32_bf16 v[92:95], v[56:59], a[36:39], v[92:95]
    s_add_u32 s58, s12, 202752
    buffer_load_dwordx4 v[168:171], v15, s[28:31], s67 offen offset:1024 sc1
    v_cvt_pk_bf16_f32 v108, v80, v81
    v_cvt_pk_bf16_f32 v109, v82, v83
    v_mfma_f32_16x16x32_bf16 v[92:95], v[60:63], a[52:55], v[92:95]
    v_cvt_pk_bf16_f32 v110, v84, v85
    v_cvt_pk_bf16_f32 v111, v86, v87
    v_mfma_f32_16x16x32_bf16 v[96:99], v[56:59], a[40:43], v[96:99]
    buffer_load_dwordx4 v242, s[24:27], s58 offen lds
    v_mfma_f32_16x16x32_bf16 v[96:99], v[60:63], a[56:59], v[96:99]
    s_add_u32 m0, s61, 102400
    ds_read_b64_tr_b16 v[48:49], v240 offset:8192
    ds_read_b64_tr_b16 v[50:51], v240 offset:10240
    v_mfma_f32_16x16x32_bf16 v[100:103], v[56:59], a[44:47], v[100:103]
    s_add_u32 s58, s12, 294912
    buffer_store_dwordx4 v[108:111], v15, s[28:31], s56 offen offset:1024 sc1
    v_mfma_f32_16x16x32_bf16 v[100:103], v[60:63], a[60:63], v[100:103]
    s_waitcnt lgkmcnt(2)
    v_lshlrev_b32 v146, 16, v227
    v_and_b32 v147, s49, v227
    v_mfma_f32_16x16x32_bf16 v[88:91], v[64:67], a[64:67], v[88:91]
    buffer_load_dwordx4 v242, s[24:27], s58 offen lds
    v_mfma_f32_16x16x32_bf16 v[88:91], v[68:71], a[80:83], v[88:91]
    s_add_u32 m0, s61, 106496
    ds_read_b64_tr_b16 v[52:53], v4 offset:32768
    ds_read_b64_tr_b16 v[54:55], v4 offset:34816
    v_mfma_f32_16x16x32_bf16 v[92:95], v[64:67], a[68:71], v[92:95]
    s_add_u32 s58, s12, 313344
    v_add_f32 v234, v234, v146
    v_add_f32 v235, v235, v147
    v_mfma_f32_16x16x32_bf16 v[92:95], v[68:71], a[84:87], v[92:95]
    v_cndmask_b32 v148, v228, v232, s[62:63]
    v_cndmask_b32 v228, v232, v228, s[62:63]
    v_mfma_f32_16x16x32_bf16 v[96:99], v[64:67], a[72:75], v[96:99]
    buffer_load_dwordx4 v242, s[24:27], s58 offen lds
    v_mfma_f32_16x16x32_bf16 v[96:99], v[68:71], a[88:91], v[96:99]
    s_add_u32 m0, s61, 110592
    ds_read_b64_tr_b16 v[56:57], v240 offset:12288
    ds_read_b64_tr_b16 v[58:59], v240 offset:14336
    v_mfma_f32_16x16x32_bf16 v[100:103], v[64:67], a[76:79], v[100:103]
    s_add_u32 s58, s12, 331776
    v_cndmask_b32 v149, v229, v233, s[62:63]
    v_cndmask_b32 v229, v233, v229, s[62:63]
    v_mfma_f32_16x16x32_bf16 v[100:103], v[68:71], a[92:95], v[100:103]
    s_waitcnt lgkmcnt(2)
    v_cndmask_b32 v150, v230, v234, s[62:63]
    v_cndmask_b32 v230, v234, v230, s[62:63]
    v_mfma_f32_16x16x32_bf16 v[88:91], v[48:51], a[96:99], v[88:91]
    buffer_load_dwordx4 v242, s[24:27], s58 offen lds
    v_mfma_f32_16x16x32_bf16 v[88:91], v[52:55], a[112:115], v[88:91]
    s_add_u32 m0, s61, 114688
    ds_read_b64_tr_b16 v[60:61], v4 offset:36864
    ds_read_b64_tr_b16 v[62:63], v4 offset:38912
    v_mfma_f32_16x16x32_bf16 v[92:95], v[48:51], a[100:103], v[92:95]
    s_waitcnt vmcnt(18) lgkmcnt(4)
    s_barrier
    v_cndmask_b32 v151, v231, v235, s[62:63]
    v_cndmask_b32 v231, v235, v231, s[62:63]
    v_mfma_f32_16x16x32_bf16 v[92:95], v[52:55], a[116:119], v[92:95]
    s_add_u32 s58, s12, 350208
    v_add_f32_dpp v148, v228, v148 row_ror:4 row_mask:0xf bank_mask:0xf
    v_add_f32_dpp v149, v229, v149 row_ror:4 row_mask:0xf bank_mask:0xf
    v_mfma_f32_16x16x32_bf16 v[96:99], v[48:51], a[104:107], v[96:99]
    buffer_load_dwordx4 v242, s[24:27], s58 offen lds
    v_mfma_f32_16x16x32_bf16 v[96:99], v[52:55], a[120:123], v[96:99]
    s_add_u32 m0, s61, 118784
    ds_read_b64_tr_b16 v[64:65], v240 offset:16384
    ds_read_b64_tr_b16 v[66:67], v240 offset:18432
    v_mfma_f32_16x16x32_bf16 v[100:103], v[48:51], a[108:111], v[100:103]
    s_add_u32 s58, s12, 442368
    v_add_f32_dpp v150, v230, v150 row_ror:4 row_mask:0xf bank_mask:0xf
    v_add_f32_dpp v151, v231, v151 row_ror:4 row_mask:0xf bank_mask:0xf
    v_mfma_f32_16x16x32_bf16 v[100:103], v[52:55], a[124:127], v[100:103]
    s_waitcnt lgkmcnt(2)
    s_mov_b64 exec, 4
    buffer_load_dword v144, v245, s[28:31], s70 offen offset:256 sc1
    s_mov_b64 exec, -1
    v_mfma_f32_16x16x32_bf16 v[88:91], v[56:59], a[128:131], v[88:91]
    buffer_load_dwordx4 v242, s[24:27], s58 offen lds
    v_mfma_f32_16x16x32_bf16 v[88:91], v[60:63], a[144:147], v[88:91]
    s_add_u32 m0, s61, 0
    ds_read_b64_tr_b16 v[68:69], v4 offset:40960
    ds_read_b64_tr_b16 v[70:71], v4 offset:43008
    v_mfma_f32_16x16x32_bf16 v[92:95], v[56:59], a[132:135], v[92:95]
    s_add_u32 s58, s12, 460800
    v_add_f32_dpp v148, v148, v148 row_ror:8 row_mask:0xf bank_mask:0xf
    v_add_f32_dpp v149, v149, v149 row_ror:8 row_mask:0xf bank_mask:0xf
    v_mfma_f32_16x16x32_bf16 v[92:95], v[60:63], a[148:151], v[92:95]
    v_add_f32_dpp v150, v150, v150 row_ror:8 row_mask:0xf bank_mask:0xf
    v_add_f32_dpp v151, v151, v151 row_ror:8 row_mask:0xf bank_mask:0xf
    v_mfma_f32_16x16x32_bf16 v[96:99], v[56:59], a[136:139], v[96:99]
    buffer_load_dwordx4 v242, s[24:27], s58 offen lds
    v_mfma_f32_16x16x32_bf16 v[96:99], v[60:63], a[152:155], v[96:99]
    s_add_u32 m0, s61, 122880
    ds_read_b64_tr_b16 v[48:49], v5 offset:28672
    ds_read_b64_tr_b16 v[50:51], v5 offset:30720
    v_mfma_f32_16x16x32_bf16 v[100:103], v[56:59], a[140:143], v[100:103]
    s_add_u32 s58, s12, 479232
    v_mfma_f32_16x16x32_bf16 v[100:103], v[60:63], a[156:159], v[100:103]
    s_waitcnt lgkmcnt(2)
    v_mfma_f32_16x16x32_bf16 v[88:91], v[64:67], a[160:163], v[88:91]
    buffer_load_dwordx4 v242, s[24:27], s58 offen lds
    v_mfma_f32_16x16x32_bf16 v[88:91], v[68:71], a[176:179], v[88:91]
    s_add_u32 m0, s61, 4096
    ds_read_b64_tr_b16 v[52:53], v4 offset:45056
    ds_read_b64_tr_b16 v[54:55], v4 offset:47104
    v_mfma_f32_16x16x32_bf16 v[92:95], v[64:67], a[164:167], v[92:95]
    s_add_u32 s58, s12, 497664
    v_mfma_f32_16x16x32_bf16 v[92:95], v[68:71], a[180:183], v[92:95]
    v_mfma_f32_16x16x32_bf16 v[96:99], v[64:67], a[168:171], v[96:99]
    buffer_load_dwordx4 v242, s[24:27], s58 offen lds
    v_mfma_f32_16x16x32_bf16 v[96:99], v[68:71], a[184:187], v[96:99]
    s_add_u32 m0, s61, 126976
    ds_read_b64_tr_b16 v[56:57], v240 offset:20480
    ds_read_b64_tr_b16 v[58:59], v240 offset:22528
    v_mfma_f32_16x16x32_bf16 v[100:103], v[64:67], a[172:175], v[100:103]
    s_add_u32 s58, s12, 589824
    s_waitcnt vmcnt(11)
    v_lshlrev_b32 v128, 16, v164
    v_and_b32 v129, s49, v164
    v_mfma_f32_16x16x32_bf16 v[100:103], v[68:71], a[188:191], v[100:103]
    s_waitcnt lgkmcnt(2)
    s_waitcnt vmcnt(9)
    s_mov_b64 exec, 1
    buffer_store_dword v145, off, s[28:31], s51 offset:384 sc1
    s_mov_b64 exec, -1
    v_mfma_f32_16x16x32_bf16 v[88:91], v[48:51], a[192:195], v[88:91]
    buffer_load_dwordx4 v8, s[24:27], s58 offen lds
    v_mfma_f32_16x16x32_bf16 v[88:91], v[52:55], a[208:211], v[88:91]
    s_add_u32 m0, s61, 8192
    ds_read_b64_tr_b16 v[60:61], v4 offset:49152
    ds_read_b64_tr_b16 v[62:63], v4 offset:51200
    v_mfma_f32_16x16x32_bf16 v[92:95], v[48:51], a[196:199], v[92:95]
    s_waitcnt vmcnt(18) lgkmcnt(4)
    s_barrier
    v_lshlrev_b32 v130, 16, v165
    v_and_b32 v131, s49, v165
    v_mfma_f32_16x16x32_bf16 v[92:95], v[52:55], a[212:215], v[92:95]
    s_add_u32 s58, s12, 626688
    v_lshlrev_b32 v132, 16, v166
    v_and_b32 v133, s49, v166
    v_mfma_f32_16x16x32_bf16 v[96:99], v[48:51], a[200:203], v[96:99]
    buffer_load_dwordx4 v8, s[24:27], s58 offen lds
    v_mfma_f32_16x16x32_bf16 v[96:99], v[52:55], a[216:219], v[96:99]
    s_add_u32 m0, s61, 131072
    ds_read_b64_tr_b16 v[64:65], v240 offset:24576
    ds_read_b64_tr_b16 v[66:67], v240 offset:26624
    v_mfma_f32_16x16x32_bf16 v[100:103], v[48:51], a[204:207], v[100:103]
    s_add_u32 s58, s13, 0
    v_lshlrev_b32 v134, 16, v167
    v_and_b32 v135, s49, v167
    v_mfma_f32_16x16x32_bf16 v[100:103], v[52:55], a[220:223], v[100:103]
    s_waitcnt lgkmcnt(2)
    v_lshlrev_b32 v136, 16, v168
    v_and_b32 v137, s49, v168
    v_mfma_f32_16x16x32_bf16 v[88:91], v[56:59], a[224:227], v[88:91]
    buffer_load_dwordx4 v242, s[24:27], s58 offen lds
    v_mfma_f32_16x16x32_bf16 v[88:91], v[60:63], a[240:243], v[88:91]
    s_add_u32 m0, s61, 12288
    ds_read_b64_tr_b16 v[68:69], v4 offset:53248
    ds_read_b64_tr_b16 v[70:71], v4 offset:55296
    s_sub_u32 s67, s5, 2
    s_and_b32 s67, s67, 7
    v_mfma_f32_16x16x32_bf16 v[92:95], v[56:59], a[228:231], v[92:95]
    s_add_u32 s58, s13, 18432
    s_waitcnt vmcnt(8)
    v_cmp_eq_u32 vcc, 0, v144
    v_mfma_f32_16x16x32_bf16 v[92:95], v[60:63], a[244:247], v[92:95]
    s_cbranch_vccnz L_gslow_15
    L_gback_16:
    v_mfma_f32_16x16x32_bf16 v[96:99], v[56:59], a[232:235], v[96:99]
    buffer_load_dwordx4 v242, s[24:27], s58 offen lds
    v_mfma_f32_16x16x32_bf16 v[96:99], v[60:63], a[248:251], v[96:99]
    s_add_u32 m0, s61, 135168
    ds_read_b64_tr_b16 v[48:49], v240 offset:28672
    ds_read_b64_tr_b16 v[50:51], v240 offset:30720
    s_mul_i32 s67, s67, 73728
    s_add_u32 s67, s67, s59
    v_mfma_f32_16x16x32_bf16 v[100:103], v[56:59], a[236:239], v[100:103]
    s_add_u32 s58, s13, 36864
    buffer_load_dwordx4 v[172:175], v15, s[28:31], s67 offen offset:0 sc1
    v_mfma_f32_16x16x32_bf16 v[100:103], v[60:63], a[252:255], v[100:103]
    s_waitcnt lgkmcnt(2)
    v_lshlrev_b32 v138, 16, v169
    v_and_b32 v139, s49, v169
    v_mfma_f32_16x16x32_bf16 v[88:91], v[64:67], v[16:19], v[88:91]
    buffer_load_dwordx4 v242, s[24:27], s58 offen lds
    v_mfma_f32_16x16x32_bf16 v[88:91], v[68:71], v[32:35], v[88:91]
    s_add_u32 m0, s61, 16384
    ds_read_b64_tr_b16 v[52:53], v4 offset:57344
    ds_read_b64_tr_b16 v[54:55], v4 offset:59392
    v_mfma_f32_16x16x32_bf16 v[92:95], v[64:67], v[20:23], v[92:95]
    s_add_u32 s58, s13, 55296
    v_lshlrev_b32 v140, 16, v170
    v_and_b32 v141, s49, v170
    v_mfma_f32_16x16x32_bf16 v[92:95], v[68:71], v[36:39], v[92:95]
    v_lshlrev_b32 v142, 16, v171
    v_and_b32 v143, s49, v171
    v_mfma_f32_16x16x32_bf16 v[96:99], v[64:67], v[24:27], v[96:99]
    buffer_load_dwordx4 v242, s[24:27], s58 offen lds
    v_mfma_f32_16x16x32_bf16 v[96:99], v[68:71], v[40:43], v[96:99]
    s_add_u32 m0, s61, 81920
    ds_read_b64_tr_b16 v[56:57], v4 offset:61440
    ds_read_b64_tr_b16 v[58:59], v4 offset:63488
    v_mfma_f32_16x16x32_bf16 v[100:103], v[64:67], v[28:31], v[100:103]
    s_add_u32 s58, s13, 147456
    s_sub_u32 s56, s11, s57
    s_lshl_b32 s56, s56, 6
    s_add_u32 s56, s56, s55
    v_mfma_f32_16x16x32_bf16 v[100:103], v[68:71], v[44:47], v[100:103]
    s_waitcnt lgkmcnt(2)
    v_mfma_f32_16x16x32_bf16 v[72:75], v[48:51], a[0:3], 0
    buffer_load_dwordx4 v242, s[24:27], s58 offen lds
    v_mfma_f32_16x16x32_bf16 v[72:75], v[52:55], a[16:19], v[72:75]
    s_add_u32 m0, s61, 20480
    ds_read_b64_tr_b16 v[60:61], v5 offset:8192
    ds_read_b64_tr_b16 v[62:63], v5 offset:10240
    v_mfma_f32_16x16x32_bf16 v[76:79], v[48:51], a[4:7], 0
    s_waitcnt vmcnt(16) lgkmcnt(4)
    s_barrier
    v_cvt_pk_bf16_f32 v104, v88, v89
    v_cvt_pk_bf16_f32 v105, v90, v91
    v_mfma_f32_16x16x32_bf16 v[76:79], v[52:55], a[20:23], v[76:79]
    s_add_u32 s58, s13, 165888
    v_cvt_pk_bf16_f32 v106, v92, v93
    v_cvt_pk_bf16_f32 v107, v94, v95
    v_mfma_f32_16x16x32_bf16 v[80:83], v[48:51], a[8:11], 0
    buffer_load_dwordx4 v242, s[24:27], s58 offen lds
    v_mfma_f32_16x16x32_bf16 v[80:83], v[52:55], a[24:27], v[80:83]
    s_add_u32 m0, s61, 86016
    ds_read_b64_tr_b16 v[64:65], v5 offset:0
    ds_read_b64_tr_b16 v[66:67], v5 offset:2048
    v_mfma_f32_16x16x32_bf16 v[84:87], v[48:51], a[12:15], 0
    s_add_u32 s58, s13, 184320
    buffer_store_dwordx4 v[104:107], v15, s[28:31], s56 offen offset:0 sc1
    v_mfma_f32_16x16x32_bf16 v[84:87], v[52:55], a[28:31], v[84:87]
    s_waitcnt lgkmcnt(2)
    v_mfma_f32_16x16x32_bf16 v[72:75], v[56:59], a[32:35], v[72:75]
    buffer_load_dwordx4 v242, s[24:27], s58 offen lds
    v_mfma_f32_16x16x32_bf16 v[72:75], v[60:63], a[48:51], v[72:75]
    s_add_u32 m0, s61, 24576
    ds_read_b64_tr_b16 v[68:69], v5 offset:12288
    ds_read_b64_tr_b16 v[70:71], v5 offset:14336
    v_mfma_f32_16x16x32_bf16 v[76:79], v[56:59], a[36:39], v[76:79]
    s_add_u32 s58, s13, 202752
    buffer_load_dwordx4 v[176:179], v15, s[28:31], s67 offen offset:1024 sc1
    v_cvt_pk_bf16_f32 v108, v96, v97
    v_cvt_pk_bf16_f32 v109, v98, v99
    v_mfma_f32_16x16x32_bf16 v[76:79], v[60:63], a[52:55], v[76:79]
    v_cvt_pk_bf16_f32 v110, v100, v101
    v_cvt_pk_bf16_f32 v111, v102, v103
    v_mfma_f32_16x16x32_bf16 v[80:83], v[56:59], a[40:43], v[80:83]
    buffer_load_dwordx4 v242, s[24:27], s58 offen lds
    v_mfma_f32_16x16x32_bf16 v[80:83], v[60:63], a[56:59], v[80:83]
    s_add_u32 m0, s61, 90112
    ds_read_b64_tr_b16 v[48:49], v5 offset:4096
    ds_read_b64_tr_b16 v[50:51], v5 offset:6144
    v_mfma_f32_16x16x32_bf16 v[84:87], v[56:59], a[44:47], v[84:87]
    s_add_u32 s58, s13, 294912
    buffer_store_dwordx4 v[108:111], v15, s[28:31], s56 offen offset:1024 sc1
    v_mfma_f32_16x16x32_bf16 v[84:87], v[60:63], a[60:63], v[84:87]
    s_waitcnt lgkmcnt(2)
    v_mfma_f32_16x16x32_bf16 v[72:75], v[64:67], a[64:67], v[72:75]
    buffer_load_dwordx4 v242, s[24:27], s58 offen lds
    v_mfma_f32_16x16x32_bf16 v[72:75], v[68:71], a[80:83], v[72:75]
    s_add_u32 m0, s61, 28672
    ds_read_b64_tr_b16 v[52:53], v5 offset:32768
    ds_read_b64_tr_b16 v[54:55], v5 offset:34816
    v_mfma_f32_16x16x32_bf16 v[76:79], v[64:67], a[68:71], v[76:79]
    s_add_u32 s58, s13, 313344
    v_mfma_f32_16x16x32_bf16 v[76:79], v[68:71], a[84:87], v[76:79]
    v_mfma_f32_16x16x32_bf16 v[80:83], v[64:67], a[72:75], v[80:83]
    buffer_load_dwordx4 v242, s[24:27], s58 offen lds
    v_mfma_f32_16x16x32_bf16 v[80:83], v[68:71], a[88:91], v[80:83]
    s_add_u32 m0, s61, 139264
    ds_read_b64_tr_b16 v[56:57], v5 offset:36864
    ds_read_b64_tr_b16 v[58:59], v5 offset:38912
    v_mfma_f32_16x16x32_bf16 v[84:87], v[64:67], a[76:79], v[84:87]
    s_add_u32 s58, s13, 331776
    v_mfma_f32_16x16x32_bf16 v[84:87], v[68:71], a[92:95], v[84:87]
    s_waitcnt lgkmcnt(2)
    v_mfma_f32_16x16x32_bf16 v[72:75], v[48:51], a[96:99], v[72:75]
    buffer_load_dwordx4 v242, s[24:27], s58 offen lds
    v_mfma_f32_16x16x32_bf16 v[72:75], v[52:55], a[112:115], v[72:75]
    s_add_u32 m0, s61, 32768
    ds_read_b64_tr_b16 v[60:61], v5 offset:40960
    ds_read_b64_tr_b16 v[62:63], v5 offset:43008
    v_mfma_f32_16x16x32_bf16 v[76:79], v[48:51], a[100:103], v[76:79]
    s_waitcnt vmcnt(18) lgkmcnt(4)
    s_barrier
    v_mfma_f32_16x16x32_bf16 v[76:79], v[52:55], a[116:119], v[76:79]
    s_add_u32 s58, s13, 350208
    v_mfma_f32_16x16x32_bf16 v[80:83], v[48:51], a[104:107], v[80:83]
    buffer_load_dwordx4 v242, s[24:27], s58 offen lds
    v_mfma_f32_16x16x32_bf16 v[80:83], v[52:55], a[120:123], v[80:83]
    s_add_u32 m0, s61, 143360
    ds_read_b64_tr_b16 v[64:65], v5 offset:45056
    ds_read_b64_tr_b16 v[66:67], v5 offset:47104
    v_mfma_f32_16x16x32_bf16 v[84:87], v[48:51], a[108:111], v[84:87]
    s_add_u32 s58, s13, 442368
    v_mfma_f32_16x16x32_bf16 v[84:87], v[52:55], a[124:127], v[84:87]
    s_waitcnt lgkmcnt(2)
    s_mov_b64 exec, 8
    buffer_load_dword v144, v245, s[28:31], s70 offen offset:384 sc1
    s_mov_b64 exec, -1
    v_mfma_f32_16x16x32_bf16 v[72:75], v[56:59], a[128:131], v[72:75]
    buffer_load_dwordx4 v242, s[24:27], s58 offen lds
    v_mfma_f32_16x16x32_bf16 v[72:75], v[60:63], a[144:147], v[72:75]
    s_add_u32 m0, s61, 36864
    ds_read_b64_tr_b16 v[68:69], v5 offset:49152
    ds_read_b64_tr_b16 v[70:71], v5 offset:51200
    v_mfma_f32_16x16x32_bf16 v[76:79], v[56:59], a[132:135], v[76:79]
    s_add_u32 s58, s13, 460800
    v_mfma_f32_16x16x32_bf16 v[76:79], v[60:63], a[148:151], v[76:79]
    v_mfma_f32_16x16x32_bf16 v[80:83], v[56:59], a[136:139], v[80:83]
    buffer_load_dwordx4 v242, s[24:27], s58 offen lds
    v_mfma_f32_16x16x32_bf16 v[80:83], v[60:63], a[152:155], v[80:83]
    s_add_u32 m0, s61, 147456
    ds_read_b64_tr_b16 v[48:49], v5 offset:53248
    ds_read_b64_tr_b16 v[50:51], v5 offset:55296
    v_mfma_f32_16x16x32_bf16 v[84:87], v[56:59], a[140:143], v[84:87]
    s_add_u32 s58, s13, 479232
    v_mfma_f32_16x16x32_bf16 v[84:87], v[60:63], a[156:159], v[84:87]
    s_waitcnt lgkmcnt(2)
    v_mfma_f32_16x16x32_bf16 v[72:75], v[64:67], a[160:163], v[72:75]
    buffer_load_dwordx4 v242, s[24:27], s58 offen lds
    v_mfma_f32_16x16x32_bf16 v[72:75], v[68:71], a[176:179], v[72:75]
    s_add_u32 m0, s61, 40960
    ds_read_b64_tr_b16 v[52:53], v4 offset:0
    ds_read_b64_tr_b16 v[54:55], v4 offset:2048
    v_mfma_f32_16x16x32_bf16 v[76:79], v[64:67], a[164:167], v[76:79]
    s_add_u32 s58, s13, 497664
    v_mfma_f32_16x16x32_bf16 v[76:79], v[68:71], a[180:183], v[76:79]
    v_mfma_f32_16x16x32_bf16 v[80:83], v[64:67], a[168:171], v[80:83]
    buffer_load_dwordx4 v242, s[24:27], s58 offen lds
    v_mfma_f32_16x16x32_bf16 v[80:83], v[68:71], a[184:187], v[80:83]
    s_add_u32 m0, s61, 94208
    ds_read_b64_tr_b16 v[56:57], v5 offset:57344
    ds_read_b64_tr_b16 v[58:59], v5 offset:59392
    v_mfma_f32_16x16x32_bf16 v[84:87], v[64:67], a[172:175], v[84:87]
    s_add_u32 s58, s13, 589824
    s_waitcnt vmcnt(11)
    v_lshlrev_b32 v146, 16, v172
    v_and_b32 v147, s49, v172
    v_mfma_f32_16x16x32_bf16 v[84:87], v[68:71], a[188:191], v[84:87]
    s_waitcnt lgkmcnt(2)
    s_waitcnt vmcnt(9)
    s_mov_b64 exec, 1
    buffer_store_dword v145, off, s[28:31], s51 offset:512 sc1
    s_mov_b64 exec, -1
    v_mfma_f32_16x16x32_bf16 v[72:75], v[48:51], a[192:195], v[72:75]
    buffer_load_dwordx4 v8, s[24:27], s58 offen lds
    v_mfma_f32_16x16x32_bf16 v[72:75], v[52:55], a[208:211], v[72:75]
    s_add_u32 m0, s61, 45056
    ds_read_b64_tr_b16 v[60:61], v4 offset:4096
    ds_read_b64_tr_b16 v[62:63], v4 offset:6144
    v_mfma_f32_16x16x32_bf16 v[76:79], v[48:51], a[196:199], v[76:79]
    s_waitcnt vmcnt(18) lgkmcnt(4)
    s_barrier
    v_add_f32 v128, v128, v146
    v_add_f32 v129, v129, v147
    v_mfma_f32_16x16x32_bf16 v[76:79], v[52:55], a[212:215], v[76:79]
    s_add_u32 s58, s13, 626688
    v_lshlrev_b32 v146, 16, v173
    v_and_b32 v147, s49, v173
    v_mfma_f32_16x16x32_bf16 v[80:83], v[48:51], a[200:203], v[80:83]
    buffer_load_dwordx4 v8, s[24:27], s58 offen lds
    v_mfma_f32_16x16x32_bf16 v[80:83], v[52:55], a[216:219], v[80:83]
    s_add_u32 m0, s61, 151552
    ds_read_b64_tr_b16 v[64:65], v5 offset:61440
    ds_read_b64_tr_b16 v[66:67], v5 offset:63488
    v_mfma_f32_16x16x32_bf16 v[84:87], v[48:51], a[204:207], v[84:87]
    s_add_u32 s58, s14, 0
    v_add_f32 v130, v130, v146
    v_add_f32 v131, v131, v147
    v_mfma_f32_16x16x32_bf16 v[84:87], v[52:55], a[220:223], v[84:87]
    s_waitcnt lgkmcnt(2)
    v_lshlrev_b32 v146, 16, v174
    v_and_b32 v147, s49, v174
    v_mfma_f32_16x16x32_bf16 v[72:75], v[56:59], a[224:227], v[72:75]
    buffer_load_dwordx4 v242, s[24:27], s58 offen lds
    v_mfma_f32_16x16x32_bf16 v[72:75], v[60:63], a[240:243], v[72:75]
    s_add_u32 m0, s61, 49152
    ds_read_b64_tr_b16 v[68:69], v4 offset:8192
    ds_read_b64_tr_b16 v[70:71], v4 offset:10240
    s_sub_u32 s67, s5, 3
    s_and_b32 s67, s67, 7
    v_mfma_f32_16x16x32_bf16 v[76:79], v[56:59], a[228:231], v[76:79]
    s_add_u32 s58, s14, 18432
    s_waitcnt vmcnt(8)
    v_cmp_eq_u32 vcc, 0, v144
    v_mfma_f32_16x16x32_bf16 v[76:79], v[60:63], a[244:247], v[76:79]
    s_cbranch_vccnz L_gslow_17
    L_gback_18:
    v_mfma_f32_16x16x32_bf16 v[80:83], v[56:59], a[232:235], v[80:83]
    buffer_load_dwordx4 v242, s[24:27], s58 offen lds
    v_mfma_f32_16x16x32_bf16 v[80:83], v[60:63], a[248:251], v[80:83]
    s_add_u32 m0, s61, 155648
    ds_read_b64_tr_b16 v[48:49], v240 offset:0
    ds_read_b64_tr_b16 v[50:51], v240 offset:2048
    s_mul_i32 s67, s67, 73728
    s_add_u32 s67, s67, s59
    v_mfma_f32_16x16x32_bf16 v[84:87], v[56:59], a[236:239], v[84:87]
    s_add_u32 s58, s14, 36864
    buffer_load_dwordx4 v[180:183], v15, s[28:31], s67 offen offset:0 sc1
    v_mfma_f32_16x16x32_bf16 v[84:87], v[60:63], a[252:255], v[84:87]
    s_waitcnt lgkmcnt(2)
    v_add_f32 v132, v132, v146
    v_add_f32 v133, v133, v147
    v_mfma_f32_16x16x32_bf16 v[72:75], v[64:67], v[16:19], v[72:75]
    buffer_load_dwordx4 v242, s[24:27], s58 offen lds
    v_mfma_f32_16x16x32_bf16 v[72:75], v[68:71], v[32:35], v[72:75]
    s_add_u32 m0, s61, 53248
    ds_read_b64_tr_b16 v[52:53], v4 offset:12288
    ds_read_b64_tr_b16 v[54:55], v4 offset:14336
    v_mfma_f32_16x16x32_bf16 v[76:79], v[64:67], v[20:23], v[76:79]
    s_add_u32 s58, s14, 55296
    v_lshlrev_b32 v146, 16, v175
    v_and_b32 v147, s49, v175
    v_mfma_f32_16x16x32_bf16 v[76:79], v[68:71], v[36:39], v[76:79]
    v_add_f32 v134, v134, v146
    v_add_f32 v135, v135, v147
    v_mfma_f32_16x16x32_bf16 v[80:83], v[64:67], v[24:27], v[80:83]
    buffer_load_dwordx4 v242, s[24:27], s58 offen lds
    v_mfma_f32_16x16x32_bf16 v[80:83], v[68:71], v[40:43], v[80:83]
    s_add_u32 m0, s61, 159744
    ds_read_b64_tr_b16 v[56:57], v240 offset:4096
    ds_read_b64_tr_b16 v[58:59], v240 offset:6144
    v_mfma_f32_16x16x32_bf16 v[84:87], v[64:67], v[28:31], v[84:87]
    s_add_u32 s58, s14, 147456
    s_sub_u32 s56, s12, s57
    s_lshl_b32 s56, s56, 6
    s_add_u32 s56, s56, s55
    v_mfma_f32_16x16x32_bf16 v[84:87], v[68:71], v[44:47], v[84:87]
    s_waitcnt lgkmcnt(2)
    v_lshlrev_b32 v146, 16, v176
    v_and_b32 v147, s49, v176
    v_mfma_f32_16x16x32_bf16 v[88:91], v[48:51], a[0:3], 0
    buffer_load_dwordx4 v242, s[24:27], s58 offen lds
    v_mfma_f32_16x16x32_bf16 v[88:91], v[52:55], a[16:19], v[88:91]
    s_add_u32 m0, s61, 57344
    ds_read_b64_tr_b16 v[60:61], v4 offset:16384
    ds_read_b64_tr_b16 v[62:63], v4 offset:18432
    v_mfma_f32_16x16x32_bf16 v[92:95], v[48:51], a[4:7], 0
    s_waitcnt vmcnt(16) lgkmcnt(4)
    s_barrier
    v_cvt_pk_bf16_f32 v104, v72, v73
    v_cvt_pk_bf16_f32 v105, v74, v75
    v_mfma_f32_16x16x32_bf16 v[92:95], v[52:55], a[20:23], v[92:95]
    s_add_u32 s58, s14, 165888
    v_cvt_pk_bf16_f32 v106, v76, v77
    v_cvt_pk_bf16_f32 v107, v78, v79
    v_mfma_f32_16x16x32_bf16 v[96:99], v[48:51], a[8:11], 0
    buffer_load_dwordx4 v242, s[24:27], s58 offen lds
    v_mfma_f32_16x16x32_bf16 v[96:99], v[52:55], a[24:27], v[96:99]
    s_add_u32 m0, s61, 61440
    ds_read_b64_tr_b16 v[64:65], v5 offset:16384
    ds_read_b64_tr_b16 v[66:67], v5 offset:18432
    v_mfma_f32_16x16x32_bf16 v[100:103], v[48:51], a[12:15], 0
    s_add_u32 s58, s14, 184320
    buffer_store_dwordx4 v[104:107], v15, s[28:31], s56 offen offset:0 sc1
    v_mfma_f32_16x16x32_bf16 v[100:103], v[52:55], a[28:31], v[100:103]
    s_waitcnt lgkmcnt(2)
    v_add_f32 v136, v136, v146
    v_add_f32 v137, v137, v147
    v_mfma_f32_16x16x32_bf16 v[88:91], v[56:59], a[32:35], v[88:91]
    buffer_load_dwordx4 v242, s[24:27], s58 offen lds
    v_mfma_f32_16x16x32_bf16 v[88:91], v[60:63], a[48:51], v[88:91]
    s_add_u32 m0, s61, 73728
    ds_read_b64_tr_b16 v[68:69], v4 offset:20480
    ds_read_b64_tr_b16 v[70:71], v4 offset:22528
    v_mfma_f32_16x16x32_bf16 v[92:95], v[56:59], a[36:39], v[92:95]
    s_add_u32 s58, s14, 202752
    buffer_load_dwordx4 v[184:187], v15, s[28:31], s67 offen offset:1024 sc1
    v_cvt_pk_bf16_f32 v108, v80, v81
    v_cvt_pk_bf16_f32 v109, v82, v83
    v_mfma_f32_16x16x32_bf16 v[92:95], v[60:63], a[52:55], v[92:95]
    v_cvt_pk_bf16_f32 v110, v84, v85
    v_cvt_pk_bf16_f32 v111, v86, v87
    v_mfma_f32_16x16x32_bf16 v[96:99], v[56:59], a[40:43], v[96:99]
    buffer_load_dwordx4 v242, s[24:27], s58 offen lds
    v_mfma_f32_16x16x32_bf16 v[96:99], v[60:63], a[56:59], v[96:99]
    s_add_u32 m0, s61, 65536
    ds_read_b64_tr_b16 v[48:49], v5 offset:20480
    ds_read_b64_tr_b16 v[50:51], v5 offset:22528
    v_mfma_f32_16x16x32_bf16 v[100:103], v[56:59], a[44:47], v[100:103]
    s_add_u32 s58, s14, 294912
    buffer_store_dwordx4 v[108:111], v15, s[28:31], s56 offen offset:1024 sc1
    v_mfma_f32_16x16x32_bf16 v[100:103], v[60:63], a[60:63], v[100:103]
    s_waitcnt lgkmcnt(2)
    v_lshlrev_b32 v146, 16, v177
    v_and_b32 v147, s49, v177
    v_mfma_f32_16x16x32_bf16 v[88:91], v[64:67], a[64:67], v[88:91]
    buffer_load_dwordx4 v242, s[24:27], s58 offen lds
    v_mfma_f32_16x16x32_bf16 v[88:91], v[68:71], a[80:83], v[88:91]
    s_add_u32 m0, s61, 77824
    ds_read_b64_tr_b16 v[52:53], v4 offset:24576
    ds_read_b64_tr_b16 v[54:55], v4 offset:26624
    v_mfma_f32_16x16x32_bf16 v[92:95], v[64:67], a[68:71], v[92:95]
    s_add_u32 s58, s14, 313344
    v_add_f32 v138, v138, v146
    v_add_f32 v139, v139, v147
    v_mfma_f32_16x16x32_bf16 v[92:95], v[68:71], a[84:87], v[92:95]
    v_lshlrev_b32 v146, 16, v178
    v_and_b32 v147, s49, v178
    v_mfma_f32_16x16x32_bf16 v[96:99], v[64:67], a[72:75], v[96:99]
    buffer_load_dwordx4 v242, s[24:27], s58 offen lds
    v_mfma_f32_16x16x32_bf16 v[96:99], v[68:71], a[88:91], v[96:99]
    s_add_u32 m0, s61, 69632
    ds_read_b64_tr_b16 v[56:57], v5 offset:24576
    ds_read_b64_tr_b16 v[58:59], v5 offset:26624
    v_mfma_f32_16x16x32_bf16 v[100:103], v[64:67], a[76:79], v[100:103]
    s_add_u32 s58, s14, 331776
    v_add_f32 v140, v140, v146
    v_add_f32 v141, v141, v147
    v_mfma_f32_16x16x32_bf16 v[100:103], v[68:71], a[92:95], v[100:103]
    s_waitcnt lgkmcnt(2)
    v_lshlrev_b32 v146, 16, v179
    v_and_b32 v147, s49, v179
    v_mfma_f32_16x16x32_bf16 v[88:91], v[48:51], a[96:99], v[88:91]
    buffer_load_dwordx4 v242, s[24:27], s58 offen lds
    v_mfma_f32_16x16x32_bf16 v[88:91], v[52:55], a[112:115], v[88:91]
    s_add_u32 m0, s61, 98304
    ds_read_b64_tr_b16 v[60:61], v4 offset:28672
    ds_read_b64_tr_b16 v[62:63], v4 offset:30720
    v_mfma_f32_16x16x32_bf16 v[92:95], v[48:51], a[100:103], v[92:95]
    s_waitcnt vmcnt(18) lgkmcnt(4)
    s_barrier
    v_add_f32 v142, v142, v146
    v_add_f32 v143, v143, v147
    v_mfma_f32_16x16x32_bf16 v[92:95], v[52:55], a[116:119], v[92:95]
    s_add_u32 s58, s14, 350208
    v_mfma_f32_16x16x32_bf16 v[96:99], v[48:51], a[104:107], v[96:99]
    buffer_load_dwordx4 v242, s[24:27], s58 offen lds
    v_mfma_f32_16x16x32_bf16 v[96:99], v[52:55], a[120:123], v[96:99]
    s_add_u32 m0, s61, 102400
    ds_read_b64_tr_b16 v[64:65], v240 offset:8192
    ds_read_b64_tr_b16 v[66:67], v240 offset:10240
    v_mfma_f32_16x16x32_bf16 v[100:103], v[48:51], a[108:111], v[100:103]
    s_add_u32 s58, s14, 442368
    v_mfma_f32_16x16x32_bf16 v[100:103], v[52:55], a[124:127], v[100:103]
    s_waitcnt lgkmcnt(2)
    s_mov_b64 exec, 16
    buffer_load_dword v144, v245, s[28:31], s70 offen offset:512 sc1
    s_mov_b64 exec, -1
    v_mfma_f32_16x16x32_bf16 v[88:91], v[56:59], a[128:131], v[88:91]
    buffer_load_dwordx4 v242, s[24:27], s58 offen lds
    v_mfma_f32_16x16x32_bf16 v[88:91], v[60:63], a[144:147], v[88:91]
    s_add_u32 m0, s61, 106496
    ds_read_b64_tr_b16 v[68:69], v4 offset:32768
    ds_read_b64_tr_b16 v[70:71], v4 offset:34816
    v_mfma_f32_16x16x32_bf16 v[92:95], v[56:59], a[132:135], v[92:95]
    s_add_u32 s58, s14, 460800
    v_mfma_f32_16x16x32_bf16 v[92:95], v[60:63], a[148:151], v[92:95]
    v_mfma_f32_16x16x32_bf16 v[96:99], v[56:59], a[136:139], v[96:99]
    buffer_load_dwordx4 v242, s[24:27], s58 offen lds
    v_mfma_f32_16x16x32_bf16 v[96:99], v[60:63], a[152:155], v[96:99]
    s_add_u32 m0, s61, 110592
    ds_read_b64_tr_b16 v[48:49], v240 offset:12288
    ds_read_b64_tr_b16 v[50:51], v240 offset:14336
    v_mfma_f32_16x16x32_bf16 v[100:103], v[56:59], a[140:143], v[100:103]
    s_add_u32 s58, s14, 479232
    v_mfma_f32_16x16x32_bf16 v[100:103], v[60:63], a[156:159], v[100:103]
    s_waitcnt lgkmcnt(2)
    v_mfma_f32_16x16x32_bf16 v[88:91], v[64:67], a[160:163], v[88:91]
    buffer_load_dwordx4 v242, s[24:27], s58 offen lds
    v_mfma_f32_16x16x32_bf16 v[88:91], v[68:71], a[176:179], v[88:91]
    s_add_u32 m0, s61, 114688
    ds_read_b64_tr_b16 v[52:53], v4 offset:36864
    ds_read_b64_tr_b16 v[54:55], v4 offset:38912
    v_mfma_f32_16x16x32_bf16 v[92:95], v[64:67], a[164:167], v[92:95]
    s_add_u32 s58, s14, 497664
    v_mfma_f32_16x16x32_bf16 v[92:95], v[68:71], a[180:183], v[92:95]
    v_mfma_f32_16x16x32_bf16 v[96:99], v[64:67], a[168:171], v[96:99]
    buffer_load_dwordx4 v242, s[24:27], s58 offen lds
    v_mfma_f32_16x16x32_bf16 v[96:99], v[68:71], a[184:187], v[96:99]
    s_add_u32 m0, s61, 118784
    ds_read_b64_tr_b16 v[56:57], v240 offset:16384
    ds_read_b64_tr_b16 v[58:59], v240 offset:18432
    v_mfma_f32_16x16x32_bf16 v[100:103], v[64:67], a[172:175], v[100:103]
    s_add_u32 s58, s14, 589824
    s_waitcnt vmcnt(11)
    v_lshlrev_b32 v146, 16, v180
    v_and_b32 v147, s49, v180
    v_mfma_f32_16x16x32_bf16 v[100:103], v[68:71], a[188:191], v[100:103]
    s_waitcnt lgkmcnt(2)
    s_waitcnt vmcnt(9)
    s_mov_b64 exec, 1
    buffer_store_dword v145, off, s[28:31], s51 offset:640 sc1
    s_mov_b64 exec, -1
    v_mfma_f32_16x16x32_bf16 v[88:91], v[48:51], a[192:195], v[88:91]
    buffer_load_dwordx4 v8, s[24:27], s58 offen lds
    v_mfma_f32_16x16x32_bf16 v[88:91], v[52:55], a[208:211], v[88:91]
    s_add_u32 m0, s61, 0
    ds_read_b64_tr_b16 v[60:61], v4 offset:40960
    ds_read_b64_tr_b16 v[62:63], v4 offset:43008
    v_mfma_f32_16x16x32_bf16 v[92:95], v[48:51], a[196:199], v[92:95]
    s_waitcnt vmcnt(18) lgkmcnt(4)
    s_barrier
    v_add_f32 v128, v128, v146
    v_add_f32 v129, v129, v147
    v_mfma_f32_16x16x32_bf16 v[92:95], v[52:55], a[212:215], v[92:95]
    s_add_u32 s58, s14, 626688
    v_lshlrev_b32 v146, 16, v181
    v_and_b32 v147, s49, v181
    v_mfma_f32_16x16x32_bf16 v[96:99], v[48:51], a[200:203], v[96:99]
    buffer_load_dwordx4 v8, s[24:27], s58 offen lds
    v_mfma_f32_16x16x32_bf16 v[96:99], v[52:55], a[216:219], v[96:99]
    s_add_u32 m0, s61, 122880
    ds_read_b64_tr_b16 v[64:65], v5 offset:28672
    ds_read_b64_tr_b16 v[66:67], v5 offset:30720
    v_mfma_f32_16x16x32_bf16 v[100:103], v[48:51], a[204:207], v[100:103]
    s_add_u32 s58, s15, 0
    v_add_f32 v130, v130, v146
    v_add_f32 v131, v131, v147
    v_mfma_f32_16x16x32_bf16 v[100:103], v[52:55], a[220:223], v[100:103]
    s_waitcnt lgkmcnt(2)
    v_lshlrev_b32 v146, 16, v182
    v_and_b32 v147, s49, v182
    v_mfma_f32_16x16x32_bf16 v[88:91], v[56:59], a[224:227], v[88:91]
    buffer_load_dwordx4 v242, s[24:27], s58 offen lds
    v_mfma_f32_16x16x32_bf16 v[88:91], v[60:63], a[240:243], v[88:91]
    s_add_u32 m0, s61, 4096
    ds_read_b64_tr_b16 v[68:69], v4 offset:45056
    ds_read_b64_tr_b16 v[70:71], v4 offset:47104
    s_sub_u32 s67, s5, 4
    s_and_b32 s67, s67, 7
    v_mfma_f32_16x16x32_bf16 v[92:95], v[56:59], a[228:231], v[92:95]
    s_add_u32 s58, s15, 18432
    s_waitcnt vmcnt(8)
    v_cmp_eq_u32 vcc, 0, v144
    v_mfma_f32_16x16x32_bf16 v[92:95], v[60:63], a[244:247], v[92:95]
    s_cbranch_vccnz L_gslow_19
    L_gback_20:
    v_mfma_f32_16x16x32_bf16 v[96:99], v[56:59], a[232:235], v[96:99]
    buffer_load_dwordx4 v242, s[24:27], s58 offen lds
    v_mfma_f32_16x16x32_bf16 v[96:99], v[60:63], a[248:251], v[96:99]
    s_add_u32 m0, s61, 126976
    ds_read_b64_tr_b16 v[48:49], v240 offset:20480
    ds_read_b64_tr_b16 v[50:51], v240 offset:22528
    s_mul_i32 s67, s67, 73728
    s_add_u32 s67, s67, s59
    v_mfma_f32_16x16x32_bf16 v[100:103], v[56:59], a[236:239], v[100:103]
    s_add_u32 s58, s15, 36864
    buffer_load_dwordx4 v[188:191], v15, s[28:31], s67 offen offset:0 sc1
    v_mfma_f32_16x16x32_bf16 v[100:103], v[60:63], a[252:255], v[100:103]
    s_waitcnt lgkmcnt(2)
    v_add_f32 v132, v132, v146
    v_add_f32 v133, v133, v147
    v_mfma_f32_16x16x32_bf16 v[88:91], v[64:67], v[16:19], v[88:91]
    buffer_load_dwordx4 v242, s[24:27], s58 offen lds
    v_mfma_f32_16x16x32_bf16 v[88:91], v[68:71], v[32:35], v[88:91]
    s_add_u32 m0, s61, 8192
    ds_read_b64_tr_b16 v[52:53], v4 offset:49152
    ds_read_b64_tr_b16 v[54:55], v4 offset:51200
    v_mfma_f32_16x16x32_bf16 v[92:95], v[64:67], v[20:23], v[92:95]
    s_add_u32 s58, s15, 55296
    v_lshlrev_b32 v146, 16, v183
    v_and_b32 v147, s49, v183
    v_mfma_f32_16x16x32_bf16 v[92:95], v[68:71], v[36:39], v[92:95]
    v_add_f32 v134, v134, v146
    v_add_f32 v135, v135, v147
    v_mfma_f32_16x16x32_bf16 v[96:99], v[64:67], v[24:27], v[96:99]
    buffer_load_dwordx4 v242, s[24:27], s58 offen lds
    v_mfma_f32_16x16x32_bf16 v[96:99], v[68:71], v[40:43], v[96:99]
    s_add_u32 m0, s61, 131072
    ds_read_b64_tr_b16 v[56:57], v240 offset:24576
    ds_read_b64_tr_b16 v[58:59], v240 offset:26624
    v_mfma_f32_16x16x32_bf16 v[100:103], v[64:67], v[28:31], v[100:103]
    s_add_u32 s58, s15, 147456
    s_sub_u32 s56, s13, s57
    s_lshl_b32 s56, s56, 6
    s_add_u32 s56, s56, s55
    v_mfma_f32_16x16x32_bf16 v[100:103], v[68:71], v[44:47], v[100:103]
    s_waitcnt lgkmcnt(2)
    v_lshlrev_b32 v146, 16, v184
    v_and_b32 v147, s49, v184
    v_mfma_f32_16x16x32_bf16 v[72:75], v[48:51], a[0:3], 0
    buffer_load_dwordx4 v242, s[24:27], s58 offen lds
    v_mfma_f32_16x16x32_bf16 v[72:75], v[52:55], a[16:19], v[72:75]
    s_add_u32 m0, s61, 12288
    ds_read_b64_tr_b16 v[60:61], v4 offset:53248
    ds_read_b64_tr_b16 v[62:63], v4 offset:55296
    v_mfma_f32_16x16x32_bf16 v[76:79], v[48:51], a[4:7], 0
    s_waitcnt vmcnt(16) lgkmcnt(4)
    s_barrier
    v_cvt_pk_bf16_f32 v104, v88, v89
    v_cvt_pk_bf16_f32 v105, v90, v91
    v_mfma_f32_16x16x32_bf16 v[76:79], v[52:55], a[20:23], v[76:79]
    s_add_u32 s58, s15, 165888
    v_cvt_pk_bf16_f32 v106, v92, v93
    v_cvt_pk_bf16_f32 v107, v94, v95
    v_mfma_f32_16x16x32_bf16 v[80:83], v[48:51], a[8:11], 0
    buffer_load_dwordx4 v242, s[24:27], s58 offen lds
    v_mfma_f32_16x16x32_bf16 v[80:83], v[52:55], a[24:27], v[80:83]
    s_add_u32 m0, s61, 135168
    ds_read_b64_tr_b16 v[64:65], v240 offset:28672
    ds_read_b64_tr_b16 v[66:67], v240 offset:30720
    v_mfma_f32_16x16x32_bf16 v[84:87], v[48:51], a[12:15], 0
    s_add_u32 s58, s15, 184320
    buffer_store_dwordx4 v[104:107], v15, s[28:31], s56 offen offset:0 sc1
    v_mfma_f32_16x16x32_bf16 v[84:87], v[52:55], a[28:31], v[84:87]
    s_waitcnt lgkmcnt(2)
    v_add_f32 v136, v136, v146
    v_add_f32 v137, v137, v147
    v_mfma_f32_16x16x32_bf16 v[72:75], v[56:59], a[32:35], v[72:75]
    buffer_load_dwordx4 v242, s[24:27], s58 offen lds
    v_mfma_f32_16x16x32_bf16 v[72:75], v[60:63], a[48:51], v[72:75]
    s_add_u32 m0, s61, 16384
    ds_read_b64_tr_b16 v[68:69], v4 offset:57344
    ds_read_b64_tr_b16 v[70:71], v4 offset:59392
    v_mfma_f32_16x16x32_bf16 v[76:79], v[56:59], a[36:39], v[76:79]
    s_add_u32 s58, s15, 202752
    buffer_load_dwordx4 v[192:195], v15, s[28:31], s67 offen offset:1024 sc1
    v_cvt_pk_bf16_f32 v108, v96, v97
    v_cvt_pk_bf16_f32 v109, v98, v99
    v_mfma_f32_16x16x32_bf16 v[76:79], v[60:63], a[52:55], v[76:79]
    v_cvt_pk_bf16_f32 v110, v100, v101
    v_cvt_pk_bf16_f32 v111, v102, v103
    v_mfma_f32_16x16x32_bf16 v[80:83], v[56:59], a[40:43], v[80:83]
    buffer_load_dwordx4 v242, s[24:27], s58 offen lds
    v_mfma_f32_16x16x32_bf16 v[80:83], v[60:63], a[56:59], v[80:83]
    s_add_u32 m0, s61, 81920
    ds_read_b64_tr_b16 v[48:49], v4 offset:61440
    ds_read_b64_tr_b16 v[50:51], v4 offset:63488
    v_mfma_f32_16x16x32_bf16 v[84:87], v[56:59], a[44:47], v[84:87]
    s_add_u32 s58, s15, 294912
    buffer_store_dwordx4 v[108:111], v15, s[28:31], s56 offen offset:1024 sc1
    v_mfma_f32_16x16x32_bf16 v[84:87], v[60:63], a[60:63], v[84:87]
    s_waitcnt lgkmcnt(2)
    v_lshlrev_b32 v146, 16, v185
    v_and_b32 v147, s49, v185
    v_mfma_f32_16x16x32_bf16 v[72:75], v[64:67], a[64:67], v[72:75]
    buffer_load_dwordx4 v242, s[24:27], s58 offen lds
    v_mfma_f32_16x16x32_bf16 v[72:75], v[68:71], a[80:83], v[72:75]
    s_add_u32 m0, s61, 20480
    ds_read_b64_tr_b16 v[52:53], v5 offset:8192
    ds_read_b64_tr_b16 v[54:55], v5 offset:10240
    v_mfma_f32_16x16x32_bf16 v[76:79], v[64:67], a[68:71], v[76:79]
    s_add_u32 s58, s15, 313344
    v_add_f32 v138, v138, v146
    v_add_f32 v139, v139, v147
    v_mfma_f32_16x16x32_bf16 v[76:79], v[68:71], a[84:87], v[76:79]
    v_lshlrev_b32 v146, 16, v186
    v_and_b32 v147, s49, v186
    v_mfma_f32_16x16x32_bf16 v[80:83], v[64:67], a[72:75], v[80:83]
    buffer_load_dwordx4 v242, s[24:27], s58 offen lds
    v_mfma_f32_16x16x32_bf16 v[80:83], v[68:71], a[88:91], v[80:83]
    s_add_u32 m0, s61, 86016
    ds_read_b64_tr_b16 v[56:57], v5 offset:0
    ds_read_b64_tr_b16 v[58:59], v5 offset:2048
    v_mfma_f32_16x16x32_bf16 v[84:87], v[64:67], a[76:79], v[84:87]
    s_add_u32 s58, s15, 331776
    v_add_f32 v140, v140, v146
    v_add_f32 v141, v141, v147
    v_mfma_f32_16x16x32_bf16 v[84:87], v[68:71], a[92:95], v[84:87]
    s_waitcnt lgkmcnt(2)
    v_lshlrev_b32 v146, 16, v187
    v_and_b32 v147, s49, v187
    v_mfma_f32_16x16x32_bf16 v[72:75], v[48:51], a[96:99], v[72:75]
    buffer_load_dwordx4 v242, s[24:27], s58 offen lds
    v_mfma_f32_16x16x32_bf16 v[72:75], v[52:55], a[112:115], v[72:75]
    s_add_u32 m0, s61, 24576
    ds_read_b64_tr_b16 v[60:61], v5 offset:12288
    ds_read_b64_tr_b16 v[62:63], v5 offset:14336
    v_mfma_f32_16x16x32_bf16 v[76:79], v[48:51], a[100:103], v[76:79]
    s_waitcnt vmcnt(18) lgkmcnt(4)
    s_barrier
    v_add_f32 v142, v142, v146
    v_add_f32 v143, v143, v147
    v_mfma_f32_16x16x32_bf16 v[76:79], v[52:55], a[116:119], v[76:79]
    s_add_u32 s58, s15, 350208
    v_mfma_f32_16x16x32_bf16 v[80:83], v[48:51], a[104:107], v[80:83]
    buffer_load_dwordx4 v242, s[24:27], s58 offen lds
    v_mfma_f32_16x16x32_bf16 v[80:83], v[52:55], a[120:123], v[80:83]
    s_add_u32 m0, s61, 90112
    ds_read_b64_tr_b16 v[64:65], v5 offset:4096
    ds_read_b64_tr_b16 v[66:67], v5 offset:6144
    v_mfma_f32_16x16x32_bf16 v[84:87], v[48:51], a[108:111], v[84:87]
    s_add_u32 s58, s15, 442368
    v_mfma_f32_16x16x32_bf16 v[84:87], v[52:55], a[124:127], v[84:87]
    s_waitcnt lgkmcnt(2)
    s_mov_b64 exec, 32
    buffer_load_dword v144, v245, s[28:31], s70 offen offset:640 sc1
    s_mov_b64 exec, -1
    v_mfma_f32_16x16x32_bf16 v[72:75], v[56:59], a[128:131], v[72:75]
    buffer_load_dwordx4 v242, s[24:27], s58 offen lds
    v_mfma_f32_16x16x32_bf16 v[72:75], v[60:63], a[144:147], v[72:75]
    s_add_u32 m0, s61, 28672
    ds_read_b64_tr_b16 v[68:69], v5 offset:32768
    ds_read_b64_tr_b16 v[70:71], v5 offset:34816
    v_mfma_f32_16x16x32_bf16 v[76:79], v[56:59], a[132:135], v[76:79]
    s_add_u32 s58, s15, 460800
    v_mfma_f32_16x16x32_bf16 v[76:79], v[60:63], a[148:151], v[76:79]
    v_mfma_f32_16x16x32_bf16 v[80:83], v[56:59], a[136:139], v[80:83]
    buffer_load_dwordx4 v242, s[24:27], s58 offen lds
    v_mfma_f32_16x16x32_bf16 v[80:83], v[60:63], a[152:155], v[80:83]
    s_add_u32 m0, s61, 139264
    ds_read_b64_tr_b16 v[48:49], v5 offset:36864
    ds_read_b64_tr_b16 v[50:51], v5 offset:38912
    v_mfma_f32_16x16x32_bf16 v[84:87], v[56:59], a[140:143], v[84:87]
    s_add_u32 s58, s15, 479232
    v_mfma_f32_16x16x32_bf16 v[84:87], v[60:63], a[156:159], v[84:87]
    s_waitcnt lgkmcnt(2)
    v_mfma_f32_16x16x32_bf16 v[72:75], v[64:67], a[160:163], v[72:75]
    buffer_load_dwordx4 v242, s[24:27], s58 offen lds
    v_mfma_f32_16x16x32_bf16 v[72:75], v[68:71], a[176:179], v[72:75]
    s_add_u32 m0, s61, 32768
    ds_read_b64_tr_b16 v[52:53], v5 offset:40960
    ds_read_b64_tr_b16 v[54:55], v5 offset:43008
    v_mfma_f32_16x16x32_bf16 v[76:79], v[64:67], a[164:167], v[76:79]
    s_add_u32 s58, s15, 497664
    v_mfma_f32_16x16x32_bf16 v[76:79], v[68:71], a[180:183], v[76:79]
    v_mfma_f32_16x16x32_bf16 v[80:83], v[64:67], a[168:171], v[80:83]
    buffer_load_dwordx4 v242, s[24:27], s58 offen lds
    v_mfma_f32_16x16x32_bf16 v[80:83], v[68:71], a[184:187], v[80:83]
    s_add_u32 m0, s61, 143360
    ds_read_b64_tr_b16 v[56:57], v5 offset:45056
    ds_read_b64_tr_b16 v[58:59], v5 offset:47104
    v_mfma_f32_16x16x32_bf16 v[84:87], v[64:67], a[172:175], v[84:87]
    s_add_u32 s58, s15, 589824
    s_waitcnt vmcnt(11)
    v_lshlrev_b32 v146, 16, v188
    v_and_b32 v147, s49, v188
    v_mfma_f32_16x16x32_bf16 v[84:87], v[68:71], a[188:191], v[84:87]
    s_waitcnt lgkmcnt(2)
    s_waitcnt vmcnt(9)
    s_mov_b64 exec, 1
    buffer_store_dword v145, off, s[28:31], s51 offset:768 sc1
    s_mov_b64 exec, -1
    v_mfma_f32_16x16x32_bf16 v[72:75], v[48:51], a[192:195], v[72:75]
    buffer_load_dwordx4 v8, s[24:27], s58 offen lds
    v_mfma_f32_16x16x32_bf16 v[72:75], v[52:55], a[208:211], v[72:75]
    s_add_u32 m0, s61, 36864
    ds_read_b64_tr_b16 v[60:61], v5 offset:49152
    ds_read_b64_tr_b16 v[62:63], v5 offset:51200
    v_mfma_f32_16x16x32_bf16 v[76:79], v[48:51], a[196:199], v[76:79]
    s_waitcnt vmcnt(18) lgkmcnt(4)
    s_barrier
    v_add_f32 v128, v128, v146
    v_add_f32 v129, v129, v147
    v_mfma_f32_16x16x32_bf16 v[76:79], v[52:55], a[212:215], v[76:79]
    s_add_u32 s58, s15, 626688
    v_lshlrev_b32 v146, 16, v189
    v_and_b32 v147, s49, v189
    v_mfma_f32_16x16x32_bf16 v[80:83], v[48:51], a[200:203], v[80:83]
    buffer_load_dwordx4 v8, s[24:27], s58 offen lds
    v_mfma_f32_16x16x32_bf16 v[80:83], v[52:55], a[216:219], v[80:83]
    ds_read_b64_tr_b16 v[64:65], v5 offset:53248
    ds_read_b64_tr_b16 v[66:67], v5 offset:55296
    v_mfma_f32_16x16x32_bf16 v[84:87], v[48:51], a[204:207], v[84:87]
    v_add_f32 v130, v130, v146
    v_add_f32 v131, v131, v147
    v_mfma_f32_16x16x32_bf16 v[84:87], v[52:55], a[220:223], v[84:87]
    s_waitcnt lgkmcnt(2)
    v_lshlrev_b32 v146, 16, v190
    v_and_b32 v147, s49, v190
    v_mfma_f32_16x16x32_bf16 v[72:75], v[56:59], a[224:227], v[72:75]
    v_mfma_f32_16x16x32_bf16 v[72:75], v[60:63], a[240:243], v[72:75]
    ds_read_b64_tr_b16 v[68:69], v4 offset:0
    ds_read_b64_tr_b16 v[70:71], v4 offset:2048
    s_sub_u32 s67, s5, 5
    s_and_b32 s67, s67, 7
    v_mfma_f32_16x16x32_bf16 v[76:79], v[56:59], a[228:231], v[76:79]
    s_waitcnt vmcnt(7)
    v_cmp_eq_u32 vcc, 0, v144
    v_mfma_f32_16x16x32_bf16 v[76:79], v[60:63], a[244:247], v[76:79]
    s_cbranch_vccnz L_gslow_21
    L_gback_22:
    v_mfma_f32_16x16x32_bf16 v[80:83], v[56:59], a[232:235], v[80:83]
    v_mfma_f32_16x16x32_bf16 v[80:83], v[60:63], a[248:251], v[80:83]
    ds_read_b64_tr_b16 v[48:49], v5 offset:57344
    ds_read_b64_tr_b16 v[50:51], v5 offset:59392
    s_mul_i32 s67, s67, 73728
    s_add_u32 s67, s67, s59
    v_mfma_f32_16x16x32_bf16 v[84:87], v[56:59], a[236:239], v[84:87]
    buffer_load_dwordx4 v[196:199], v15, s[28:31], s67 offen offset:0 sc1
    v_mfma_f32_16x16x32_bf16 v[84:87], v[60:63], a[252:255], v[84:87]
    s_waitcnt lgkmcnt(2)
    v_add_f32 v132, v132, v146
    v_add_f32 v133, v133, v147
    v_mfma_f32_16x16x32_bf16 v[72:75], v[64:67], v[16:19], v[72:75]
    v_mfma_f32_16x16x32_bf16 v[72:75], v[68:71], v[32:35], v[72:75]
    ds_read_b64_tr_b16 v[52:53], v4 offset:4096
    ds_read_b64_tr_b16 v[54:55], v4 offset:6144
    v_mfma_f32_16x16x32_bf16 v[76:79], v[64:67], v[20:23], v[76:79]
    buffer_load_dwordx4 v[200:203], v15, s[28:31], s67 offen offset:1024 sc1
    v_mfma_f32_16x16x32_bf16 v[76:79], v[68:71], v[36:39], v[76:79]
    v_lshlrev_b32 v146, 16, v191
    v_and_b32 v147, s49, v191
    v_mfma_f32_16x16x32_bf16 v[80:83], v[64:67], v[24:27], v[80:83]
    v_mfma_f32_16x16x32_bf16 v[80:83], v[68:71], v[40:43], v[80:83]
    ds_read_b64_tr_b16 v[56:57], v5 offset:61440
    ds_read_b64_tr_b16 v[58:59], v5 offset:63488
    v_mfma_f32_16x16x32_bf16 v[84:87], v[64:67], v[28:31], v[84:87]
    s_sub_u32 s56, s14, s57
    s_lshl_b32 s56, s56, 6
    s_add_u32 s56, s56, s55
    v_mfma_f32_16x16x32_bf16 v[84:87], v[68:71], v[44:47], v[84:87]
    s_waitcnt lgkmcnt(2)
    v_add_f32 v134, v134, v146
    v_add_f32 v135, v135, v147
    v_mfma_f32_16x16x32_bf16 v[88:91], v[48:51], a[0:3], 0
    v_mfma_f32_16x16x32_bf16 v[88:91], v[52:55], a[16:19], v[88:91]
    ds_read_b64_tr_b16 v[60:61], v4 offset:8192
    ds_read_b64_tr_b16 v[62:63], v4 offset:10240
    v_mfma_f32_16x16x32_bf16 v[92:95], v[48:51], a[4:7], 0
    s_waitcnt vmcnt(12) lgkmcnt(4)
    s_barrier
    v_cvt_pk_bf16_f32 v104, v72, v73
    v_cvt_pk_bf16_f32 v105, v74, v75
    v_mfma_f32_16x16x32_bf16 v[92:95], v[52:55], a[20:23], v[92:95]
    v_cvt_pk_bf16_f32 v106, v76, v77
    v_cvt_pk_bf16_f32 v107, v78, v79
    v_mfma_f32_16x16x32_bf16 v[96:99], v[48:51], a[8:11], 0
    v_mfma_f32_16x16x32_bf16 v[96:99], v[52:55], a[24:27], v[96:99]
    ds_read_b64_tr_b16 v[64:65], v240 offset:0
    ds_read_b64_tr_b16 v[66:67], v240 offset:2048
    v_mfma_f32_16x16x32_bf16 v[100:103], v[48:51], a[12:15], 0
    buffer_store_dwordx4 v[104:107], v15, s[28:31], s56 offen offset:0 sc1
    v_mfma_f32_16x16x32_bf16 v[100:103], v[52:55], a[28:31], v[100:103]
    s_waitcnt lgkmcnt(2)
    v_cvt_pk_bf16_f32 v108, v80, v81
    v_cvt_pk_bf16_f32 v109, v82, v83
    v_cvt_pk_bf16_f32 v110, v84, v85
    v_cvt_pk_bf16_f32 v111, v86, v87
    v_mfma_f32_16x16x32_bf16 v[88:91], v[56:59], a[32:35], v[88:91]
    v_mfma_f32_16x16x32_bf16 v[88:91], v[60:63], a[48:51], v[88:91]
    ds_read_b64_tr_b16 v[68:69], v4 offset:12288
    ds_read_b64_tr_b16 v[70:71], v4 offset:14336
    v_mfma_f32_16x16x32_bf16 v[92:95], v[56:59], a[36:39], v[92:95]
    buffer_store_dwordx4 v[108:111], v15, s[28:31], s56 offen offset:1024 sc1
    v_mfma_f32_16x16x32_bf16 v[92:95], v[60:63], a[52:55], v[92:95]
    v_lshlrev_b32 v146, 16, v192
    v_and_b32 v147, s49, v192
    v_mfma_f32_16x16x32_bf16 v[96:99], v[56:59], a[40:43], v[96:99]
    v_mfma_f32_16x16x32_bf16 v[96:99], v[60:63], a[56:59], v[96:99]
    ds_read_b64_tr_b16 v[48:49], v240 offset:4096
    ds_read_b64_tr_b16 v[50:51], v240 offset:6144
    v_mfma_f32_16x16x32_bf16 v[100:103], v[56:59], a[44:47], v[100:103]
    v_add_f32 v136, v136, v146
    v_add_f32 v137, v137, v147
    v_mfma_f32_16x16x32_bf16 v[100:103], v[60:63], a[60:63], v[100:103]
    s_waitcnt lgkmcnt(2)
    v_lshlrev_b32 v146, 16, v193
    v_and_b32 v147, s49, v193
    v_mfma_f32_16x16x32_bf16 v[88:91], v[64:67], a[64:67], v[88:91]
    v_mfma_f32_16x16x32_bf16 v[88:91], v[68:71], a[80:83], v[88:91]
    ds_read_b64_tr_b16 v[52:53], v4 offset:16384
    ds_read_b64_tr_b16 v[54:55], v4 offset:18432
    v_mfma_f32_16x16x32_bf16 v[92:95], v[64:67], a[68:71], v[92:95]
    v_add_f32 v138, v138, v146
    v_add_f32 v139, v139, v147
    v_mfma_f32_16x16x32_bf16 v[92:95], v[68:71], a[84:87], v[92:95]
    v_lshlrev_b32 v146, 16, v194
    v_and_b32 v147, s49, v194
    v_mfma_f32_16x16x32_bf16 v[96:99], v[64:67], a[72:75], v[96:99]
    v_mfma_f32_16x16x32_bf16 v[96:99], v[68:71], a[88:91], v[96:99]
    ds_read_b64_tr_b16 v[56:57], v5 offset:16384
    ds_read_b64_tr_b16 v[58:59], v5 offset:18432
    v_mfma_f32_16x16x32_bf16 v[100:103], v[64:67], a[76:79], v[100:103]
    v_add_f32 v140, v140, v146
    v_add_f32 v141, v141, v147
    v_mfma_f32_16x16x32_bf16 v[100:103], v[68:71], a[92:95], v[100:103]
    s_waitcnt lgkmcnt(2)
    v_lshlrev_b32 v146, 16, v195
    v_and_b32 v147, s49, v195
    v_mfma_f32_16x16x32_bf16 v[88:91], v[48:51], a[96:99], v[88:91]
    v_mfma_f32_16x16x32_bf16 v[88:91], v[52:55], a[112:115], v[88:91]
    ds_read_b64_tr_b16 v[60:61], v4 offset:20480
    ds_read_b64_tr_b16 v[62:63], v4 offset:22528
    v_mfma_f32_16x16x32_bf16 v[92:95], v[48:51], a[100:103], v[92:95]
    s_waitcnt vmcnt(7) lgkmcnt(4)
    s_barrier
    v_add_f32 v142, v142, v146
    v_add_f32 v143, v143, v147
    v_mfma_f32_16x16x32_bf16 v[92:95], v[52:55], a[116:119], v[92:95]
    v_mfma_f32_16x16x32_bf16 v[96:99], v[48:51], a[104:107], v[96:99]
    v_mfma_f32_16x16x32_bf16 v[96:99], v[52:55], a[120:123], v[96:99]
    ds_read_b64_tr_b16 v[64:65], v5 offset:20480
    ds_read_b64_tr_b16 v[66:67], v5 offset:22528
    v_mfma_f32_16x16x32_bf16 v[100:103], v[48:51], a[108:111], v[100:103]
    s_waitcnt vmcnt(2)
    v_lshlrev_b32 v146, 16, v196
    v_and_b32 v147, s49, v196
    v_mfma_f32_16x16x32_bf16 v[100:103], v[52:55], a[124:127], v[100:103]
    s_waitcnt lgkmcnt(2)
    s_mov_b64 exec, 64
    buffer_load_dword v144, v245, s[28:31], s70 offen offset:768 sc1
    s_mov_b64 exec, -1
    v_mfma_f32_16x16x32_bf16 v[88:91], v[56:59], a[128:131], v[88:91]
    v_mfma_f32_16x16x32_bf16 v[88:91], v[60:63], a[144:147], v[88:91]
    ds_read_b64_tr_b16 v[68:69], v4 offset:24576
    ds_read_b64_tr_b16 v[70:71], v4 offset:26624
    v_mfma_f32_16x16x32_bf16 v[92:95], v[56:59], a[132:135], v[92:95]
    v_add_f32 v128, v128, v146
    v_add_f32 v129, v129, v147
    v_mfma_f32_16x16x32_bf16 v[92:95], v[60:63], a[148:151], v[92:95]
    v_lshlrev_b32 v146, 16, v197
    v_and_b32 v147, s49, v197
    v_mfma_f32_16x16x32_bf16 v[96:99], v[56:59], a[136:139], v[96:99]
    v_mfma_f32_16x16x32_bf16 v[96:99], v[60:63], a[152:155], v[96:99]
    ds_read_b64_tr_b16 v[48:49], v5 offset:24576
    ds_read_b64_tr_b16 v[50:51], v5 offset:26624
    v_mfma_f32_16x16x32_bf16 v[100:103], v[56:59], a[140:143], v[100:103]
    v_add_f32 v130, v130, v146
    v_add_f32 v131, v131, v147
    v_mfma_f32_16x16x32_bf16 v[100:103], v[60:63], a[156:159], v[100:103]
    s_waitcnt lgkmcnt(2)
    s_waitcnt vmcnt(1)
    s_mov_b64 exec, 1
    buffer_store_dword v145, off, s[28:31], s51 offset:896 sc1
    s_mov_b64 exec, -1
    v_mfma_f32_16x16x32_bf16 v[88:91], v[64:67], a[160:163], v[88:91]
    v_mfma_f32_16x16x32_bf16 v[88:91], v[68:71], a[176:179], v[88:91]
    ds_read_b64_tr_b16 v[52:53], v4 offset:28672
    ds_read_b64_tr_b16 v[54:55], v4 offset:30720
    v_mfma_f32_16x16x32_bf16 v[92:95], v[64:67], a[164:167], v[92:95]
    v_lshlrev_b32 v146, 16, v198
    v_and_b32 v147, s49, v198
    v_mfma_f32_16x16x32_bf16 v[92:95], v[68:71], a[180:183], v[92:95]
    v_add_f32 v132, v132, v146
    v_add_f32 v133, v133, v147
    v_mfma_f32_16x16x32_bf16 v[96:99], v[64:67], a[168:171], v[96:99]
    v_mfma_f32_16x16x32_bf16 v[96:99], v[68:71], a[184:187], v[96:99]
    ds_read_b64_tr_b16 v[56:57], v240 offset:8192
    ds_read_b64_tr_b16 v[58:59], v240 offset:10240
    v_mfma_f32_16x16x32_bf16 v[100:103], v[64:67], a[172:175], v[100:103]
    v_lshlrev_b32 v146, 16, v199
    v_and_b32 v147, s49, v199
    v_mfma_f32_16x16x32_bf16 v[100:103], v[68:71], a[188:191], v[100:103]
    s_waitcnt lgkmcnt(2)
    v_add_f32 v134, v134, v146
    v_add_f32 v135, v135, v147
    v_mfma_f32_16x16x32_bf16 v[88:91], v[48:51], a[192:195], v[88:91]
    v_mfma_f32_16x16x32_bf16 v[88:91], v[52:55], a[208:211], v[88:91]
    ds_read_b64_tr_b16 v[60:61], v4 offset:32768
    ds_read_b64_tr_b16 v[62:63], v4 offset:34816
    v_mfma_f32_16x16x32_bf16 v[92:95], v[48:51], a[196:199], v[92:95]
    s_waitcnt vmcnt(6) lgkmcnt(4)
    s_barrier
    v_lshlrev_b32 v146, 16, v200
    v_and_b32 v147, s49, v200
    v_mfma_f32_16x16x32_bf16 v[92:95], v[52:55], a[212:215], v[92:95]
    v_add_f32 v136, v136, v146
    v_add_f32 v137, v137, v147
    v_mfma_f32_16x16x32_bf16 v[96:99], v[48:51], a[200:203], v[96:99]
    v_mfma_f32_16x16x32_bf16 v[96:99], v[52:55], a[216:219], v[96:99]
    ds_read_b64_tr_b16 v[64:65], v240 offset:12288
    ds_read_b64_tr_b16 v[66:67], v240 offset:14336
    v_mfma_f32_16x16x32_bf16 v[100:103], v[48:51], a[204:207], v[100:103]
    v_lshlrev_b32 v146, 16, v201
    v_and_b32 v147, s49, v201
    v_mfma_f32_16x16x32_bf16 v[100:103], v[52:55], a[220:223], v[100:103]
    s_waitcnt lgkmcnt(2)
    v_add_f32 v138, v138, v146
    v_add_f32 v139, v139, v147
    v_mfma_f32_16x16x32_bf16 v[88:91], v[56:59], a[224:227], v[88:91]
    v_mfma_f32_16x16x32_bf16 v[88:91], v[60:63], a[240:243], v[88:91]
    ds_read_b64_tr_b16 v[68:69], v4 offset:36864
    ds_read_b64_tr_b16 v[70:71], v4 offset:38912
    s_sub_u32 s67, s5, 6
    s_and_b32 s67, s67, 7
    v_mfma_f32_16x16x32_bf16 v[92:95], v[56:59], a[228:231], v[92:95]
    s_waitcnt vmcnt(1)
    v_cmp_eq_u32 vcc, 0, v144
    s_mul_i32 s67, s67, 73728
    s_add_u32 s67, s67, s59
    v_mfma_f32_16x16x32_bf16 v[92:95], v[60:63], a[244:247], v[92:95]
    s_cbranch_vccnz L_gslow_23
    L_gback_24:
    v_mfma_f32_16x16x32_bf16 v[96:99], v[56:59], a[232:235], v[96:99]
    buffer_load_dwordx4 v[204:207], v15, s[28:31], s67 offen offset:0 sc1
    v_mfma_f32_16x16x32_bf16 v[96:99], v[60:63], a[248:251], v[96:99]
    v_mfma_f32_16x16x32_bf16 v[100:103], v[56:59], a[236:239], v[100:103]
    v_lshlrev_b32 v146, 16, v202
    v_and_b32 v147, s49, v202
    v_mfma_f32_16x16x32_bf16 v[100:103], v[60:63], a[252:255], v[100:103]
    s_waitcnt lgkmcnt(0)
    v_add_f32 v140, v140, v146
    v_add_f32 v141, v141, v147
    v_mfma_f32_16x16x32_bf16 v[88:91], v[64:67], v[16:19], v[88:91]
    buffer_load_dwordx4 v[208:211], v15, s[28:31], s67 offen offset:1024 sc1
    s_sub_u32 s65, s5, 7
    s_and_b32 s65, s65, 7
    v_mfma_f32_16x16x32_bf16 v[88:91], v[68:71], v[32:35], v[88:91]
    s_mul_i32 s65, s65, 73728
    s_add_u32 s65, s65, s59
    v_mfma_f32_16x16x32_bf16 v[92:95], v[64:67], v[20:23], v[92:95]
    v_lshlrev_b32 v146, 16, v203
    v_and_b32 v147, s49, v203
    v_mfma_f32_16x16x32_bf16 v[92:95], v[68:71], v[36:39], v[92:95]
    v_add_f32 v142, v142, v146
    v_add_f32 v143, v143, v147
    v_mfma_f32_16x16x32_bf16 v[96:99], v[64:67], v[24:27], v[96:99]
    v_mfma_f32_16x16x32_bf16 v[96:99], v[68:71], v[40:43], v[96:99]
    v_mfma_f32_16x16x32_bf16 v[100:103], v[64:67], v[28:31], v[100:103]
    v_mfma_f32_16x16x32_bf16 v[100:103], v[68:71], v[44:47], v[100:103]
    s_add_u32 s64, s5, 1
    s_and_b32 s64, s64, 7
    s_lshl_b32 s64, s64, 10
    s_add_u32 s64, s64, s70
    s_add_u32 s7, s64, 896
    s_mov_b32 s6, 0
L_spoll_25:
    s_load_dword s12, s[28:29], s7 glc
    s_add_u32 s6, s6, 1
    s_cmp_gt_u32 s6, 0x200000
    s_cbranch_scc1 L_spolle_26
    s_waitcnt lgkmcnt(0)
    s_and_b32 s12, s12, s12
    s_cbranch_scc0 L_spoll_25
L_spolle_26:
    buffer_load_dwordx4 v[212:215], v15, s[28:31], s65 offen offset:0 sc1
    buffer_load_dwordx4 v[216:219], v15, s[28:31], s65 offen offset:1024 sc1
    v_mov_b32 v60, 0xc0088e99
    v_pk_fma_f32 v[148:149], v[148:149], v[60:61], v[152:153] op_sel_hi:[1,0,1]
    v_cvt_pk_bf16_f32 v66, v148, v149
    v_pk_fma_f32 v[150:151], v[150:151], v[60:61], v[154:155] op_sel_hi:[1,0,1]
    v_cvt_pk_bf16_f32 v67, v150, v151
    s_mov_b32 exec_lo, 0x00ff00ff
    s_mov_b32 exec_hi, 0x00ff00ff
    buffer_store_dwordx2 v[66:67], v254, s[32:35], 0 offen
    s_mov_b64 exec, -1
    v_pk_add_f32 v[88:89], v[88:89], v[128:129]
    v_pk_add_f32 v[90:91], v[90:91], v[130:131]
    v_pk_add_f32 v[92:93], v[92:93], v[132:133]
    v_pk_add_f32 v[94:95], v[94:95], v[134:135]
    v_pk_add_f32 v[96:97], v[96:97], v[136:137]
    v_pk_add_f32 v[98:99], v[98:99], v[138:139]
    v_pk_add_f32 v[100:101], v[100:101], v[140:141]
    v_pk_add_f32 v[102:103], v[102:103], v[142:143]
    s_waitcnt vmcnt(3)
    v_lshlrev_b32 v62, 16, v204
    v_and_b32 v63, s49, v204
    v_pk_add_f32 v[88:89], v[88:89], v[62:63]
    v_lshlrev_b32 v64, 16, v205
    v_and_b32 v65, s49, v205
    v_pk_add_f32 v[90:91], v[90:91], v[64:65]
    v_lshlrev_b32 v62, 16, v206
    v_and_b32 v63, s49, v206
    v_pk_add_f32 v[92:93], v[92:93], v[62:63]
    v_lshlrev_b32 v64, 16, v207
    v_and_b32 v65, s49, v207
    v_pk_add_f32 v[94:95], v[94:95], v[64:65]
    v_lshlrev_b32 v62, 16, v208
    v_and_b32 v63, s49, v208
    v_pk_add_f32 v[96:97], v[96:97], v[62:63]
    v_lshlrev_b32 v64, 16, v209
    v_and_b32 v65, s49, v209
    v_pk_add_f32 v[98:99], v[98:99], v[64:65]
    v_lshlrev_b32 v62, 16, v210
    v_and_b32 v63, s49, v210
    v_pk_add_f32 v[100:101], v[100:101], v[62:63]
    v_lshlrev_b32 v64, 16, v211
    v_and_b32 v65, s49, v211
    v_pk_add_f32 v[102:103], v[102:103], v[64:65]
    v_pk_fma_f32 v[88:89], v[88:89], v[60:61], v[112:113] op_sel_hi:[1,0,1]
    v_pk_fma_f32 v[90:91], v[90:91], v[60:61], v[114:115] op_sel_hi:[1,0,1]
    v_pk_fma_f32 v[92:93], v[92:93], v[60:61], v[116:117] op_sel_hi:[1,0,1]
    v_pk_fma_f32 v[94:95], v[94:95], v[60:61], v[118:119] op_sel_hi:[1,0,1]
    v_pk_fma_f32 v[96:97], v[96:97], v[60:61], v[120:121] op_sel_hi:[1,0,1]
    v_pk_fma_f32 v[98:99], v[98:99], v[60:61], v[122:123] op_sel_hi:[1,0,1]
    v_pk_fma_f32 v[100:101], v[100:101], v[60:61], v[124:125] op_sel_hi:[1,0,1]
    v_pk_fma_f32 v[102:103], v[102:103], v[60:61], v[126:127] op_sel_hi:[1,0,1]
    s_waitcnt vmcnt(2)
    v_lshlrev_b32 v62, 16, v212
    v_and_b32 v63, s49, v212
    v_pk_fma_f32 v[88:89], v[62:63], v[60:61], v[88:89] op_sel_hi:[1,0,1]
    v_cvt_pk_bf16_f32 v104, v88, v89
    v_lshlrev_b32 v64, 16, v213
    v_and_b32 v65, s49, v213
    v_pk_fma_f32 v[90:91], v[64:65], v[60:61], v[90:91] op_sel_hi:[1,0,1]
    v_cvt_pk_bf16_f32 v105, v90, v91
    s_mov_b32 s6, 0
    buffer_store_dwordx2 v[104:105], v253, s[32:35], s6 offen
    v_lshlrev_b32 v62, 16, v214
    v_and_b32 v63, s49, v214
    v_pk_fma_f32 v[92:93], v[62:63], v[60:61], v[92:93] op_sel_hi:[1,0,1]
    v_cvt_pk_bf16_f32 v106, v92, v93
    v_lshlrev_b32 v64, 16, v215
    v_and_b32 v65, s49, v215
    v_pk_fma_f32 v[94:95], v[64:65], v[60:61], v[94:95] op_sel_hi:[1,0,1]
    v_cvt_pk_bf16_f32 v107, v94, v95
    s_mov_b32 s6, 18432
    buffer_store_dwordx2 v[106:107], v253, s[32:35], s6 offen
    s_waitcnt vmcnt(3)
    v_lshlrev_b32 v62, 16, v216
    v_and_b32 v63, s49, v216
    v_pk_fma_f32 v[96:97], v[62:63], v[60:61], v[96:97] op_sel_hi:[1,0,1]
    v_cvt_pk_bf16_f32 v108, v96, v97
    v_lshlrev_b32 v64, 16, v217
    v_and_b32 v65, s49, v217
    v_pk_fma_f32 v[98:99], v[64:65], v[60:61], v[98:99] op_sel_hi:[1,0,1]
    v_cvt_pk_bf16_f32 v109, v98, v99
    s_mov_b32 s6, 36864
    buffer_store_dwordx2 v[108:109], v253, s[32:35], s6 offen
    v_lshlrev_b32 v62, 16, v218
    v_and_b32 v63, s49, v218
    v_pk_fma_f32 v[100:101], v[62:63], v[60:61], v[100:101] op_sel_hi:[1,0,1]
    v_cvt_pk_bf16_f32 v110, v100, v101
    v_lshlrev_b32 v64, 16, v219
    v_and_b32 v65, s49, v219
    v_pk_fma_f32 v[102:103], v[64:65], v[60:61], v[102:103] op_sel_hi:[1,0,1]
    v_cvt_pk_bf16_f32 v111, v102, v103
    s_mov_b32 s6, 55296
    buffer_store_dwordx2 v[110:111], v253, s[32:35], s6 offen
    s_endpgm
    L_dslow_3:
    s_lshl_b32 s7, s4, 2
    v_mov_b32 v249, 0
    s_mov_b64 exec, 1
    s_mov_b32 s6, 0
    L_poll_1005:
    buffer_load_dword v250, v249, s[44:47], s7 offen offset:0 sc1
    s_add_u32 s6, s6, 1
    s_cmp_gt_u32 s6, 0x200000
    s_cbranch_scc1 L_polle_1006
    s_waitcnt vmcnt(0)
    v_cmp_gt_u32 vcc, 1, v250
    s_cbranch_vccnz L_poll_1005
    L_polle_1006:
    s_mov_b64 exec, -1
    s_branch L_dback_4
    L_gslow_11:
    s_mov_b64 exec, 255
    s_mov_b32 s6, 0
    L_poll_2013:
    buffer_load_dword v144, v245, s[28:31], s70 offen offset:0 sc1
    s_add_u32 s6, s6, 1
    s_cmp_gt_u32 s6, 0x200000
    s_cbranch_scc1 L_polle_2014
    s_waitcnt vmcnt(0)
    v_cmp_gt_u32 vcc, 1, v144
    s_cbranch_vccnz L_poll_2013
    L_polle_2014:
    s_mov_b64 exec, -1
    s_branch L_gback_12
    L_gslow_13:
    s_mov_b64 exec, 2
    s_mov_b32 s6, 0
    L_poll_2015:
    buffer_load_dword v144, v245, s[28:31], s70 offen offset:128 sc1
    s_add_u32 s6, s6, 1
    s_cmp_gt_u32 s6, 0x200000
    s_cbranch_scc1 L_polle_2016
    s_waitcnt vmcnt(0)
    v_cmp_gt_u32 vcc, 1, v144
    s_cbranch_vccnz L_poll_2015
    L_polle_2016:
    s_mov_b64 exec, -1
    s_branch L_gback_14
    L_gslow_15:
    s_mov_b64 exec, 4
    s_mov_b32 s6, 0
    L_poll_2017:
    buffer_load_dword v144, v245, s[28:31], s70 offen offset:256 sc1
    s_add_u32 s6, s6, 1
    s_cmp_gt_u32 s6, 0x200000
    s_cbranch_scc1 L_polle_2018
    s_waitcnt vmcnt(0)
    v_cmp_gt_u32 vcc, 1, v144
    s_cbranch_vccnz L_poll_2017
    L_polle_2018:
    s_mov_b64 exec, -1
    s_branch L_gback_16
    L_gslow_17:
    s_mov_b64 exec, 8
    s_mov_b32 s6, 0
    L_poll_2019:
    buffer_load_dword v144, v245, s[28:31], s70 offen offset:384 sc1
    s_add_u32 s6, s6, 1
    s_cmp_gt_u32 s6, 0x200000
    s_cbranch_scc1 L_polle_2020
    s_waitcnt vmcnt(0)
    v_cmp_gt_u32 vcc, 1, v144
    s_cbranch_vccnz L_poll_2019
    L_polle_2020:
    s_mov_b64 exec, -1
    s_branch L_gback_18
    L_gslow_19:
    s_mov_b64 exec, 16
    s_mov_b32 s6, 0
    L_poll_2021:
    buffer_load_dword v144, v245, s[28:31], s70 offen offset:512 sc1
    s_add_u32 s6, s6, 1
    s_cmp_gt_u32 s6, 0x200000
    s_cbranch_scc1 L_polle_2022
    s_waitcnt vmcnt(0)
    v_cmp_gt_u32 vcc, 1, v144
    s_cbranch_vccnz L_poll_2021
    L_polle_2022:
    s_mov_b64 exec, -1
    s_branch L_gback_20
    L_gslow_21:
    s_mov_b64 exec, 32
    s_mov_b32 s6, 0
    L_poll_2023:
    buffer_load_dword v144, v245, s[28:31], s70 offen offset:640 sc1
    s_add_u32 s6, s6, 1
    s_cmp_gt_u32 s6, 0x200000
    s_cbranch_scc1 L_polle_2024
    s_waitcnt vmcnt(0)
    v_cmp_gt_u32 vcc, 1, v144
    s_cbranch_vccnz L_poll_2023
    L_polle_2024:
    s_mov_b64 exec, -1
    s_branch L_gback_22
    L_gslow_23:
    s_mov_b64 exec, 64
    s_mov_b32 s6, 0
    L_poll_2025:
    buffer_load_dword v144, v245, s[28:31], s70 offen offset:768 sc1
    s_add_u32 s6, s6, 1
    s_cmp_gt_u32 s6, 0x200000
    s_cbranch_scc1 L_polle_2026
    s_waitcnt vmcnt(0)
    v_cmp_gt_u32 vcc, 1, v144
    s_cbranch_vccnz L_poll_2025
    L_polle_2026:
    s_mov_b64 exec, -1
    s_branch L_gback_24
L_end:
    s_endpgm

.section .rodata,"a"
.p2align 6
.amdhsa_kernel sequential_preLN__sliding_local_dilated__dense_activation_gelu__prompt_kernel
  .amdhsa_next_free_vgpr 512
  .amdhsa_next_free_sgpr 102
  .amdhsa_accum_offset 256
  .amdhsa_group_segment_fixed_size 0
  .amdhsa_kernarg_size 88
  .amdhsa_user_sgpr_count 2
  .amdhsa_user_sgpr_kernarg_segment_ptr 1
  .amdhsa_system_sgpr_workgroup_id_x 1
  .amdhsa_float_denorm_mode_32 3
.end_amdhsa_kernel
```
